```python
import torch

def _softmax(x, axis=-1):
    return torch.softmax(x, dim=axis)
def _gelu(x):
    return torch.nn.functional.gelu(x, approximate="tanh")
def _silu(x):
    return torch.nn.functional.silu(x)
def _sigmoid(x):
    return torch.sigmoid(x)
def _layernorm(x, axis=-1, eps=1e-5):
    m = x.mean(dim=axis, keepdim=True)
    v = x.var(dim=axis, keepdim=True, unbiased=False)
    return (x - m) / torch.sqrt(v + eps)
def _scatter_add(tgt, idx, src, axis=0):
    return tgt.clone().index_add_(axis, idx, src)
def _segment_sum(src, seg, n):
    out = torch.zeros((n,) + src.shape[1:], dtype=src.dtype)
    return out.index_add_(0, seg, src)
def _pad(x, pw):
    flat = tuple(v for pair in reversed(pw) for v in pair)
    return torch.nn.functional.pad(x, flat)

kernel_name = 'concat_heads__grouped_kv_mqa__ssm_conv_s4d__prompt'

def setup_inputs():

    _w = (lambda a: (lambda t: t.to(torch.bfloat16) if t.is_floating_point() else t)(torch.as_tensor(a)))
    def _A_setup():
        B, S, D, H = 1, 2048, 640, 32
        Dh = D // H
        return {
            "x": _w((lambda *s: torch.randn(*s, dtype=torch.bfloat16) * 0.05)(B, S, D)),
            "wq": _w((lambda *s: torch.randn(*s, dtype=torch.bfloat16) * 0.8)(D, H * Dh)),
            "wk": _w((lambda *s: torch.randn(*s, dtype=torch.bfloat16) * 0.8)(D, Dh)),
            "wv": _w((lambda *s: torch.randn(*s, dtype=torch.bfloat16) * 0.05)(D, Dh)),
            "wo": _w((lambda *s: torch.randn(*s, dtype=torch.bfloat16) * 0.05)(H * Dh, D)),
        }
    _A_in = _A_setup()

    def _B_setup():
        Bsz, L, D, N = 1, 2048, 640, 128
        return {
            "u": _w((lambda *s: torch.randn(*s, dtype=torch.bfloat16) * 0.05)(Bsz, L, D)),
            "log_A_real": _w((lambda *s: torch.randn(*s, dtype=torch.bfloat16) * 6.4)(D, N) * 0.5),
            "A_imag": _w((lambda *s: torch.randn(*s, dtype=torch.bfloat16) * 0.05)(D, N) * 3.14),
            "C_real": _w((lambda *s: torch.randn(*s, dtype=torch.bfloat16) * 0.05)(D, N) / N ** 0.5),
            "C_imag": _w((lambda *s: torch.randn(*s, dtype=torch.bfloat16) * 0.05)(D, N) / N ** 0.5),
            "log_dt": _w((lambda *s: torch.randn(*s, dtype=torch.bfloat16) * 0.05)(D) * 0.5 - 4.0),
            "D_skip": _w((lambda *s: torch.randn(*s, dtype=torch.bfloat16) * 0.05)(D)),
        }
    _B_in = _B_setup()

    return {
        "A_x": _A_in["x"],
        "A_wq": _A_in["wq"],
        "A_wk": _A_in["wk"],
        "A_wv": _A_in["wv"],
        "A_wo": _A_in["wo"],
        "B_u": _B_in["u"],
        "B_log_A_real": _B_in["log_A_real"],
        "B_A_imag": _B_in["A_imag"],
        "B_C_real": _B_in["C_real"],
        "B_C_imag": _B_in["C_imag"],
        "B_log_dt": _B_in["log_dt"],
        "B_D_skip": _B_in["D_skip"],
    }

def reference(A_x, A_wq, A_wk, A_wv, A_wo, B_u, B_log_A_real, B_A_imag, B_C_real, B_C_imag, B_log_dt, B_D_skip):
    def _A_ref(x, wq, wk, wv, wo):
        B, S, D = x.shape
        H = 32
        Dh = D // H
        q = (lambda x, *d: x.permute(*d))((x @ wq).reshape(B, S, H, Dh), 0, 2, 1, 3)
        k = x @ wk
        v = x @ wv
        scores = torch.einsum("bhqd,bkd->bhqk", q, k) * (Dh ** -0.5)
        p = _softmax(scores, axis=-1)
        o = torch.einsum("bhqk,bkd->bhqd", p, v)
        return (lambda x, *d: x.permute(*d))(o, 0, 2, 1, 3).reshape(B, S, H * Dh) @ wo

    def _B_ref(u, log_A_real, A_imag, C_real, C_imag, log_dt, D_skip):
        L = u.shape[1]
        dt = torch.exp(log_dt)
        A = -torch.exp(log_A_real) + 1j * A_imag
        C = (C_real + 1j * C_imag) * dt[:, None]
        pos = (lambda x, dt: x.to(dt))(torch.arange(L), log_dt.dtype)
        P = torch.exp((A * dt[:, None])[:, :, None] * pos[None, None, :])
        K = 2.0 * torch.einsum("dn,dnl->dl", C, P).real
        L2 = 2 * L
        u_t = (lambda x, *d: x.permute(*d))(u, 0, 2, 1)
        Kf = (lambda x, *a, **k: torch.fft.rfft(x.float(), *a, **k))(K, L2)
        Uf = (lambda x, *a, **k: torch.fft.rfft(x.float(), *a, **k))(u_t, L2)
        y = (lambda x, *a, **k: torch.fft.irfft(x, *a, **k).to(torch.bfloat16))(Uf * Kf[None, :, :], L2)[:, :, :L]
        y = (lambda x, *d: x.permute(*d))(y, 0, 2, 1)
        return y + u * D_skip[None, None, :]

    a = _A_ref(A_x, A_wq, A_wk, A_wv, A_wo)
    b = _B_ref(B_u, B_log_A_real, B_A_imag, B_C_real, B_C_imag, B_log_dt, B_D_skip)
    return torch.concatenate([a, b], axis=-1)
```

```asm
; @launch grid=(256,1,1) block=(512,1,1) lds=163840
.amdgcn_target "amdgcn-amd-amdhsa--gfx950"
.text
.globl concat_heads__grouped_kv_mqa__ssm_conv_s4d__prompt_kernel
.p2align 8
.type concat_heads__grouped_kv_mqa__ssm_conv_s4d__prompt_kernel,@function
concat_heads__grouped_kv_mqa__ssm_conv_s4d__prompt_kernel:
    s_cmp_ge_u32 s2, 256
    s_cbranch_scc1 L_end
    s_load_dwordx16 s[4:19], s[0:1], 0
    s_load_dwordx2 s[32:33], s[0:1], 112
    s_load_dwordx8 s[20:27], s[0:1], 64
    s_load_dwordx4 s[28:31], s[0:1], 96
    v_lshrrev_b32 v1, 6, v0
    v_and_b32 v0, 63, v0
    s_and_b32 s53, s2, 7
    v_readfirstlane_b32 s52, v1
    s_lshr_b32 s54, s2, 3
    s_lshr_b32 s62, s54, 3
    s_lshl_b32 s55, s53, 2
    s_add_u32 s55, s55, s62
    s_and_b32 s56, s54, 7
    v_lshlrev_b32 v1, 4, v0
    s_getpc_b64 s[92:93]
L_pc:
    s_sub_u32 s92, s92, L_pc - concat_heads__grouped_kv_mqa__ssm_conv_s4d__prompt_kernel
    s_subb_u32 s93, s93, 0
    s_lshl_b32 s62, s52, 10
    v_add_u32 v3, s62, v1
    v_add_co_u32 v4, vcc, s92, v3
    v_mov_b32 v5, s93
    s_mul_i32 s63, s54, 1024
    v_addc_co_u32 v5, vcc, 0, v5, vcc
    s_cmp_lt_u32 s52, 6
    global_load_dwordx4 v[200:203], v[4:5], off
    s_cbranch_scc1 L_nocp
    s_add_u32 s63, s63, 2048
    v_add_u32 v3, s63, v3
    v_min_u32 v3, L_code_end - concat_heads__grouped_kv_mqa__ssm_conv_s4d__prompt_kernel - 16, v3
    v_add_co_u32 v4, vcc, s92, v3
    v_mov_b32 v5, s93
    s_nop 0
    v_addc_co_u32 v5, vcc, 0, v5, vcc
    global_load_dwordx4 v[200:203], v[4:5], off
L_nocp:
    v_lshrrev_b32 v2, 3, v0
    v_and_b32 v3, 7, v0
    v_xor_b32 v3, v3, v2
    v_mul_u32_u24 v2, 1280, v2
    v_lshl_add_u32 v250, v3, 4, v2
    v_mov_b32 v245, 0
    s_lshr_b32 s62, s54, 1
    s_mul_i32 s62, s62, 5
    s_mul_i32 s58, s53, 80
    s_add_u32 s58, s58, s62
    s_add_u32 s59, s58, 2
    s_and_b32 s62, s54, 1
    s_mul_i32 s62, s62, 3
    s_add_u32 s58, s58, s62
    s_lshr_b32 s62, s56, 1
    s_add_u32 s70, s62, s52
    s_and_b32 s70, s70, 3
    s_lshr_b32 s71, s52, 2
    s_mov_b32 s72, 0
    s_mov_b32 s60, 0x000fffff
    s_mov_b32 s61, 0x000fffff
    s_mul_i32 s67, s55, 81920
    s_cmp_ge_u32 s52, 4
    s_cbranch_scc1 L_kside
    s_setprio 2
    s_waitcnt lgkmcnt(0)
    s_load_dword s57, s[32:33], 0
    s_mov_b32 s36, s4
    s_mov_b32 s37, s5
    s_mov_b32 s38, 2621440
    s_mov_b32 s39, 0x00020000
    s_and_b32 s65, s56, 6
    s_and_b32 s66, s52, 1
    s_add_u32 s65, s65, s66
    s_lshr_b32 s66, s52, 1
    s_mul_i32 s62, s65, 10240
    s_lshl_b32 s63, s66, 7
    s_add_u32 s62, s62, s63
    s_add_u32 s62, s62, s67
    s_lshl_b32 s63, s66, 3
    s_add_u32 s63, s63, s65
    s_lshl_b32 m0, s63, 10
    s_bitcmp1_b32 s56, 0
    buffer_load_dwordx4 v250, s[36:39], s62 offen  lds
    s_add_u32 m0, m0, 16384
    s_add_u32 s62, s62, 256
    buffer_load_dwordx4 v250, s[36:39], s62 offen  lds
    s_add_u32 m0, m0, 16384
    s_add_u32 s62, s62, 256
    buffer_load_dwordx4 v250, s[36:39], s62 offen  lds
    s_add_u32 m0, m0, 16384
    s_add_u32 s62, s62, 256
    buffer_load_dwordx4 v250, s[36:39], s62 offen  lds
    s_add_u32 m0, m0, 16384
    s_add_u32 s62, s62, 256
    buffer_load_dwordx4 v250, s[36:39], s62 offen  lds
    s_bitcmp1_b32 s56, 0
    s_cselect_b32 s40, s10, s8
    s_cselect_b32 s41, s11, s9
    s_mov_b32 s42, 25600
    s_mov_b32 s43, 0x00020000
    s_lshl_b32 s62, s52, 10
    s_add_u32 m0, s62, 102400
    s_nop 0
    buffer_load_dwordx4 v1, s[40:43], s62 offen lds
    s_add_u32 m0, m0, 4096
    s_add_u32 s62, s62, 4096
    buffer_load_dwordx4 v1, s[40:43], s62 offen lds
    s_add_u32 m0, m0, 4096
    s_add_u32 s62, s62, 4096
    buffer_load_dwordx4 v1, s[40:43], s62 offen lds
    s_add_u32 m0, m0, 4096
    s_add_u32 s62, s62, 4096
    buffer_load_dwordx4 v1, s[40:43], s62 offen lds
    s_add_u32 m0, m0, 4096
    s_add_u32 s62, s62, 4096
    buffer_load_dwordx4 v1, s[40:43], s62 offen lds
    s_add_u32 m0, m0, 4096
    s_add_u32 s62, s62, 4096
    buffer_load_dwordx4 v1, s[40:43], s62 offen lds
    s_add_u32 m0, m0, 4096
    s_add_u32 s62, s62, 4096
    s_cmp_lg_u32 s52, 0
    s_cbranch_scc1 L_wk_done
    buffer_load_dwordx4 v1, s[40:43], s62 offen lds
L_wk_done:
    s_mul_i32 s66, s52, 15
    s_mul_i32 s65, s66, 205
    s_lshr_b32 s65, s65, 11
    s_mul_i32 s63, s65, 10
    s_sub_u32 s66, s66, s63
    s_and_b32 s63, s56, 6
    s_add_u32 s65, s65, s63
    s_add_u32 s65, s65, 2
    s_and_b32 s65, s65, 7
    s_mov_b32 s64, 15
L_xl_lo:
    s_mul_i32 s62, s65, 10240
    s_lshl_b32 s63, s66, 7
    s_add_u32 s62, s62, s63
    s_lshl_b32 s63, s66, 3
    s_add_u32 s63, s63, s65
    s_lshl_b32 m0, s63, 10
    s_add_u32 s62, s62, s67
    buffer_load_dwordx4 v250, s[36:39], s62 offen  lds
    s_add_u32 s66, s66, 1
    s_cmp_eq_u32 s66, 10
    s_cselect_b32 s66, 0, s66
    s_addc_u32 s65, s65, 0
    s_and_b32 s65, s65, 7
    s_sub_u32 s64, s64, 1
    s_cmp_lg_u32 s64, 0
    s_cbranch_scc1 L_xl_lo
    s_mov_b32 s44, s32
    s_mov_b32 s45, s33
    s_mov_b32 s46, 16777216
    s_mov_b32 s47, 0x00020000
    s_lshl_b32 s64, s52, 6
    v_add_u32 v2, s64, v0
    v_mul_u32_u24 v3, 6554, v2
    v_lshrrev_b32 v3, 16, v3
    v_mul_u32_u24 v4, 10, v3
    v_sub_u32 v2, v2, v4
    v_lshrrev_b32 v4, 2, v3
    v_lshrrev_b32 v5, 3, v3
    v_xor_b32 v4, v4, v5
    v_and_b32 v4, 1, v4
    v_mul_u32_u24 v4, 12, v4
    v_xor_b32 v3, v3, v4
    v_mul_u32_u24 v3, 1280, v3
    v_lshl_add_u32 v245, v2, 4, v3
    v_add_u32 v2, 256, v0
    v_mul_u32_u24 v3, 6554, v2
    v_lshrrev_b32 v3, 16, v3
    v_mul_u32_u24 v4, 10, v3
    v_sub_u32 v2, v2, v4
    v_lshrrev_b32 v4, 2, v3
    v_lshrrev_b32 v5, 3, v3
    v_xor_b32 v4, v4, v5
    v_and_b32 v4, 1, v4
    v_mul_u32_u24 v4, 12, v4
    v_xor_b32 v3, v3, v4
    v_mul_u32_u24 v3, 1280, v3
    v_lshl_add_u32 v8, v2, 4, v3
    v_lshrrev_b32 v2, 5, v0
    v_lshlrev_b32 v2, 4, v2
    v_bfe_u32 v3, v0, 4, 1
    v_lshl_add_u32 v2, v3, 2, v2
    v_bfe_u32 v3, v0, 2, 2
    v_add_u32 v2, v2, v3
    v_mul_u32_u24 v2, 160, v2
    v_and_b32 v3, 3, v0
    v_lshl_add_u32 v2, v3, 3, v2
    s_bitcmp0_b32 s52, 0
    s_cselect_b32 s63, 96, 0
    v_add_u32 v14, s63, v2
    v_and_b32 v2, 15, v0
    v_lshrrev_b32 v3, 4, v0
    v_and_b32 v4, 7, v2
    v_xor_b32 v4, v3, v4
    v_lshlrev_b32 v5, 7, v2
    v_lshl_add_u32 v246, v4, 4, v5
    v_xor_b32 v247, 64, v246
    s_lshr_b32 s62, s52, 1
    s_mul_i32 s62, s62, 5120
    s_add_u32 s62, s62, s63
    s_add_u32 s62, s62, 152320
    v_mul_u32_u24 v2, 160, v2
    v_lshl_add_u32 v2, v3, 3, v2
    v_add_u32 v13, s62, v2
    s_bitcmp1_b32 s52, 0
    s_cbranch_scc1 L_q_wa1
    s_mov_b32 s40, s6
    s_mov_b32 s41, s7
    s_mov_b32 s42, 819200
    s_mov_b32 s43, 0x00020000
    s_lshl_b32 s90, s52, 10
    s_add_u32 s90, s90, 81920
    s_mul_i32 s91, s56, 160
    s_add_u32 s91, s91, 655360
    s_lshr_b32 s64, s52, 1
    s_add_u32 s64, s64, 16
    s_mul_i32 s92, s64, 5120
    s_add_u32 s92, s92, 4096
    s_mul_i32 s93, s64, 40960
    s_mul_i32 s64, s56, 160
    s_add_u32 s93, s93, s64
    s_mov_b32 m0, s90
    s_add_u32 s90, s90, 5120
    buffer_load_dwordx4 v245, s[40:43], s91 offen lds
    s_add_u32 s91, s91, 40960
    s_mov_b32 m0, s90
    s_add_u32 s90, s90, 5120
    buffer_load_dwordx4 v245, s[40:43], s91 offen lds
    s_add_u32 s91, s91, 40960
    s_mov_b32 m0, s92
    s_add_u32 s92, s92, 10240
    buffer_load_dwordx4 v8, s[40:43], s93 offen lds
    s_add_u32 s93, s93, 81920
    s_mov_b32 m0, s90
    s_add_u32 s90, s90, 5120
    buffer_load_dwordx4 v245, s[40:43], s91 offen lds
    s_add_u32 s91, s91, 40960
    s_mov_b32 m0, s90
    s_add_u32 s90, s90, 5120
    buffer_load_dwordx4 v245, s[40:43], s91 offen lds
    s_add_u32 s91, s91, 40960
    s_mov_b32 m0, s92
    s_add_u32 s92, s92, 10240
    buffer_load_dwordx4 v8, s[40:43], s93 offen lds
    s_add_u32 s93, s93, 81920
    s_branch L_q_wa2
L_q_wa1:
    s_mov_b32 s40, s6
    s_mov_b32 s41, s7
    s_mov_b32 s42, 819200
    s_mov_b32 s43, 0x00020000
    s_lshl_b32 s90, s52, 10
    s_add_u32 s90, s90, 81920
    s_mul_i32 s91, s56, 160
    s_add_u32 s91, s91, 655360
    s_mov_b32 m0, s90
    s_add_u32 s90, s90, 5120
    buffer_load_dwordx4 v245, s[40:43], s91 offen lds
    s_add_u32 s91, s91, 40960
    s_mov_b32 m0, s90
    s_add_u32 s90, s90, 5120
    buffer_load_dwordx4 v245, s[40:43], s91 offen lds
    s_add_u32 s91, s91, 40960
    s_mov_b32 m0, s90
    s_add_u32 s90, s90, 5120
    buffer_load_dwordx4 v245, s[40:43], s91 offen lds
    s_add_u32 s91, s91, 40960
    s_mov_b32 m0, s90
    s_add_u32 s90, s90, 5120
    buffer_load_dwordx4 v245, s[40:43], s91 offen lds
    s_add_u32 s91, s91, 40960
L_q_wa2:
    v_and_b32 v2, 15, v0
    v_lshrrev_b32 v3, 4, v0
    v_lshrrev_b32 v4, 2, v0
    v_and_b32 v5, 3, v0
    v_lshl_add_u32 v4, v5, 2, v4
    v_and_b32 v4, 15, v4
    v_lshl_add_u32 v4, v5, 4, v4
    v_lshlrev_b32 v251, 4, v4
    s_and_b32 s62, s52, 3
    s_lshl_b32 s62, s62, 10
    v_lshl_add_u32 v252, v0, 3, s62
    s_and_b32 s62, s52, 3
    s_mul_i32 s63, s62, 2560
    s_add_u32 s63, s63, 152320
    v_mul_u32_u24 v2, 160, v2
    v_add_u32 v2, s63, v2
    v_and_b32 v3, 1, v3
    v_mul_u32_u24 v3, 40, v3
    v_add_u32 v2, v2, v3
    v_lshrrev_b32 v3, 5, v0
    v_lshl_add_u32 v224, v3, 4, v2
    v_mul_u32_u24 v3, 80, v3
    v_add_u32 v225, v2, v3
    s_lshl_b32 s62, s52, 2
    s_add_u32 s62, s62, 162560
    v_mov_b32 v248, s62
    v_and_b32 v2, 7, v0
    v_lshlrev_b32 v2, 2, v2
    v_add_u32 v249, 162560, v2
    s_waitcnt lgkmcnt(0)
    s_mul_i32 s57, s57, 0x9E3779B1
    s_add_u32 s57, s57, 0x7F4A7C15
    v_mov_b32 v15, s57
    v_lshrrev_b32 v6, 4, v0
    v_lshlrev_b32 v6, 3, v6
    v_bfe_u32 v7, v0, 2, 2
    v_add_u32 v6, v6, v7
    v_mul_u32_u24 v6, 40, v6
    v_and_b32 v7, 3, v0
    v_lshl_add_u32 v6, v7, 3, v6
    s_lshl_b32 s62, s52, 4
    s_add_u32 s62, s62, 102400
    v_add_u32 v6, s62, v6
    s_bitcmp1_b32 s52, 0
    s_cbranch_scc1 L_q_wb1
    s_waitcnt vmcnt(21)
    s_branch L_q_wb2
L_q_wb1:
    s_waitcnt vmcnt(19)
L_q_wb2:
    s_mov_b64 exec, 1
    ds_write_b32 v248, v15 offset:0
    s_mov_b64 exec, -1
    s_setprio 0
    s_bitcmp1_b32 s52, 0
    s_cbranch_scc1 L_q_odd
    s_mov_b32 s69, 0
L_ev_1:
    ds_read_b32 v2, v249 offset:0
    s_add_u32 s69, s69, 1
    s_waitcnt lgkmcnt(0)
    v_cmp_eq_u32 vcc, v2, v15
    s_cmp_ge_u32 s69, 1000000
    s_cbranch_scc1 L_evd_1
    s_nop 1
    s_and_b32 s62, vcc_lo, 15
    s_cmp_eq_u32 s62, 15
    s_cbranch_scc1 L_evd_1
    s_sleep 1
    s_branch L_ev_1
L_evd_1:
    s_lshr_b32 s62, s56, 1
    s_lshl_b32 s62, s62, 11
    s_add_u32 s63, s62, 40960
    v_add_u32 v2, s62, v246
    v_add_u32 v3, s62, v247
    v_add_u32 v4, s63, v246
    v_add_u32 v5, s63, v247
    ds_read_b128 v[32:35], v2 offset:0
    ds_read_b128 v[36:39], v3 offset:0
    ds_read_b128 v[40:43], v2 offset:8192
    ds_read_b128 v[44:47], v3 offset:8192
    ds_read_b128 v[48:51], v2 offset:16384
    ds_read_b128 v[52:55], v3 offset:16384
    ds_read_b128 v[56:59], v2 offset:24576
    ds_read_b128 v[60:63], v3 offset:24576
    ds_read_b128 v[64:67], v2 offset:32768
    ds_read_b128 v[68:71], v3 offset:32768
    ds_read_b128 v[72:75], v4 offset:0
    ds_read_b128 v[76:79], v5 offset:0
    ds_read_b128 v[80:83], v4 offset:8192
    ds_read_b128 v[84:87], v5 offset:8192
    ds_read_b128 v[88:91], v4 offset:16384
    ds_read_b128 v[92:95], v5 offset:16384
    ds_read_b128 v[16:19], v4 offset:24576
    ds_read_b128 v[20:23], v5 offset:24576
    ds_read_b128 v[24:27], v4 offset:32768
    ds_read_b128 v[28:31], v5 offset:32768
    s_bitcmp1_b32 s56, 0
    s_cbranch_scc1 L_kv_v
    ds_read_b64_tr_b16 v[176:177], v6 offset:0
    ds_read_b64_tr_b16 v[178:179], v6 offset:160
    ds_read_b64_tr_b16 v[180:181], v6 offset:1280
    ds_read_b64_tr_b16 v[182:183], v6 offset:1440
    ds_read_b64_tr_b16 v[184:185], v6 offset:2560
    ds_read_b64_tr_b16 v[186:187], v6 offset:2720
    ds_read_b64_tr_b16 v[188:189], v6 offset:3840
    ds_read_b64_tr_b16 v[190:191], v6 offset:4000
    s_waitcnt lgkmcnt(6)
    v_mfma_f32_16x16x32_bf16 v[200:203], v[176:179], v[32:35], 0
    ds_read_b64_tr_b16 v[176:177], v6 offset:5120
    ds_read_b64_tr_b16 v[178:179], v6 offset:5280
    s_waitcnt lgkmcnt(6)
    v_mfma_f32_16x16x32_bf16 v[200:203], v[180:183], v[36:39], v[200:203]
    ds_read_b64_tr_b16 v[180:181], v6 offset:6400
    ds_read_b64_tr_b16 v[182:183], v6 offset:6560
    s_waitcnt lgkmcnt(6)
    v_mfma_f32_16x16x32_bf16 v[200:203], v[184:187], v[40:43], v[200:203]
    ds_read_b64_tr_b16 v[184:185], v6 offset:7680
    ds_read_b64_tr_b16 v[186:187], v6 offset:7840
    s_waitcnt lgkmcnt(6)
    v_mfma_f32_16x16x32_bf16 v[200:203], v[188:191], v[44:47], v[200:203]
    ds_read_b64_tr_b16 v[188:189], v6 offset:8960
    ds_read_b64_tr_b16 v[190:191], v6 offset:9120
    s_waitcnt lgkmcnt(6)
    v_mfma_f32_16x16x32_bf16 v[200:203], v[176:179], v[48:51], v[200:203]
    ds_read_b64_tr_b16 v[176:177], v6 offset:10240
    ds_read_b64_tr_b16 v[178:179], v6 offset:10400
    s_waitcnt lgkmcnt(6)
    v_mfma_f32_16x16x32_bf16 v[200:203], v[180:183], v[52:55], v[200:203]
    ds_read_b64_tr_b16 v[180:181], v6 offset:11520
    ds_read_b64_tr_b16 v[182:183], v6 offset:11680
    s_waitcnt lgkmcnt(6)
    v_mfma_f32_16x16x32_bf16 v[200:203], v[184:187], v[56:59], v[200:203]
    ds_read_b64_tr_b16 v[184:185], v6 offset:12800
    ds_read_b64_tr_b16 v[186:187], v6 offset:12960
    s_waitcnt lgkmcnt(6)
    v_mfma_f32_16x16x32_bf16 v[200:203], v[188:191], v[60:63], v[200:203]
    ds_read_b64_tr_b16 v[188:189], v6 offset:14080
    ds_read_b64_tr_b16 v[190:191], v6 offset:14240
    s_waitcnt lgkmcnt(6)
    v_mfma_f32_16x16x32_bf16 v[200:203], v[176:179], v[64:67], v[200:203]
    ds_read_b64_tr_b16 v[176:177], v6 offset:15360
    ds_read_b64_tr_b16 v[178:179], v6 offset:15520
    s_waitcnt lgkmcnt(6)
    v_mfma_f32_16x16x32_bf16 v[200:203], v[180:183], v[68:71], v[200:203]
    ds_read_b64_tr_b16 v[180:181], v6 offset:16640
    ds_read_b64_tr_b16 v[182:183], v6 offset:16800
    s_waitcnt lgkmcnt(6)
    v_mfma_f32_16x16x32_bf16 v[200:203], v[184:187], v[72:75], v[200:203]
    ds_read_b64_tr_b16 v[184:185], v6 offset:17920
    ds_read_b64_tr_b16 v[186:187], v6 offset:18080
    s_waitcnt lgkmcnt(6)
    v_mfma_f32_16x16x32_bf16 v[200:203], v[188:191], v[76:79], v[200:203]
    ds_read_b64_tr_b16 v[188:189], v6 offset:19200
    ds_read_b64_tr_b16 v[190:191], v6 offset:19360
    s_waitcnt lgkmcnt(6)
    v_mfma_f32_16x16x32_bf16 v[200:203], v[176:179], v[80:83], v[200:203]
    ds_read_b64_tr_b16 v[176:177], v6 offset:20480
    ds_read_b64_tr_b16 v[178:179], v6 offset:20640
    s_waitcnt lgkmcnt(6)
    v_mfma_f32_16x16x32_bf16 v[200:203], v[180:183], v[84:87], v[200:203]
    ds_read_b64_tr_b16 v[180:181], v6 offset:21760
    ds_read_b64_tr_b16 v[182:183], v6 offset:21920
    s_waitcnt lgkmcnt(6)
    v_mfma_f32_16x16x32_bf16 v[200:203], v[184:187], v[88:91], v[200:203]
    ds_read_b64_tr_b16 v[184:185], v6 offset:23040
    ds_read_b64_tr_b16 v[186:187], v6 offset:23200
    s_waitcnt lgkmcnt(6)
    v_mfma_f32_16x16x32_bf16 v[200:203], v[188:191], v[92:95], v[200:203]
    ds_read_b64_tr_b16 v[188:189], v6 offset:24320
    ds_read_b64_tr_b16 v[190:191], v6 offset:24480
    s_waitcnt lgkmcnt(6)
    v_mfma_f32_16x16x32_bf16 v[200:203], v[176:179], v[16:19], v[200:203]
    s_waitcnt lgkmcnt(4)
    v_mfma_f32_16x16x32_bf16 v[200:203], v[180:183], v[20:23], v[200:203]
    s_waitcnt lgkmcnt(2)
    v_mfma_f32_16x16x32_bf16 v[200:203], v[184:187], v[24:27], v[200:203]
    s_waitcnt lgkmcnt(0)
    v_mfma_f32_16x16x32_bf16 v[200:203], v[188:191], v[28:31], v[200:203]
    s_mov_b64 exec, 1
    ds_write_b32 v248, v15 offset:224
    s_mov_b64 exec, -1
    s_mul_i32 s62, s55, 5120
    s_add_u32 s62, s62, 65536
    s_lshr_b32 s65, s56, 1
    v_and_b32 v3, 15, v0
    v_lshrrev_b32 v4, 4, v0
    s_lshr_b32 s63, s65, 1
    s_lshl_b32 s63, s63, 10
    s_and_b32 s64, s65, 1
    s_lshl_b32 s64, s64, 8
    s_add_u32 s63, s63, s64
    s_add_u32 s63, s63, s62
    v_lshrrev_b32 v5, 1, v4
    v_lshlrev_b32 v5, 9, v5
    v_lshl_add_u32 v5, v3, 4, v5
    v_and_b32 v6, 1, v4
    v_lshl_add_u32 v5, v6, 3, v5
    s_lshl_b32 s64, s65, 7
    s_add_u32 s64, s64, s62
    s_add_u32 s64, s64, 2048
    v_lshlrev_b32 v6, 3, v3
    v_cmp_gt_u32 vcc, 16, v0
    s_mov_b32 s65, 0x3ea52b5c
    v_cvt_pk_bf16_f32 v200, v200, v201
    v_cvt_pk_bf16_f32 v202, v202, v203
    v_and_b32 v201, 0xffff0000, v200
    v_lshlrev_b32 v200, 16, v200
    v_and_b32 v203, 0xffff0000, v202
    v_lshlrev_b32 v202, 16, v202
    v_mul_f32 v200, s65, v200
    v_mul_f32 v201, s65, v201
    v_mul_f32 v202, s65, v202
    v_mul_f32 v203, s65, v203
    s_branch L_kv_st
L_kv_v:
    ds_read_b64_tr_b16 v[176:177], v6 offset:0
    ds_read_b64_tr_b16 v[178:179], v6 offset:160
    ds_read_b64_tr_b16 v[180:181], v6 offset:1280
    ds_read_b64_tr_b16 v[182:183], v6 offset:1440
    ds_read_b64_tr_b16 v[184:185], v6 offset:2560
    ds_read_b64_tr_b16 v[186:187], v6 offset:2720
    ds_read_b64_tr_b16 v[188:189], v6 offset:3840
    ds_read_b64_tr_b16 v[190:191], v6 offset:4000
    s_waitcnt lgkmcnt(6)
    v_mfma_f32_16x16x32_bf16 v[200:203], v[32:35], v[176:179], 0
    ds_read_b64_tr_b16 v[176:177], v6 offset:5120
    ds_read_b64_tr_b16 v[178:179], v6 offset:5280
    s_waitcnt lgkmcnt(6)
    v_mfma_f32_16x16x32_bf16 v[200:203], v[36:39], v[180:183], v[200:203]
    ds_read_b64_tr_b16 v[180:181], v6 offset:6400
    ds_read_b64_tr_b16 v[182:183], v6 offset:6560
    s_waitcnt lgkmcnt(6)
    v_mfma_f32_16x16x32_bf16 v[200:203], v[40:43], v[184:187], v[200:203]
    ds_read_b64_tr_b16 v[184:185], v6 offset:7680
    ds_read_b64_tr_b16 v[186:187], v6 offset:7840
    s_waitcnt lgkmcnt(6)
    v_mfma_f32_16x16x32_bf16 v[200:203], v[44:47], v[188:191], v[200:203]
    ds_read_b64_tr_b16 v[188:189], v6 offset:8960
    ds_read_b64_tr_b16 v[190:191], v6 offset:9120
    s_waitcnt lgkmcnt(6)
    v_mfma_f32_16x16x32_bf16 v[200:203], v[48:51], v[176:179], v[200:203]
    ds_read_b64_tr_b16 v[176:177], v6 offset:10240
    ds_read_b64_tr_b16 v[178:179], v6 offset:10400
    s_waitcnt lgkmcnt(6)
    v_mfma_f32_16x16x32_bf16 v[200:203], v[52:55], v[180:183], v[200:203]
    ds_read_b64_tr_b16 v[180:181], v6 offset:11520
    ds_read_b64_tr_b16 v[182:183], v6 offset:11680
    s_waitcnt lgkmcnt(6)
    v_mfma_f32_16x16x32_bf16 v[200:203], v[56:59], v[184:187], v[200:203]
    ds_read_b64_tr_b16 v[184:185], v6 offset:12800
    ds_read_b64_tr_b16 v[186:187], v6 offset:12960
    s_waitcnt lgkmcnt(6)
    v_mfma_f32_16x16x32_bf16 v[200:203], v[60:63], v[188:191], v[200:203]
    ds_read_b64_tr_b16 v[188:189], v6 offset:14080
    ds_read_b64_tr_b16 v[190:191], v6 offset:14240
    s_waitcnt lgkmcnt(6)
    v_mfma_f32_16x16x32_bf16 v[200:203], v[64:67], v[176:179], v[200:203]
    ds_read_b64_tr_b16 v[176:177], v6 offset:15360
    ds_read_b64_tr_b16 v[178:179], v6 offset:15520
    s_waitcnt lgkmcnt(6)
    v_mfma_f32_16x16x32_bf16 v[200:203], v[68:71], v[180:183], v[200:203]
    ds_read_b64_tr_b16 v[180:181], v6 offset:16640
    ds_read_b64_tr_b16 v[182:183], v6 offset:16800
    s_waitcnt lgkmcnt(6)
    v_mfma_f32_16x16x32_bf16 v[200:203], v[72:75], v[184:187], v[200:203]
    ds_read_b64_tr_b16 v[184:185], v6 offset:17920
    ds_read_b64_tr_b16 v[186:187], v6 offset:18080
    s_waitcnt lgkmcnt(6)
    v_mfma_f32_16x16x32_bf16 v[200:203], v[76:79], v[188:191], v[200:203]
    ds_read_b64_tr_b16 v[188:189], v6 offset:19200
    ds_read_b64_tr_b16 v[190:191], v6 offset:19360
    s_waitcnt lgkmcnt(6)
    v_mfma_f32_16x16x32_bf16 v[200:203], v[80:83], v[176:179], v[200:203]
    ds_read_b64_tr_b16 v[176:177], v6 offset:20480
    ds_read_b64_tr_b16 v[178:179], v6 offset:20640
    s_waitcnt lgkmcnt(6)
    v_mfma_f32_16x16x32_bf16 v[200:203], v[84:87], v[180:183], v[200:203]
    ds_read_b64_tr_b16 v[180:181], v6 offset:21760
    ds_read_b64_tr_b16 v[182:183], v6 offset:21920
    s_waitcnt lgkmcnt(6)
    v_mfma_f32_16x16x32_bf16 v[200:203], v[88:91], v[184:187], v[200:203]
    ds_read_b64_tr_b16 v[184:185], v6 offset:23040
    ds_read_b64_tr_b16 v[186:187], v6 offset:23200
    s_waitcnt lgkmcnt(6)
    v_mfma_f32_16x16x32_bf16 v[200:203], v[92:95], v[188:191], v[200:203]
    ds_read_b64_tr_b16 v[188:189], v6 offset:24320
    ds_read_b64_tr_b16 v[190:191], v6 offset:24480
    s_waitcnt lgkmcnt(6)
    v_mfma_f32_16x16x32_bf16 v[200:203], v[16:19], v[176:179], v[200:203]
    s_waitcnt lgkmcnt(4)
    v_mfma_f32_16x16x32_bf16 v[200:203], v[20:23], v[180:183], v[200:203]
    s_waitcnt lgkmcnt(2)
    v_mfma_f32_16x16x32_bf16 v[200:203], v[24:27], v[184:187], v[200:203]
    s_waitcnt lgkmcnt(0)
    v_mfma_f32_16x16x32_bf16 v[200:203], v[28:31], v[188:191], v[200:203]
    s_mov_b64 exec, 1
    ds_write_b32 v248, v15 offset:224
    s_mov_b64 exec, -1
    s_mul_i32 s62, s55, 5120
    s_add_u32 s62, s62, 65536
    s_lshr_b32 s65, s56, 1
    v_and_b32 v3, 15, v0
    v_lshrrev_b32 v4, 4, v0
    s_mul_i32 s63, s65, 640
    s_add_u32 s63, s63, s62
    s_add_u32 s63, s63, 2560
    s_add_u32 s64, s63, 256
    v_lshrrev_b32 v5, 1, v4
    v_mul_u32_u24 v5, 320, v5
    v_lshl_add_u32 v5, v3, 4, v5
    v_and_b32 v6, 1, v4
    v_lshl_add_u32 v5, v6, 3, v5
    v_mov_b32 v6, v5
    v_cmp_gt_u32 vcc, 4, v3
L_kv_st:
    v_cvt_pk_bf16_f32 v208, v200, v201
    v_cvt_pk_bf16_f32 v209, v202, v203
    s_cmp_lg_u32 s52, 0
    s_cbranch_scc1 L_kv_st1
    buffer_store_dwordx2 v[208:209], v5, s[44:47], s63 offen sc1
    s_branch L_kv_done
L_kv_st1:
    s_and_saveexec_b64 s[74:75], vcc
    buffer_store_dwordx2 v[208:209], v6, s[44:47], s64 offen sc1
    s_mov_b64 exec, s[74:75]
L_kv_done:
    s_waitcnt vmcnt(7)
    s_mov_b64 exec, 1
    ds_write_b32 v248, v15 offset:32
    s_mov_b64 exec, -1
    s_branch L_q_tail
L_q_odd:
    s_waitcnt vmcnt(4)
    s_mov_b64 exec, 1
    ds_write_b32 v248, v15 offset:32
    s_mov_b64 exec, -1
L_q_tail:
    s_setprio 0
    v_lshrrev_b32 v231, 5, v0
    v_lshlrev_b32 v231, 4, v231
    v_bfe_u32 v4, v0, 4, 1
    v_lshl_add_u32 v231, v4, 2, v231
    v_bfe_u32 v4, v0, 2, 2
    v_add_u32 v231, v231, v4
    v_mul_u32_u24 v231, 160, v231
    v_and_b32 v4, 3, v0
    v_lshl_add_u32 v231, v4, 3, v231
    s_mul_i32 s62, s71, 51200
    v_add_u32 v231, s62, v231
    v_and_b32 v4, 3, v0
    v_lshrrev_b32 v5, 4, v0
    v_lshl_add_u32 v4, v5, 2, v4
    v_lshrrev_b32 v5, 1, v4
    v_lshlrev_b32 v5, 3, v5
    v_bfe_u32 v226, v0, 2, 2
    v_add_u32 v5, v5, v226
    v_lshlrev_b32 v5, 7, v5
    v_and_b32 v4, 1, v4
    v_lshl_add_u32 v5, v4, 3, v5
    s_lshl_b32 s62, s52, 4
    s_add_u32 s62, s62, 102400
    v_add_u32 v226, s62, v5
    v_lshrrev_b32 v4, 2, v0
    v_and_b32 v5, 1, v4
    v_and_b32 v227, 3, v0
    v_lshl_add_u32 v5, v5, 2, v227
    v_mul_u32_u24 v5, 160, v5
    v_lshrrev_b32 v4, 1, v4
    v_lshl_add_u32 v5, v4, 4, v5
    s_mul_i32 s62, s52, 1280
    s_add_u32 s62, s62, 112640
    v_add_u32 v227, s62, v5
    v_add_u32 v228, s62, v1
    v_add_u32 v4, 0, v0
    v_mul_u32_u24 v5, 6554, v4
    v_lshrrev_b32 v5, 16, v5
    v_mul_u32_u24 v229, 10, v5
    v_sub_u32 v4, v4, v229
    v_mul_u32_u24 v5, 2560, v5
    v_lshl_add_u32 v229, v4, 4, v5
    v_add_u32 v4, 64, v0
    v_mul_u32_u24 v5, 6554, v4
    v_lshrrev_b32 v5, 16, v5
    v_mul_u32_u24 v230, 10, v5
    v_sub_u32 v4, v4, v230
    v_mul_u32_u24 v5, 2560, v5
    v_lshl_add_u32 v230, v4, 4, v5
    s_mul_i32 s62, s52, 1536
    s_add_u32 s62, s62, 147456
    v_and_b32 v4, 15, v0
    v_mul_u32_u24 v4, 80, v4
    v_bfe_u32 v5, v0, 4, 1
    v_mul_u32_u24 v5, 40, v5
    v_add3_u32 v5, v4, v5, s62
    v_lshrrev_b32 v232, 5, v0
    v_lshl_add_u32 v232, v232, 3, v5
    v_lshrrev_b32 v5, 4, v0
    v_lshl_add_u32 v4, v5, 4, v4
    v_add_u32 v233, s62, v4
    s_lshl_b32 s62, s56, 1
    s_add_u32 s62, s62, s71
    s_mul_i32 s62, s62, 1280
    s_lshl_b32 s64, s55, 2
    s_add_u32 s64, s64, s70
    s_mul_i32 s64, s64, 20480
    s_add_u32 s62, s62, s64
    s_add_u32 s62, s62, 5505024
    v_add_u32 v234, s62, v1
    s_mul_i32 s62, s52, 3072
    s_add_u32 s62, s62, 122880
    v_add_u32 v235, s62, v1
    s_xor_b32 s62, s52, 4
    s_mul_i32 s62, s62, 3072
    s_add_u32 s62, s62, 122880
    v_add_u32 v236, s62, v1
    v_lshrrev_b32 v4, 3, v0
    v_lshlrev_b32 v4, 12, v4
    v_and_b32 v5, 7, v0
    v_lshl_add_u32 v240, v5, 4, v4
    s_lshl_b32 s62, s55, 8
    s_add_u32 s62, s62, 24576
    v_lshl_add_u32 v241, v0, 2, s62
    s_mul_i32 s62, s52, 1536
    s_add_u32 s62, s62, 147456
    v_and_b32 v4, 15, v0
    s_mul_i32 s65, s71, 32
    s_sub_u32 s65, 96, s65
    v_mul_u32_u24 v4, s65, v4
    v_lshrrev_b32 v5, 4, v0
    v_lshl_add_u32 v4, v5, 3, v4
    v_add_u32 v237, s62, v4
    s_cmp_eq_u32 s71, 0
    s_cbranch_scc0 L_ta_hi_q
    v_mul_u32_u24 v4, 10923, v0
    v_lshrrev_b32 v4, 16, v4
    v_mul_u32_u24 v5, 6, v4
    v_sub_u32 v5, v0, v5
    v_mul_u32_u24 v4, 2560, v4
    v_lshl_add_u32 v238, v5, 4, v4
    v_add_u32 v5, 64, v0
    v_mul_u32_u24 v4, 10923, v5
    v_lshrrev_b32 v4, 16, v4
    v_mul_u32_u24 v239, 6, v4
    v_sub_u32 v5, v5, v239
    v_mul_u32_u24 v4, 2560, v4
    v_lshl_add_u32 v239, v5, 4, v4
    s_branch L_ta_done_q
L_ta_hi_q:
    v_lshrrev_b32 v4, 2, v0
    v_mul_u32_u24 v4, 2560, v4
    v_and_b32 v5, 3, v0
    v_lshl_add_u32 v4, v5, 4, v4
    v_add_u32 v238, 96, v4
    v_mov_b32 v239, 0
L_ta_done_q:
    s_branch L_cut_q_main
L_kside:
    s_setprio 3
    s_cmp_eq_u32 s52, 4
    s_cbranch_scc1 L_k_u
    s_waitcnt lgkmcnt(0)
    s_load_dword s57, s[32:33], 0
    s_sub_u32 s64, s52, 5
    s_add_u32 s64, s64, s58
    s_cmp_eq_u32 s52, 7
    s_cselect_b32 s64, s59, s64
    s_lshl_b32 s65, s64, 8
    v_lshlrev_b32 v2, 2, v0
    s_mov_b32 s40, s16
    s_mov_b32 s41, s17
    s_mov_b32 s42, 163840
    s_mov_b32 s43, 0x00020000
    buffer_load_dword v56, v2, s[40:43], s65 offen
    s_mov_b32 s40, s18
    s_mov_b32 s41, s19
    s_mov_b32 s42, 163840
    s_mov_b32 s43, 0x00020000
    buffer_load_dword v57, v2, s[40:43], s65 offen
    s_mov_b32 s40, s20
    s_mov_b32 s41, s21
    s_mov_b32 s42, 163840
    s_mov_b32 s43, 0x00020000
    buffer_load_dword v58, v2, s[40:43], s65 offen
    s_mov_b32 s40, s22
    s_mov_b32 s41, s23
    s_mov_b32 s42, 163840
    s_mov_b32 s43, 0x00020000
    buffer_load_dword v59, v2, s[40:43], s65 offen
    s_lshl_b32 s65, s64, 1
    s_and_b32 s65, s65, 0xfffffffc
    s_load_dword s76, s[24:25], s65
    s_and_b32 s35, s64, 1
    s_lshl_b32 s35, s35, 4
    s_load_dword s77, s[26:27], s65
    s_setprio 3
L_k_nopf:
    s_mov_b32 s44, s32
    s_mov_b32 s45, s33
    s_mov_b32 s46, 16777216
    s_mov_b32 s47, 0x00020000
    s_call_b64 s[92:93], L_sub_kaddr
    s_mov_b32 s80, 0x3fb8aa3b
    s_mov_b32 s81, 0x32a57060
    s_mov_b32 s82, 0x3f317218
    s_mov_b32 s83, 0x3e22f983
    s_sub_u32 s64, s52, 5
    s_mul_i32 s65, s64, 4352
    s_add_u32 s65, s65, 128000
    v_lshl_add_u32 v8, v0, 2, s65
    v_add_u32 v9, 1088, v8
    v_add_u32 v10, 2176, v8
    v_add_u32 v11, 3264, v8
    v_and_b32 v4, 15, v0
    v_mul_u32_u24 v4, 272, v4
    v_lshrrev_b32 v5, 4, v0
    v_lshl_add_u32 v4, v5, 4, v4
    v_add_u32 v12, s65, v4
    s_lshr_b32 s76, s76, s35
    s_lshl_b32 s76, s76, 16
    v_mov_b32 v6, s76
    v_mul_f32 v4, s80, v6
    v_fma_f32 v5, v6, s80, -v4
    v_fma_f32 v5, v6, s81, v5
    v_exp_f32 v4, v4
    v_fma_f32 v5, v5, s82, 1.0
    v_mul_f32 v182, v4, v5
    v_cvt_pk_bf16_f32 v182, v182, v182
    v_lshlrev_b32 v182, 16, v182
    s_branch L_cut_k_gen
L_sub_kaddr:
    s_sub_u32 s64, s52, 4
    s_lshl_b32 s65, s64, 9
    s_sub_u32 s65, 2048, s65
    v_lshlrev_b32 v4, 3, v0
    v_sub_u32 v4, s65, v4
    v_cvt_f32_u32 v5, v4
    s_mov_b32 s66, 0x0001d508
    s_mov_b32 s67, 154376
    v_lshlrev_b32 v6, 1, v4
    v_add_u32 v6, 154120, v6
    v_subrev_f32 v66, 0x00000000, v5
    v_subrev_f32 v67, 0x3f800000, v5
    v_subrev_f32 v68, 0x40000000, v5
    v_subrev_f32 v69, 0x40400000, v5
    v_subrev_f32 v70, 0x40800000, v5
    v_subrev_f32 v71, 0x40a00000, v5
    v_subrev_f32 v72, 0x40c00000, v5
    v_subrev_f32 v73, 0x40e00000, v5
    v_subrev_f32 v74, 0x41000000, v5
    v_subrev_f32 v75, 0x41100000, v5
    v_max_f32 v75, 0, v75
    v_subrev_f32 v76, 0x41200000, v5
    v_max_f32 v76, 0, v76
    v_subrev_f32 v77, 0x41300000, v5
    v_max_f32 v77, 0, v77
    v_cvt_pk_bf16_f32 v60, v66, v67
    v_cvt_pk_bf16_f32 v61, v68, v69
    v_cvt_pk_bf16_f32 v62, v70, v71
    v_cvt_pk_bf16_f32 v63, v72, v73
    v_cvt_pk_bf16_f32 v64, v74, v75
    v_cvt_pk_bf16_f32 v65, v76, v77
    v_mad_u32_u16 v186, v60, 2, s66 op_sel:[0,0,0,0]
    v_subrev_u32 v66, 0, v6
    v_mad_u32_u16 v187, v60, 2, s66 op_sel:[1,0,0,0]
    v_subrev_u32 v67, 2, v6
    v_mad_u32_u16 v188, v61, 2, s66 op_sel:[0,0,0,0]
    v_subrev_u32 v68, 4, v6
    v_mad_u32_u16 v189, v61, 2, s66 op_sel:[1,0,0,0]
    v_subrev_u32 v69, 6, v6
    v_mad_u32_u16 v190, v62, 2, s66 op_sel:[0,0,0,0]
    v_subrev_u32 v70, 8, v6
    v_mad_u32_u16 v191, v62, 2, s66 op_sel:[1,0,0,0]
    v_subrev_u32 v71, 10, v6
    v_mad_u32_u16 v192, v63, 2, s66 op_sel:[0,0,0,0]
    v_subrev_u32 v72, 12, v6
    v_mad_u32_u16 v193, v63, 2, s66 op_sel:[1,0,0,0]
    v_subrev_u32 v73, 14, v6
    v_mad_u32_u16 v194, v64, 2, s66 op_sel:[0,0,0,0]
    v_subrev_u32 v74, 16, v6
    v_mad_u32_u16 v195, v64, 2, s66 op_sel:[1,0,0,0]
    v_subrev_u32 v75, 18, v6
    v_mad_u32_u16 v196, v65, 2, s66 op_sel:[0,0,0,0]
    v_subrev_u32 v76, 20, v6
    v_mad_u32_u16 v197, v65, 2, s66 op_sel:[1,0,0,0]
    v_subrev_u32 v77, 22, v6
    v_med3_i32 v186, v186, v66, s67
    v_med3_i32 v187, v187, v67, s67
    v_med3_i32 v188, v188, v68, s67
    v_med3_i32 v189, v189, v69, s67
    v_med3_i32 v190, v190, v70, s67
    v_med3_i32 v191, v191, v71, s67
    v_med3_i32 v192, v192, v72, s67
    v_med3_i32 v193, v193, v73, s67
    v_med3_i32 v194, v194, v74, s67
    v_med3_i32 v195, v195, v75, s67
    v_med3_i32 v196, v196, v76, s67
    v_med3_i32 v197, v197, v77, s67
    s_lshl_b32 s64, s52, 6
    v_add_u32 v2, s64, v0
    v_mul_u32_u24 v3, 6554, v2
    v_lshrrev_b32 v3, 16, v3
    v_mul_u32_u24 v4, 10, v3
    v_sub_u32 v2, v2, v4
    v_lshrrev_b32 v4, 2, v3
    v_lshrrev_b32 v5, 3, v3
    v_xor_b32 v4, v4, v5
    v_and_b32 v4, 1, v4
    v_mul_u32_u24 v4, 12, v4
    v_xor_b32 v3, v3, v4
    v_mul_u32_u24 v3, 1280, v3
    v_lshl_add_u32 v245, v2, 4, v3
    v_and_b32 v2, 15, v0
    v_lshrrev_b32 v3, 4, v0
    s_sub_u32 s62, s52, 4
    s_lshr_b32 s63, s62, 1
    s_and_b32 s64, s62, 1
    s_lshl_b32 s64, s64, 8
    s_mul_i32 s66, s63, 16640
    s_sub_u32 s66, s66, s64
    s_add_u32 s66, s66, 102688
    s_mul_i32 s68, s63, 4608
    s_sub_u32 s68, s68, s64
    s_add_u32 s68, s68, 86816
    s_lshl_b32 s64, s62, 7
    s_sub_u32 s63, 135968, s64
    s_sub_u32 s64, 82208, s64
    v_sub_u32 v4, 0, v2
    v_and_b32 v4, 3, v4
    v_add_u32 v5, v2, v4
    v_mul_u32_u24 v4, 4160, v4
    v_lshlrev_b32 v5, 1, v5
    v_sub_u32 v4, v4, v5
    v_lshl_add_u32 v4, v3, 4, v4
    v_add_u32 v242, s66, v4
    v_add_u32 v246, s63, v4
    v_lshlrev_b32 v5, 5, v2
    v_lshl_add_u32 v5, v3, 4, v5
    v_add_u32 v243, s68, v5
    v_add_u32 v247, s64, v5
    v_lshl_add_u32 v4, v3, 2, v2
    v_and_b32 v4, 15, v4
    v_lshl_add_u32 v4, v3, 4, v4
    v_lshlrev_b32 v244, 4, v4
    v_lshrrev_b32 v4, 2, v0
    v_and_b32 v5, 3, v0
    v_lshl_add_u32 v4, v5, 2, v4
    v_and_b32 v4, 15, v4
    v_lshl_add_u32 v4, v5, 4, v4
    v_lshlrev_b32 v251, 4, v4
    s_and_b32 s62, s52, 3
    s_lshl_b32 s62, s62, 10
    v_lshl_add_u32 v252, v0, 3, s62
    s_and_b32 s62, s52, 3
    s_mul_i32 s63, s62, 2560
    s_add_u32 s63, s63, 152320
    v_mul_u32_u24 v2, 160, v2
    v_add_u32 v2, s63, v2
    v_and_b32 v3, 1, v3
    v_mul_u32_u24 v3, 40, v3
    v_add_u32 v2, v2, v3
    v_lshrrev_b32 v3, 5, v0
    v_lshl_add_u32 v224, v3, 4, v2
    v_mul_u32_u24 v3, 80, v3
    v_add_u32 v225, v2, v3
    s_lshl_b32 s62, s52, 2
    s_add_u32 s62, s62, 162560
    v_mov_b32 v248, s62
    v_and_b32 v2, 7, v0
    v_lshlrev_b32 v2, 2, v2
    v_add_u32 v249, 162560, v2
    v_lshrrev_b32 v231, 5, v0
    v_lshlrev_b32 v231, 4, v231
    v_bfe_u32 v4, v0, 4, 1
    v_lshl_add_u32 v231, v4, 2, v231
    v_bfe_u32 v4, v0, 2, 2
    v_add_u32 v231, v231, v4
    v_mul_u32_u24 v231, 160, v231
    v_and_b32 v4, 3, v0
    v_lshl_add_u32 v231, v4, 3, v231
    s_mul_i32 s62, s71, 51200
    v_add_u32 v231, s62, v231
    v_and_b32 v4, 3, v0
    v_lshrrev_b32 v5, 4, v0
    v_lshl_add_u32 v4, v5, 2, v4
    v_lshrrev_b32 v5, 1, v4
    v_lshlrev_b32 v5, 3, v5
    v_bfe_u32 v226, v0, 2, 2
    v_add_u32 v5, v5, v226
    v_lshlrev_b32 v5, 7, v5
    v_and_b32 v4, 1, v4
    v_lshl_add_u32 v5, v4, 3, v5
    s_lshl_b32 s62, s52, 4
    s_add_u32 s62, s62, 102400
    v_add_u32 v226, s62, v5
    v_lshrrev_b32 v4, 2, v0
    v_and_b32 v5, 1, v4
    v_and_b32 v227, 3, v0
    v_lshl_add_u32 v5, v5, 2, v227
    v_mul_u32_u24 v5, 160, v5
    v_lshrrev_b32 v4, 1, v4
    v_lshl_add_u32 v5, v4, 4, v5
    s_mul_i32 s62, s52, 1280
    s_add_u32 s62, s62, 112640
    v_add_u32 v227, s62, v5
    v_add_u32 v228, s62, v1
    v_add_u32 v4, 0, v0
    v_mul_u32_u24 v5, 6554, v4
    v_lshrrev_b32 v5, 16, v5
    v_mul_u32_u24 v229, 10, v5
    v_sub_u32 v4, v4, v229
    v_mul_u32_u24 v5, 2560, v5
    v_lshl_add_u32 v229, v4, 4, v5
    v_add_u32 v4, 64, v0
    v_mul_u32_u24 v5, 6554, v4
    v_lshrrev_b32 v5, 16, v5
    v_mul_u32_u24 v230, 10, v5
    v_sub_u32 v4, v4, v230
    v_mul_u32_u24 v5, 2560, v5
    v_lshl_add_u32 v230, v4, 4, v5
    s_mul_i32 s62, s52, 1536
    s_add_u32 s62, s62, 147456
    v_and_b32 v4, 15, v0
    v_mul_u32_u24 v4, 80, v4
    v_bfe_u32 v5, v0, 4, 1
    v_mul_u32_u24 v5, 40, v5
    v_add3_u32 v5, v4, v5, s62
    v_lshrrev_b32 v232, 5, v0
    v_lshl_add_u32 v232, v232, 3, v5
    v_lshrrev_b32 v5, 4, v0
    v_lshl_add_u32 v4, v5, 4, v4
    v_add_u32 v233, s62, v4
    s_lshl_b32 s62, s56, 1
    s_add_u32 s62, s62, s71
    s_mul_i32 s62, s62, 1280
    s_lshl_b32 s64, s55, 2
    s_add_u32 s64, s64, s70
    s_mul_i32 s64, s64, 20480
    s_add_u32 s62, s62, s64
    s_add_u32 s62, s62, 5505024
    v_add_u32 v234, s62, v1
    s_mul_i32 s62, s52, 3072
    s_add_u32 s62, s62, 122880
    v_add_u32 v235, s62, v1
    s_xor_b32 s62, s52, 4
    s_mul_i32 s62, s62, 3072
    s_add_u32 s62, s62, 122880
    v_add_u32 v236, s62, v1
    v_lshrrev_b32 v4, 3, v0
    v_lshlrev_b32 v4, 12, v4
    v_and_b32 v5, 7, v0
    v_lshl_add_u32 v240, v5, 4, v4
    s_lshl_b32 s62, s55, 8
    s_add_u32 s62, s62, 24576
    v_lshl_add_u32 v241, v0, 2, s62
    s_mul_i32 s62, s52, 1536
    s_add_u32 s62, s62, 147456
    v_and_b32 v4, 15, v0
    s_mul_i32 s65, s71, 32
    s_sub_u32 s65, 96, s65
    v_mul_u32_u24 v4, s65, v4
    v_lshrrev_b32 v5, 4, v0
    v_lshl_add_u32 v4, v5, 3, v4
    v_add_u32 v237, s62, v4
    s_cmp_eq_u32 s71, 0
    s_cbranch_scc0 L_ta_hi_k
    v_mul_u32_u24 v4, 10923, v0
    v_lshrrev_b32 v4, 16, v4
    v_mul_u32_u24 v5, 6, v4
    v_sub_u32 v5, v0, v5
    v_mul_u32_u24 v4, 2560, v4
    v_lshl_add_u32 v238, v5, 4, v4
    v_add_u32 v5, 64, v0
    v_mul_u32_u24 v4, 10923, v5
    v_lshrrev_b32 v4, 16, v4
    v_mul_u32_u24 v239, 6, v4
    v_sub_u32 v5, v5, v239
    v_mul_u32_u24 v4, 2560, v4
    v_lshl_add_u32 v239, v5, 4, v4
    s_branch L_ta_done_k
L_ta_hi_k:
    v_lshrrev_b32 v4, 2, v0
    v_mul_u32_u24 v4, 2560, v4
    v_and_b32 v5, 3, v0
    v_lshl_add_u32 v4, v5, 4, v4
    v_add_u32 v238, 96, v4
    v_mov_b32 v239, 0
L_ta_done_k:
    s_mul_i32 s62, s71, 5120
    v_add_u32 v153, s62, v1
    v_lshl_add_u32 v154, v0, 3, s62
    v_and_b32 v2, 31, v0
    v_lshrrev_b32 v3, 5, v0
    v_mul_u32_u24 v3, 320, v3
    v_lshl_add_u32 v2, v2, 4, v3
    v_add_u32 v155, s62, v2
    v_mov_b32 v152, 0xdddd
    v_mov_b32 v144, 0
    v_mov_b32 v145, 0
    v_mov_b32 v146, 0
    v_mov_b32 v147, 0
    v_mov_b32 v148, 0
    v_mov_b32 v149, 0
    v_mov_b32 v150, 0
    v_mov_b32 v151, 0
    s_mov_b32 exec_lo, 0x00100000
    s_mov_b32 exec_hi, 0x00100000
    v_mov_b32 v144, 0x3f803f80
    v_mov_b32 v145, 0x3f803f80
    v_mov_b32 v146, 0x3f803f80
    v_mov_b32 v147, 0x3f803f80
    v_mov_b32 v148, 0x3f803f80
    v_mov_b32 v149, 0x3f803f80
    v_mov_b32 v150, 0x3f803f80
    v_mov_b32 v151, 0x3f803f80
    s_mov_b64 exec, -1
    s_waitcnt lgkmcnt(0)
    s_cmp_eq_u32 s52, 4
    s_cbranch_scc1 L_fn_done_k
    s_mul_i32 s57, s57, 0x9E3779B1
    s_add_u32 s57, s57, 0x7F4A7C15
    v_mov_b32 v15, s57
L_fn_done_k:
    s_setpc_b64 s[92:93]
L_k_u:
    v_add_u32 v2, 0, v0
    v_mul_u32_u24 v3, 6554, v2
    v_lshrrev_b32 v3, 16, v3
    v_mul_u32_u24 v4, 10, v3
    v_sub_u32 v2, v2, v4
    v_mul_u32_u24 v3, 1280, v3
    v_lshl_add_u32 v8, v2, 4, v3
    v_add_u32 v2, 64, v0
    v_mul_u32_u24 v3, 6554, v2
    v_lshrrev_b32 v3, 16, v3
    v_mul_u32_u24 v4, 10, v3
    v_sub_u32 v2, v2, v4
    v_mul_u32_u24 v3, 1280, v3
    v_lshl_add_u32 v9, v2, 4, v3
    v_add_u32 v2, 128, v0
    v_mul_u32_u24 v3, 6554, v2
    v_lshrrev_b32 v3, 16, v3
    v_mul_u32_u24 v4, 10, v3
    v_sub_u32 v2, v2, v4
    v_mul_u32_u24 v3, 1280, v3
    v_lshl_add_u32 v10, v2, 4, v3
    v_add_u32 v2, 192, v0
    v_mul_u32_u24 v3, 6554, v2
    v_lshrrev_b32 v3, 16, v3
    v_mul_u32_u24 v4, 10, v3
    v_sub_u32 v2, v2, v4
    v_mul_u32_u24 v3, 1280, v3
    v_lshl_add_u32 v11, v2, 4, v3
    v_add_u32 v2, 256, v0
    v_mul_u32_u24 v3, 6554, v2
    v_lshrrev_b32 v3, 16, v3
    v_mul_u32_u24 v4, 10, v3
    v_sub_u32 v2, v2, v4
    v_mul_u32_u24 v3, 1280, v3
    v_lshl_add_u32 v12, v2, 4, v3
    s_waitcnt lgkmcnt(0)
    s_load_dword s57, s[32:33], 0
    s_mov_b32 s40, s14
    s_mov_b32 s41, s15
    s_mov_b32 s42, 2621440
    s_mov_b32 s43, 0x00020000
    s_mul_i32 s64, s54, 81920
    s_mul_i32 s65, s53, 160
    s_add_u32 s64, s64, s65
    s_add_u32 s65, s64, 40960
    s_mov_b32 m0, 141056
    s_nop 0
    buffer_load_dwordx4 v8, s[40:43], s64 offen  lds
    s_add_u32 m0, m0, 1024
    s_nop 0
    buffer_load_dwordx4 v9, s[40:43], s64 offen  lds
    s_add_u32 m0, m0, 1024
    s_nop 0
    buffer_load_dwordx4 v10, s[40:43], s64 offen  lds
    s_add_u32 m0, m0, 1024
    s_nop 0
    buffer_load_dwordx4 v11, s[40:43], s64 offen  lds
    s_add_u32 m0, m0, 1024
    s_nop 0
    buffer_load_dwordx4 v12, s[40:43], s64 offen  lds
    s_add_u32 m0, m0, 1024
    s_nop 0
    buffer_load_dwordx4 v8, s[40:43], s65 offen  lds
    s_add_u32 m0, m0, 1024
    s_nop 0
    buffer_load_dwordx4 v9, s[40:43], s65 offen  lds
    s_add_u32 m0, m0, 1024
    s_nop 0
    buffer_load_dwordx4 v10, s[40:43], s65 offen  lds
    s_add_u32 m0, m0, 1024
    s_nop 0
    buffer_load_dwordx4 v11, s[40:43], s65 offen  lds
    s_add_u32 m0, m0, 1024
    s_nop 0
    buffer_load_dwordx4 v12, s[40:43], s65 offen  lds
    s_mov_b32 s44, s32
    s_mov_b32 s45, s33
    s_mov_b32 s46, 16777216
    s_mov_b32 s47, 0x00020000
    s_lshl_b32 s62, s52, 2
    s_add_u32 s62, s62, 162560
    v_mov_b32 v248, s62
    v_and_b32 v2, 3, v0
    v_lshrrev_b32 v3, 4, v0
    v_lshl_add_u32 v2, v3, 2, v2
    v_and_b32 v3, 7, v2
    v_lshrrev_b32 v4, 3, v2
    v_bfe_u32 v5, v0, 2, 2
    v_lshl_add_u32 v5, v3, 3, v5
    v_mul_u32_u24 v5, 160, v5
    v_lshl_add_u32 v5, v4, 3, v5
    v_add_u32 v5, 141056, v5
    v_and_b32 v2, 3, v0
    v_lshl_add_u32 v6, v4, 2, v2
    v_bfe_u32 v3, v0, 2, 3
    v_xor_b32 v7, v3, v6
    v_lshlrev_b32 v6, 7, v6
    v_lshl_add_u32 v6, v7, 4, v6
    v_add_u32 v6, 141056, v6
    v_lshrrev_b32 v7, 3, v0
    v_and_b32 v3, 7, v0
    v_xor_b32 v3, v3, v7
    v_lshlrev_b32 v7, 12, v7
    v_lshl_add_u32 v7, v3, 4, v7
    v_add_u32 v8, 141056, v1
    s_mul_i32 s64, s53, 327680
    s_lshl_b32 s65, s54, 7
    s_add_u32 s64, s64, s65
    s_add_u32 s64, s64, 262144
    s_waitcnt lgkmcnt(0)
    s_mul_i32 s57, s57, 0x9E3779B1
    s_add_u32 s57, s57, 0x7F4A7C15
    v_mov_b32 v15, s57
    s_waitcnt vmcnt(0)
    ds_read_b64_tr_b16 v[60:61], v5 offset:0
    ds_read_b64_tr_b16 v[62:63], v5 offset:640
    ds_read_b64_tr_b16 v[64:65], v5 offset:16
    ds_read_b64_tr_b16 v[66:67], v5 offset:656
    ds_read_b64_tr_b16 v[68:69], v5 offset:32
    ds_read_b64_tr_b16 v[70:71], v5 offset:672
    ds_read_b64_tr_b16 v[72:73], v5 offset:48
    ds_read_b64_tr_b16 v[74:75], v5 offset:688
    ds_read_b64_tr_b16 v[76:77], v5 offset:64
    ds_read_b64_tr_b16 v[78:79], v5 offset:704
    ds_read_b64_tr_b16 v[80:81], v5 offset:80
    ds_read_b64_tr_b16 v[82:83], v5 offset:720
    ds_read_b64_tr_b16 v[84:85], v5 offset:96
    ds_read_b64_tr_b16 v[86:87], v5 offset:736
    ds_read_b64_tr_b16 v[88:89], v5 offset:112
    ds_read_b64_tr_b16 v[90:91], v5 offset:752
    ds_read_b64_tr_b16 v[92:93], v5 offset:128
    ds_read_b64_tr_b16 v[94:95], v5 offset:768
    ds_read_b64_tr_b16 v[96:97], v5 offset:144
    ds_read_b64_tr_b16 v[98:99], v5 offset:784
    s_waitcnt lgkmcnt(0)
    ds_write_b128 v6, v[60:63] offset:0
    ds_write_b128 v6, v[64:67] offset:1024
    ds_write_b128 v6, v[68:71] offset:2048
    ds_write_b128 v6, v[72:75] offset:3072
    ds_write_b128 v6, v[76:79] offset:4096
    ds_write_b128 v6, v[80:83] offset:5120
    ds_write_b128 v6, v[84:87] offset:6144
    ds_write_b128 v6, v[88:91] offset:7168
    ds_write_b128 v6, v[92:95] offset:8192
    ds_write_b128 v6, v[96:99] offset:9216
    ds_read_b128 v[100:103], v8 offset:0
    ds_read_b128 v[104:107], v8 offset:1024
    ds_read_b128 v[108:111], v8 offset:2048
    ds_read_b128 v[112:115], v8 offset:3072
    ds_read_b128 v[116:119], v8 offset:4096
    ds_read_b128 v[120:123], v8 offset:5120
    ds_read_b128 v[124:127], v8 offset:6144
    ds_read_b128 v[128:131], v8 offset:7168
    ds_read_b128 v[132:135], v8 offset:8192
    ds_read_b128 v[136:139], v8 offset:9216
    s_waitcnt lgkmcnt(9)
    buffer_store_dwordx4 v[100:103], v7, s[44:47], s64 offen sc1
    s_add_u32 s64, s64, 32768
    s_waitcnt lgkmcnt(8)
    buffer_store_dwordx4 v[104:107], v7, s[44:47], s64 offen sc1
    s_add_u32 s64, s64, 32768
    s_waitcnt lgkmcnt(7)
    buffer_store_dwordx4 v[108:111], v7, s[44:47], s64 offen sc1
    s_add_u32 s64, s64, 32768
    s_waitcnt lgkmcnt(6)
    buffer_store_dwordx4 v[112:115], v7, s[44:47], s64 offen sc1
    s_add_u32 s64, s64, 32768
    s_waitcnt lgkmcnt(5)
    buffer_store_dwordx4 v[116:119], v7, s[44:47], s64 offen sc1
    s_add_u32 s64, s64, 32768
    s_waitcnt lgkmcnt(4)
    buffer_store_dwordx4 v[120:123], v7, s[44:47], s64 offen sc1
    s_add_u32 s64, s64, 32768
    s_waitcnt lgkmcnt(3)
    buffer_store_dwordx4 v[124:127], v7, s[44:47], s64 offen sc1
    s_add_u32 s64, s64, 32768
    s_waitcnt lgkmcnt(2)
    buffer_store_dwordx4 v[128:131], v7, s[44:47], s64 offen sc1
    s_add_u32 s64, s64, 32768
    s_waitcnt lgkmcnt(1)
    buffer_store_dwordx4 v[132:135], v7, s[44:47], s64 offen sc1
    s_add_u32 s64, s64, 32768
    s_waitcnt lgkmcnt(0)
    buffer_store_dwordx4 v[136:139], v7, s[44:47], s64 offen sc1
    s_add_u32 s64, s64, 32768
    s_mov_b64 exec, 1
    ds_write_b32 v248, v15 offset:224
    s_mov_b64 exec, -1
    s_lshl_b32 s62, s53, 8
    s_lshl_b32 s64, s54, 2
    s_add_u32 s62, s62, s64
    s_add_u32 s62, s62, 4096
    v_mov_b32 v7, 0
    s_waitcnt vmcnt(0)
    s_mov_b64 exec, 1
    buffer_store_dword v15, v7, s[44:47], s62 offen sc1
    s_mov_b64 exec, -1
    s_setprio 0
    s_branch L_cut_u_main
L_cut_k_gen:
    s_setprio 1
    s_waitcnt vmcnt(0)
    v_lshlrev_b32 v98, 16, v56
    v_lshlrev_b32 v99, 16, v57
    v_lshlrev_b32 v100, 16, v58
    v_lshlrev_b32 v101, 16, v59
    v_mul_f32 v4, s80, v98
    v_fma_f32 v5, v98, s80, -v4
    v_fma_f32 v5, v98, s81, v5
    v_exp_f32 v4, v4
    v_fma_f32 v5, v5, s82, 1.0
    v_mul_f32 v183, v4, v5
    v_cvt_pk_bf16_f32 v183, v183, v183
    v_mul_f32 v184, v99, v182
    v_lshlrev_b32 v183, 16, v183
    v_mul_f32 v70, v100, v182
    v_mul_f32 v183, v183, v182
    v_mul_f32 v71, v101, v182
    v_mul_f32 v183, s80, -v183
    v_mul_f32 v184, s83, v184
    v_add_f32 v70, v70, v70
    v_add_f32 v71, v71, v71
    v_mul_f32 v92, 0x41000000, v183
    v_mul_f32 v93, 0x41000000, v184
    v_mul_f32 v94, 0x43000000, v183
    v_mul_f32 v95, 0x43000000, v184
    v_fract_f32 v91, v184
    v_fract_f32 v93, v93
    v_fract_f32 v95, v95
    v_exp_f32 v90, v183
    v_exp_f32 v92, v92
    v_exp_f32 v94, v94
    v_cos_f32 v60, v91
    v_sin_f32 v61, v91
    v_cos_f32 v64, v93
    v_sin_f32 v65, v93
    v_cos_f32 v68, v95
    v_sin_f32 v69, v95
    v_mov_b32 v98, 0x3f80
    v_pk_mul_f32 v[60:61], v[60:61], v[90:91] op_sel_hi:[1,0]
    v_pk_mul_f32 v[64:65], v[64:65], v[92:93] op_sel_hi:[1,0]
    v_pk_mul_f32 v[68:69], v[68:69], v[94:95] op_sel_hi:[1,0]
    v_pk_mul_f32 v[90:91], v[60:61], v[60:61] op_sel:[0,0] op_sel_hi:[0,1]
    v_pk_mul_f32 v[92:93], v[64:65], v[64:65] op_sel:[0,0] op_sel_hi:[0,1]
    v_pk_mul_f32 v[94:95], v[70:71], v[60:61] op_sel:[0,0] op_sel_hi:[0,1]
    v_pk_fma_f32 v[62:63], v[60:61], v[60:61], v[90:91] op_sel:[1,1,0] op_sel_hi:[1,0,1] neg_lo:[1,0,0]
    v_pk_fma_f32 v[66:67], v[64:65], v[64:65], v[92:93] op_sel:[1,1,0] op_sel_hi:[1,0,1] neg_lo:[1,0,0]
    v_pk_fma_f32 v[72:73], v[70:71], v[60:61], v[94:95] op_sel:[1,1,0] op_sel_hi:[1,0,1] neg_lo:[1,0,0]
    v_cvt_pk_bf16_f32 v99, v64, -v65
    ds_write2_b32 v8, v98, v99 offset0:0 offset1:68
    v_cvt_pk_bf16_f32 v100, v66, -v67
    v_pk_mul_f32 v[90:91], v[64:65], v[66:67] op_sel:[0,0] op_sel_hi:[0,1]
    v_pk_mul_f32 v[92:93], v[66:67], v[66:67] op_sel:[0,0] op_sel_hi:[0,1]
    v_pk_mul_f32 v[94:95], v[70:71], v[62:63] op_sel:[0,0] op_sel_hi:[0,1]
    v_pk_mul_f32 v[96:97], v[72:73], v[62:63] op_sel:[0,0] op_sel_hi:[0,1]
    v_pk_fma_f32 v[86:87], v[64:65], v[66:67], v[90:91] op_sel:[1,1,0] op_sel_hi:[1,0,1] neg_lo:[1,0,0]
    v_pk_fma_f32 v[88:89], v[66:67], v[66:67], v[92:93] op_sel:[1,1,0] op_sel_hi:[1,0,1] neg_lo:[1,0,0]
    v_pk_fma_f32 v[74:75], v[70:71], v[62:63], v[94:95] op_sel:[1,1,0] op_sel_hi:[1,0,1] neg_lo:[1,0,0]
    v_pk_fma_f32 v[76:77], v[72:73], v[62:63], v[96:97] op_sel:[1,1,0] op_sel_hi:[1,0,1] neg_lo:[1,0,0]
    v_cvt_pk_bf16_f32 v101, v86, -v87
    ds_write2_b32 v8, v100, v101 offset0:136 offset1:204
    v_cvt_pk_bf16_f32 v102, v88, -v89
    v_pk_mul_f32 v[90:91], v[86:87], v[66:67] op_sel:[0,0] op_sel_hi:[0,1]
    v_pk_mul_f32 v[92:93], v[88:89], v[66:67] op_sel:[0,0] op_sel_hi:[0,1]
    v_pk_mul_f32 v[94:95], v[74:75], v[62:63] op_sel:[0,0] op_sel_hi:[0,1]
    v_pk_mul_f32 v[96:97], v[76:77], v[62:63] op_sel:[0,0] op_sel_hi:[0,1]
    v_pk_fma_f32 v[86:87], v[86:87], v[66:67], v[90:91] op_sel:[1,1,0] op_sel_hi:[1,0,1] neg_lo:[1,0,0]
    v_pk_fma_f32 v[88:89], v[88:89], v[66:67], v[92:93] op_sel:[1,1,0] op_sel_hi:[1,0,1] neg_lo:[1,0,0]
    v_pk_fma_f32 v[78:79], v[74:75], v[62:63], v[94:95] op_sel:[1,1,0] op_sel_hi:[1,0,1] neg_lo:[1,0,0]
    v_pk_fma_f32 v[80:81], v[76:77], v[62:63], v[96:97] op_sel:[1,1,0] op_sel_hi:[1,0,1] neg_lo:[1,0,0]
    v_cvt_pk_bf16_f32 v103, v86, -v87
    ds_write2_b32 v9, v102, v103 offset0:0 offset1:68
    v_cvt_pk_bf16_f32 v98, v88, -v89
    v_pk_mul_f32 v[90:91], v[86:87], v[66:67] op_sel:[0,0] op_sel_hi:[0,1]
    v_pk_mul_f32 v[92:93], v[88:89], v[66:67] op_sel:[0,0] op_sel_hi:[0,1]
    v_pk_mul_f32 v[94:95], v[78:79], v[62:63] op_sel:[0,0] op_sel_hi:[0,1]
    v_pk_mul_f32 v[96:97], v[80:81], v[62:63] op_sel:[0,0] op_sel_hi:[0,1]
    v_pk_fma_f32 v[86:87], v[86:87], v[66:67], v[90:91] op_sel:[1,1,0] op_sel_hi:[1,0,1] neg_lo:[1,0,0]
    v_pk_fma_f32 v[88:89], v[88:89], v[66:67], v[92:93] op_sel:[1,1,0] op_sel_hi:[1,0,1] neg_lo:[1,0,0]
    v_pk_fma_f32 v[82:83], v[78:79], v[62:63], v[94:95] op_sel:[1,1,0] op_sel_hi:[1,0,1] neg_lo:[1,0,0]
    v_pk_fma_f32 v[84:85], v[80:81], v[62:63], v[96:97] op_sel:[1,1,0] op_sel_hi:[1,0,1] neg_lo:[1,0,0]
    v_cvt_pk_bf16_f32 v99, v86, -v87
    ds_write2_b32 v9, v98, v99 offset0:136 offset1:204
    v_cvt_pk_bf16_f32 v100, v88, -v89
    v_pk_mul_f32 v[90:91], v[86:87], v[66:67] op_sel:[0,0] op_sel_hi:[0,1]
    v_pk_mul_f32 v[92:93], v[88:89], v[66:67] op_sel:[0,0] op_sel_hi:[0,1]
    v_pk_fma_f32 v[86:87], v[86:87], v[66:67], v[90:91] op_sel:[1,1,0] op_sel_hi:[1,0,1] neg_lo:[1,0,0]
    v_pk_fma_f32 v[88:89], v[88:89], v[66:67], v[92:93] op_sel:[1,1,0] op_sel_hi:[1,0,1] neg_lo:[1,0,0]
    v_cvt_pk_bf16_f32 v101, v86, -v87
    ds_write2_b32 v10, v100, v101 offset0:0 offset1:68
    v_cvt_pk_bf16_f32 v102, v88, -v89
    v_pk_mul_f32 v[90:91], v[86:87], v[66:67] op_sel:[0,0] op_sel_hi:[0,1]
    v_pk_mul_f32 v[92:93], v[88:89], v[66:67] op_sel:[0,0] op_sel_hi:[0,1]
    v_pk_fma_f32 v[86:87], v[86:87], v[66:67], v[90:91] op_sel:[1,1,0] op_sel_hi:[1,0,1] neg_lo:[1,0,0]
    v_pk_fma_f32 v[88:89], v[88:89], v[66:67], v[92:93] op_sel:[1,1,0] op_sel_hi:[1,0,1] neg_lo:[1,0,0]
    v_cvt_pk_bf16_f32 v103, v86, -v87
    ds_write2_b32 v10, v102, v103 offset0:136 offset1:204
    v_cvt_pk_bf16_f32 v98, v88, -v89
    v_pk_mul_f32 v[90:91], v[86:87], v[66:67] op_sel:[0,0] op_sel_hi:[0,1]
    v_pk_mul_f32 v[92:93], v[88:89], v[66:67] op_sel:[0,0] op_sel_hi:[0,1]
    v_pk_fma_f32 v[86:87], v[86:87], v[66:67], v[90:91] op_sel:[1,1,0] op_sel_hi:[1,0,1] neg_lo:[1,0,0]
    v_pk_fma_f32 v[88:89], v[88:89], v[66:67], v[92:93] op_sel:[1,1,0] op_sel_hi:[1,0,1] neg_lo:[1,0,0]
    v_cvt_pk_bf16_f32 v99, v86, -v87
    ds_write2_b32 v11, v98, v99 offset0:0 offset1:68
    v_cvt_pk_bf16_f32 v100, v88, -v89
    v_pk_mul_f32 v[90:91], v[86:87], v[66:67] op_sel:[0,0] op_sel_hi:[0,1]
    v_pk_fma_f32 v[86:87], v[86:87], v[66:67], v[90:91] op_sel:[1,1,0] op_sel_hi:[1,0,1] neg_lo:[1,0,0]
    v_cvt_pk_bf16_f32 v101, v86, -v87
    ds_write2_b32 v11, v100, v101 offset0:136 offset1:204
    ds_read_b128 v[104:107], v12 offset:0
    ds_read_b128 v[108:111], v12 offset:64
    ds_read_b128 v[112:115], v12 offset:128
    ds_read_b128 v[116:119], v12 offset:192
    v_cvt_pk_bf16_f32 v102, v70, v71
    v_cvt_pk_bf16_f32 v103, v72, v73
    ds_write2_b32 v8, v102, v103 offset0:0 offset1:68
    v_cvt_pk_bf16_f32 v98, v74, v75
    v_cvt_pk_bf16_f32 v99, v76, v77
    ds_write2_b32 v8, v98, v99 offset0:136 offset1:204
    v_cvt_pk_bf16_f32 v100, v78, v79
    v_cvt_pk_bf16_f32 v101, v80, v81
    ds_write2_b32 v9, v100, v101 offset0:0 offset1:68
    v_cvt_pk_bf16_f32 v102, v82, v83
    v_cvt_pk_bf16_f32 v103, v84, v85
    ds_write2_b32 v9, v102, v103 offset0:136 offset1:204
    v_pk_mul_f32 v[90:91], v[70:71], v[68:69] op_sel:[0,0] op_sel_hi:[0,1]
    v_pk_mul_f32 v[92:93], v[72:73], v[68:69] op_sel:[0,0] op_sel_hi:[0,1]
    v_pk_mul_f32 v[94:95], v[74:75], v[68:69] op_sel:[0,0] op_sel_hi:[0,1]
    v_pk_mul_f32 v[96:97], v[76:77], v[68:69] op_sel:[0,0] op_sel_hi:[0,1]
    v_pk_fma_f32 v[70:71], v[70:71], v[68:69], v[90:91] op_sel:[1,1,0] op_sel_hi:[1,0,1] neg_lo:[1,0,0]
    v_pk_fma_f32 v[72:73], v[72:73], v[68:69], v[92:93] op_sel:[1,1,0] op_sel_hi:[1,0,1] neg_lo:[1,0,0]
    v_pk_fma_f32 v[74:75], v[74:75], v[68:69], v[94:95] op_sel:[1,1,0] op_sel_hi:[1,0,1] neg_lo:[1,0,0]
    v_pk_fma_f32 v[76:77], v[76:77], v[68:69], v[96:97] op_sel:[1,1,0] op_sel_hi:[1,0,1] neg_lo:[1,0,0]
    v_pk_mul_f32 v[90:91], v[78:79], v[68:69] op_sel:[0,0] op_sel_hi:[0,1]
    v_pk_mul_f32 v[92:93], v[80:81], v[68:69] op_sel:[0,0] op_sel_hi:[0,1]
    v_pk_mul_f32 v[94:95], v[82:83], v[68:69] op_sel:[0,0] op_sel_hi:[0,1]
    v_pk_mul_f32 v[96:97], v[84:85], v[68:69] op_sel:[0,0] op_sel_hi:[0,1]
    v_pk_fma_f32 v[78:79], v[78:79], v[68:69], v[90:91] op_sel:[1,1,0] op_sel_hi:[1,0,1] neg_lo:[1,0,0]
    v_pk_fma_f32 v[80:81], v[80:81], v[68:69], v[92:93] op_sel:[1,1,0] op_sel_hi:[1,0,1] neg_lo:[1,0,0]
    v_pk_fma_f32 v[82:83], v[82:83], v[68:69], v[94:95] op_sel:[1,1,0] op_sel_hi:[1,0,1] neg_lo:[1,0,0]
    v_pk_fma_f32 v[84:85], v[84:85], v[68:69], v[96:97] op_sel:[1,1,0] op_sel_hi:[1,0,1] neg_lo:[1,0,0]
    v_cvt_pk_bf16_f32 v98, v70, v71
    v_cvt_pk_bf16_f32 v99, v72, v73
    ds_write2_b32 v10, v98, v99 offset0:0 offset1:68
    v_cvt_pk_bf16_f32 v100, v74, v75
    v_cvt_pk_bf16_f32 v101, v76, v77
    ds_write2_b32 v10, v100, v101 offset0:136 offset1:204
    v_cvt_pk_bf16_f32 v102, v78, v79
    v_cvt_pk_bf16_f32 v103, v80, v81
    ds_write2_b32 v11, v102, v103 offset0:0 offset1:68
    v_cvt_pk_bf16_f32 v98, v82, v83
    v_cvt_pk_bf16_f32 v99, v84, v85
    ds_write2_b32 v11, v98, v99 offset0:136 offset1:204
    ds_read_b128 v[120:123], v12 offset:0
    ds_read_b128 v[124:127], v12 offset:64
    ds_read_b128 v[128:131], v12 offset:128
    ds_read_b128 v[132:135], v12 offset:192
    v_pk_mul_f32 v[90:91], v[70:71], v[68:69] op_sel:[0,0] op_sel_hi:[0,1]
    v_pk_mul_f32 v[92:93], v[74:75], v[68:69] op_sel:[0,0] op_sel_hi:[0,1]
    v_pk_mul_f32 v[94:95], v[78:79], v[68:69] op_sel:[0,0] op_sel_hi:[0,1]
    v_pk_mul_f32 v[96:97], v[82:83], v[68:69] op_sel:[0,0] op_sel_hi:[0,1]
    v_pk_fma_f32 v[70:71], v[70:71], v[68:69], v[90:91] op_sel:[1,1,0] op_sel_hi:[1,0,1] neg_lo:[1,0,0]
    v_pk_fma_f32 v[74:75], v[74:75], v[68:69], v[92:93] op_sel:[1,1,0] op_sel_hi:[1,0,1] neg_lo:[1,0,0]
    v_pk_fma_f32 v[78:79], v[78:79], v[68:69], v[94:95] op_sel:[1,1,0] op_sel_hi:[1,0,1] neg_lo:[1,0,0]
    v_pk_fma_f32 v[82:83], v[82:83], v[68:69], v[96:97] op_sel:[1,1,0] op_sel_hi:[1,0,1] neg_lo:[1,0,0]
    v_cvt_pk_bf16_f32 v100, v70, v71
    v_cvt_pk_bf16_f32 v101, v74, v75
    ds_write2_b32 v8, v100, v101 offset0:0 offset1:68
    v_cvt_pk_bf16_f32 v102, v78, v79
    v_cvt_pk_bf16_f32 v103, v82, v83
    ds_write2_b32 v8, v102, v103 offset0:136 offset1:204
    v_pk_mul_f32 v[90:91], v[70:71], v[68:69] op_sel:[0,0] op_sel_hi:[0,1]
    v_pk_mul_f32 v[92:93], v[74:75], v[68:69] op_sel:[0,0] op_sel_hi:[0,1]
    v_pk_mul_f32 v[94:95], v[78:79], v[68:69] op_sel:[0,0] op_sel_hi:[0,1]
    v_pk_mul_f32 v[96:97], v[82:83], v[68:69] op_sel:[0,0] op_sel_hi:[0,1]
    v_pk_fma_f32 v[70:71], v[70:71], v[68:69], v[90:91] op_sel:[1,1,0] op_sel_hi:[1,0,1] neg_lo:[1,0,0]
    v_pk_fma_f32 v[74:75], v[74:75], v[68:69], v[92:93] op_sel:[1,1,0] op_sel_hi:[1,0,1] neg_lo:[1,0,0]
    v_pk_fma_f32 v[78:79], v[78:79], v[68:69], v[94:95] op_sel:[1,1,0] op_sel_hi:[1,0,1] neg_lo:[1,0,0]
    v_pk_fma_f32 v[82:83], v[82:83], v[68:69], v[96:97] op_sel:[1,1,0] op_sel_hi:[1,0,1] neg_lo:[1,0,0]
    v_cvt_pk_bf16_f32 v98, v70, v71
    v_cvt_pk_bf16_f32 v99, v74, v75
    s_waitcnt lgkmcnt(5)
    v_mfma_f32_16x16x32_bf16 v[170:173], v[120:123], v[104:107], 0
    ds_write2_b32 v9, v98, v99 offset0:0 offset1:68
    v_cvt_pk_bf16_f32 v100, v78, v79
    v_cvt_pk_bf16_f32 v101, v82, v83
    ds_write2_b32 v9, v100, v101 offset0:136 offset1:204
    v_pk_mul_f32 v[90:91], v[70:71], v[68:69] op_sel:[0,0] op_sel_hi:[0,1]
    s_waitcnt lgkmcnt(6)
    v_mfma_f32_16x16x32_bf16 v[170:173], v[124:127], v[108:111], v[170:173]
    v_pk_mul_f32 v[92:93], v[78:79], v[68:69] op_sel:[0,0] op_sel_hi:[0,1]
    v_pk_fma_f32 v[70:71], v[70:71], v[68:69], v[90:91] op_sel:[1,1,0] op_sel_hi:[1,0,1] neg_lo:[1,0,0]
    v_pk_fma_f32 v[78:79], v[78:79], v[68:69], v[92:93] op_sel:[1,1,0] op_sel_hi:[1,0,1] neg_lo:[1,0,0]
    v_cvt_pk_bf16_f32 v102, v70, v71
    v_cvt_pk_bf16_f32 v103, v78, v79
    s_waitcnt lgkmcnt(5)
    v_mfma_f32_16x16x32_bf16 v[170:173], v[128:131], v[112:115], v[170:173]
    ds_write2_b32 v10, v102, v103 offset0:0 offset1:68
    v_pk_mul_f32 v[90:91], v[70:71], v[68:69] op_sel:[0,0] op_sel_hi:[0,1]
    v_pk_mul_f32 v[92:93], v[78:79], v[68:69] op_sel:[0,0] op_sel_hi:[0,1]
    v_pk_fma_f32 v[70:71], v[70:71], v[68:69], v[90:91] op_sel:[1,1,0] op_sel_hi:[1,0,1] neg_lo:[1,0,0]
    v_pk_fma_f32 v[78:79], v[78:79], v[68:69], v[92:93] op_sel:[1,1,0] op_sel_hi:[1,0,1] neg_lo:[1,0,0]
    s_waitcnt lgkmcnt(5)
    v_mfma_f32_16x16x32_bf16 v[170:173], v[132:135], v[116:119], v[170:173]
    v_cvt_pk_bf16_f32 v98, v70, v71
    v_cvt_pk_bf16_f32 v99, v78, v79
    ds_write2_b32 v10, v98, v99 offset0:136 offset1:204
    v_pk_mul_f32 v[90:91], v[70:71], v[68:69] op_sel:[0,0] op_sel_hi:[0,1]
    v_pk_mul_f32 v[92:93], v[78:79], v[68:69] op_sel:[0,0] op_sel_hi:[0,1]
    v_pk_fma_f32 v[70:71], v[70:71], v[68:69], v[90:91] op_sel:[1,1,0] op_sel_hi:[1,0,1] neg_lo:[1,0,0]
    v_pk_fma_f32 v[78:79], v[78:79], v[68:69], v[92:93] op_sel:[1,1,0] op_sel_hi:[1,0,1] neg_lo:[1,0,0]
    v_cvt_pk_bf16_f32 v100, v70, v71
    v_cvt_pk_bf16_f32 v101, v78, v79
    ds_write2_b32 v11, v100, v101 offset0:0 offset1:68
    v_pk_mul_f32 v[90:91], v[70:71], v[68:69] op_sel:[0,0] op_sel_hi:[0,1]
    v_pk_mul_f32 v[92:93], v[78:79], v[68:69] op_sel:[0,0] op_sel_hi:[0,1]
    v_pk_fma_f32 v[70:71], v[70:71], v[68:69], v[90:91] op_sel:[1,1,0] op_sel_hi:[1,0,1] neg_lo:[1,0,0]
    v_pk_fma_f32 v[78:79], v[78:79], v[68:69], v[92:93] op_sel:[1,1,0] op_sel_hi:[1,0,1] neg_lo:[1,0,0]
    v_cvt_pk_bf16_f32 v102, v70, v71
    v_cvt_pk_bf16_f32 v103, v78, v79
    ds_write2_b32 v11, v102, v103 offset0:136 offset1:204
    ds_read_b128 v[120:123], v12 offset:0
    ds_read_b128 v[124:127], v12 offset:64
    ds_read_b128 v[128:131], v12 offset:128
    ds_read_b128 v[132:135], v12 offset:192
    v_pk_mul_f32 v[90:91], v[70:71], v[68:69] op_sel:[0,0] op_sel_hi:[0,1]
    v_pk_mul_f32 v[92:93], v[68:69], v[68:69] op_sel:[0,0] op_sel_hi:[0,1]
    v_pk_fma_f32 v[70:71], v[70:71], v[68:69], v[90:91] op_sel:[1,1,0] op_sel_hi:[1,0,1] neg_lo:[1,0,0]
    v_pk_fma_f32 v[62:63], v[68:69], v[68:69], v[92:93] op_sel:[1,1,0] op_sel_hi:[1,0,1] neg_lo:[1,0,0]
    v_pk_mul_f32 v[90:91], v[70:71], v[68:69] op_sel:[0,0] op_sel_hi:[0,1]
    v_pk_fma_f32 v[72:73], v[70:71], v[68:69], v[90:91] op_sel:[1,1,0] op_sel_hi:[1,0,1] neg_lo:[1,0,0]
    v_cvt_pk_bf16_f32 v98, v70, v71
    v_cvt_pk_bf16_f32 v99, v72, v73
    ds_write2_b32 v8, v98, v99 offset0:0 offset1:68
    v_pk_mul_f32 v[90:91], v[70:71], v[62:63] op_sel:[0,0] op_sel_hi:[0,1]
    v_pk_mul_f32 v[92:93], v[72:73], v[62:63] op_sel:[0,0] op_sel_hi:[0,1]
    v_pk_fma_f32 v[70:71], v[70:71], v[62:63], v[90:91] op_sel:[1,1,0] op_sel_hi:[1,0,1] neg_lo:[1,0,0]
    v_pk_fma_f32 v[72:73], v[72:73], v[62:63], v[92:93] op_sel:[1,1,0] op_sel_hi:[1,0,1] neg_lo:[1,0,0]
    v_cvt_pk_bf16_f32 v100, v70, v71
    v_cvt_pk_bf16_f32 v101, v72, v73
    ds_write2_b32 v8, v100, v101 offset0:136 offset1:204
    v_pk_mul_f32 v[90:91], v[70:71], v[62:63] op_sel:[0,0] op_sel_hi:[0,1]
    v_pk_mul_f32 v[92:93], v[72:73], v[62:63] op_sel:[0,0] op_sel_hi:[0,1]
    v_pk_fma_f32 v[70:71], v[70:71], v[62:63], v[90:91] op_sel:[1,1,0] op_sel_hi:[1,0,1] neg_lo:[1,0,0]
    v_pk_fma_f32 v[72:73], v[72:73], v[62:63], v[92:93] op_sel:[1,1,0] op_sel_hi:[1,0,1] neg_lo:[1,0,0]
    v_cvt_pk_bf16_f32 v102, v70, v71
    v_cvt_pk_bf16_f32 v103, v72, v73
    ds_write2_b32 v9, v102, v103 offset0:0 offset1:68
    v_pk_mul_f32 v[90:91], v[70:71], v[62:63] op_sel:[0,0] op_sel_hi:[0,1]
    s_waitcnt lgkmcnt(6)
    v_mfma_f32_16x16x32_bf16 v[174:177], v[120:123], v[104:107], 0
    v_pk_mul_f32 v[92:93], v[72:73], v[62:63] op_sel:[0,0] op_sel_hi:[0,1]
    v_pk_fma_f32 v[70:71], v[70:71], v[62:63], v[90:91] op_sel:[1,1,0] op_sel_hi:[1,0,1] neg_lo:[1,0,0]
    v_pk_fma_f32 v[72:73], v[72:73], v[62:63], v[92:93] op_sel:[1,1,0] op_sel_hi:[1,0,1] neg_lo:[1,0,0]
    v_cvt_pk_bf16_f32 v98, v70, v71
    v_cvt_pk_bf16_f32 v99, v72, v73
    s_waitcnt lgkmcnt(5)
    v_mfma_f32_16x16x32_bf16 v[174:177], v[124:127], v[108:111], v[174:177]
    ds_write2_b32 v9, v98, v99 offset0:136 offset1:204
    v_pk_mul_f32 v[90:91], v[70:71], v[62:63] op_sel:[0,0] op_sel_hi:[0,1]
    v_pk_fma_f32 v[70:71], v[70:71], v[62:63], v[90:91] op_sel:[1,1,0] op_sel_hi:[1,0,1] neg_lo:[1,0,0]
    v_cvt_pk_bf16_f32 v100, v70, v71
    ds_write_b32 v10, v100 offset:0
    s_waitcnt lgkmcnt(6)
    v_mfma_f32_16x16x32_bf16 v[174:177], v[128:131], v[112:115], v[174:177]
    s_waitcnt lgkmcnt(5)
    v_mfma_f32_16x16x32_bf16 v[174:177], v[132:135], v[116:119], v[174:177]
    ds_read_b128 v[120:123], v12 offset:0
    ds_read_b128 v[124:127], v12 offset:64
    ds_read_b128 v[128:131], v12 offset:128
    ds_read_b128 v[132:135], v12 offset:192
    v_and_b32 v98, 0xffff0000, v56
    v_and_b32 v99, 0xffff0000, v57
    v_and_b32 v100, 0xffff0000, v58
    v_and_b32 v101, 0xffff0000, v59
    v_mul_f32 v4, s80, v98
    v_fma_f32 v5, v98, s80, -v4
    v_fma_f32 v5, v98, s81, v5
    v_exp_f32 v4, v4
    v_fma_f32 v5, v5, s82, 1.0
    v_mul_f32 v183, v4, v5
    v_cvt_pk_bf16_f32 v183, v183, v183
    v_mul_f32 v184, v99, v182
    v_lshlrev_b32 v183, 16, v183
    v_mul_f32 v70, v100, v182
    v_mul_f32 v183, v183, v182
    v_mul_f32 v71, v101, v182
    v_mul_f32 v183, s80, -v183
    v_mul_f32 v184, s83, v184
    v_add_f32 v70, v70, v70
    v_add_f32 v71, v71, v71
    v_mul_f32 v92, 0x41000000, v183
    v_mul_f32 v93, 0x41000000, v184
    v_mul_f32 v94, 0x43000000, v183
    v_mul_f32 v95, 0x43000000, v184
    s_waitcnt lgkmcnt(3)
    v_mfma_f32_16x16x32_bf16 v[178:181], v[120:123], v[104:107], 0
    v_fract_f32 v91, v184
    v_fract_f32 v93, v93
    v_fract_f32 v95, v95
    v_exp_f32 v90, v183
    v_exp_f32 v92, v92
    s_waitcnt lgkmcnt(2)
    v_mfma_f32_16x16x32_bf16 v[178:181], v[124:127], v[108:111], v[178:181]
    v_exp_f32 v94, v94
    v_cos_f32 v60, v91
    v_sin_f32 v61, v91
    v_cos_f32 v64, v93
    v_sin_f32 v65, v93
    s_waitcnt lgkmcnt(1)
    v_mfma_f32_16x16x32_bf16 v[178:181], v[128:131], v[112:115], v[178:181]
    v_cos_f32 v68, v95
    v_sin_f32 v69, v95
    v_mov_b32 v98, 0x3f80
    v_pk_mul_f32 v[60:61], v[60:61], v[90:91] op_sel_hi:[1,0]
    v_pk_mul_f32 v[64:65], v[64:65], v[92:93] op_sel_hi:[1,0]
    s_waitcnt lgkmcnt(0)
    v_mfma_f32_16x16x32_bf16 v[178:181], v[132:135], v[116:119], v[178:181]
    v_pk_mul_f32 v[68:69], v[68:69], v[94:95] op_sel_hi:[1,0]
    v_pk_mul_f32 v[90:91], v[60:61], v[60:61] op_sel:[0,0] op_sel_hi:[0,1]
    v_pk_mul_f32 v[92:93], v[64:65], v[64:65] op_sel:[0,0] op_sel_hi:[0,1]
    v_pk_mul_f32 v[94:95], v[70:71], v[60:61] op_sel:[0,0] op_sel_hi:[0,1]
    v_pk_fma_f32 v[62:63], v[60:61], v[60:61], v[90:91] op_sel:[1,1,0] op_sel_hi:[1,0,1] neg_lo:[1,0,0]
    v_pk_fma_f32 v[66:67], v[64:65], v[64:65], v[92:93] op_sel:[1,1,0] op_sel_hi:[1,0,1] neg_lo:[1,0,0]
    v_pk_fma_f32 v[72:73], v[70:71], v[60:61], v[94:95] op_sel:[1,1,0] op_sel_hi:[1,0,1] neg_lo:[1,0,0]
    v_cvt_pk_bf16_f32 v99, v64, -v65
    ds_write2_b32 v8, v98, v99 offset0:0 offset1:68
    v_cvt_pk_bf16_f32 v100, v66, -v67
    v_pk_mul_f32 v[90:91], v[64:65], v[66:67] op_sel:[0,0] op_sel_hi:[0,1]
    v_pk_mul_f32 v[92:93], v[66:67], v[66:67] op_sel:[0,0] op_sel_hi:[0,1]
    v_pk_mul_f32 v[94:95], v[70:71], v[62:63] op_sel:[0,0] op_sel_hi:[0,1]
    v_pk_mul_f32 v[96:97], v[72:73], v[62:63] op_sel:[0,0] op_sel_hi:[0,1]
    v_pk_fma_f32 v[86:87], v[64:65], v[66:67], v[90:91] op_sel:[1,1,0] op_sel_hi:[1,0,1] neg_lo:[1,0,0]
    v_pk_fma_f32 v[88:89], v[66:67], v[66:67], v[92:93] op_sel:[1,1,0] op_sel_hi:[1,0,1] neg_lo:[1,0,0]
    v_pk_fma_f32 v[74:75], v[70:71], v[62:63], v[94:95] op_sel:[1,1,0] op_sel_hi:[1,0,1] neg_lo:[1,0,0]
    v_pk_fma_f32 v[76:77], v[72:73], v[62:63], v[96:97] op_sel:[1,1,0] op_sel_hi:[1,0,1] neg_lo:[1,0,0]
    v_cvt_pk_bf16_f32 v101, v86, -v87
    ds_write2_b32 v8, v100, v101 offset0:136 offset1:204
    v_cvt_pk_bf16_f32 v102, v88, -v89
    v_pk_mul_f32 v[90:91], v[86:87], v[66:67] op_sel:[0,0] op_sel_hi:[0,1]
    v_pk_mul_f32 v[92:93], v[88:89], v[66:67] op_sel:[0,0] op_sel_hi:[0,1]
    v_pk_mul_f32 v[94:95], v[74:75], v[62:63] op_sel:[0,0] op_sel_hi:[0,1]
    v_pk_mul_f32 v[96:97], v[76:77], v[62:63] op_sel:[0,0] op_sel_hi:[0,1]
    v_pk_fma_f32 v[86:87], v[86:87], v[66:67], v[90:91] op_sel:[1,1,0] op_sel_hi:[1,0,1] neg_lo:[1,0,0]
    v_pk_fma_f32 v[88:89], v[88:89], v[66:67], v[92:93] op_sel:[1,1,0] op_sel_hi:[1,0,1] neg_lo:[1,0,0]
    v_pk_fma_f32 v[78:79], v[74:75], v[62:63], v[94:95] op_sel:[1,1,0] op_sel_hi:[1,0,1] neg_lo:[1,0,0]
    v_pk_fma_f32 v[80:81], v[76:77], v[62:63], v[96:97] op_sel:[1,1,0] op_sel_hi:[1,0,1] neg_lo:[1,0,0]
    v_cvt_pk_bf16_f32 v103, v86, -v87
    ds_write2_b32 v9, v102, v103 offset0:0 offset1:68
    v_cvt_pk_bf16_f32 v98, v88, -v89
    v_pk_mul_f32 v[90:91], v[86:87], v[66:67] op_sel:[0,0] op_sel_hi:[0,1]
    v_pk_mul_f32 v[92:93], v[88:89], v[66:67] op_sel:[0,0] op_sel_hi:[0,1]
    v_pk_mul_f32 v[94:95], v[78:79], v[62:63] op_sel:[0,0] op_sel_hi:[0,1]
    v_pk_mul_f32 v[96:97], v[80:81], v[62:63] op_sel:[0,0] op_sel_hi:[0,1]
    v_pk_fma_f32 v[86:87], v[86:87], v[66:67], v[90:91] op_sel:[1,1,0] op_sel_hi:[1,0,1] neg_lo:[1,0,0]
    v_pk_fma_f32 v[88:89], v[88:89], v[66:67], v[92:93] op_sel:[1,1,0] op_sel_hi:[1,0,1] neg_lo:[1,0,0]
    v_pk_fma_f32 v[82:83], v[78:79], v[62:63], v[94:95] op_sel:[1,1,0] op_sel_hi:[1,0,1] neg_lo:[1,0,0]
    v_pk_fma_f32 v[84:85], v[80:81], v[62:63], v[96:97] op_sel:[1,1,0] op_sel_hi:[1,0,1] neg_lo:[1,0,0]
    v_cvt_pk_bf16_f32 v99, v86, -v87
    ds_write2_b32 v9, v98, v99 offset0:136 offset1:204
    v_cvt_pk_bf16_f32 v100, v88, -v89
    v_pk_mul_f32 v[90:91], v[86:87], v[66:67] op_sel:[0,0] op_sel_hi:[0,1]
    v_pk_mul_f32 v[92:93], v[88:89], v[66:67] op_sel:[0,0] op_sel_hi:[0,1]
    v_pk_fma_f32 v[86:87], v[86:87], v[66:67], v[90:91] op_sel:[1,1,0] op_sel_hi:[1,0,1] neg_lo:[1,0,0]
    v_pk_fma_f32 v[88:89], v[88:89], v[66:67], v[92:93] op_sel:[1,1,0] op_sel_hi:[1,0,1] neg_lo:[1,0,0]
    v_cvt_pk_bf16_f32 v101, v86, -v87
    ds_write2_b32 v10, v100, v101 offset0:0 offset1:68
    v_cvt_pk_bf16_f32 v102, v88, -v89
    v_pk_mul_f32 v[90:91], v[86:87], v[66:67] op_sel:[0,0] op_sel_hi:[0,1]
    v_pk_mul_f32 v[92:93], v[88:89], v[66:67] op_sel:[0,0] op_sel_hi:[0,1]
    v_pk_fma_f32 v[86:87], v[86:87], v[66:67], v[90:91] op_sel:[1,1,0] op_sel_hi:[1,0,1] neg_lo:[1,0,0]
    v_pk_fma_f32 v[88:89], v[88:89], v[66:67], v[92:93] op_sel:[1,1,0] op_sel_hi:[1,0,1] neg_lo:[1,0,0]
    v_cvt_pk_bf16_f32 v103, v86, -v87
    ds_write2_b32 v10, v102, v103 offset0:136 offset1:204
    v_cvt_pk_bf16_f32 v98, v88, -v89
    v_pk_mul_f32 v[90:91], v[86:87], v[66:67] op_sel:[0,0] op_sel_hi:[0,1]
    v_pk_mul_f32 v[92:93], v[88:89], v[66:67] op_sel:[0,0] op_sel_hi:[0,1]
    v_pk_fma_f32 v[86:87], v[86:87], v[66:67], v[90:91] op_sel:[1,1,0] op_sel_hi:[1,0,1] neg_lo:[1,0,0]
    v_pk_fma_f32 v[88:89], v[88:89], v[66:67], v[92:93] op_sel:[1,1,0] op_sel_hi:[1,0,1] neg_lo:[1,0,0]
    v_cvt_pk_bf16_f32 v99, v86, -v87
    ds_write2_b32 v11, v98, v99 offset0:0 offset1:68
    v_cvt_pk_bf16_f32 v100, v88, -v89
    v_pk_mul_f32 v[90:91], v[86:87], v[66:67] op_sel:[0,0] op_sel_hi:[0,1]
    v_pk_fma_f32 v[86:87], v[86:87], v[66:67], v[90:91] op_sel:[1,1,0] op_sel_hi:[1,0,1] neg_lo:[1,0,0]
    v_cvt_pk_bf16_f32 v101, v86, -v87
    ds_write2_b32 v11, v100, v101 offset0:136 offset1:204
    ds_read_b128 v[104:107], v12 offset:0
    ds_read_b128 v[108:111], v12 offset:64
    ds_read_b128 v[112:115], v12 offset:128
    ds_read_b128 v[116:119], v12 offset:192
    v_cvt_pk_bf16_f32 v102, v70, v71
    v_cvt_pk_bf16_f32 v103, v72, v73
    ds_write2_b32 v8, v102, v103 offset0:0 offset1:68
    v_cvt_pk_bf16_f32 v98, v74, v75
    v_cvt_pk_bf16_f32 v99, v76, v77
    ds_write2_b32 v8, v98, v99 offset0:136 offset1:204
    v_cvt_pk_bf16_f32 v100, v78, v79
    v_cvt_pk_bf16_f32 v101, v80, v81
    ds_write2_b32 v9, v100, v101 offset0:0 offset1:68
    v_cvt_pk_bf16_f32 v102, v82, v83
    v_cvt_pk_bf16_f32 v103, v84, v85
    ds_write2_b32 v9, v102, v103 offset0:136 offset1:204
    v_pk_mul_f32 v[90:91], v[70:71], v[68:69] op_sel:[0,0] op_sel_hi:[0,1]
    v_pk_mul_f32 v[92:93], v[72:73], v[68:69] op_sel:[0,0] op_sel_hi:[0,1]
    v_pk_mul_f32 v[94:95], v[74:75], v[68:69] op_sel:[0,0] op_sel_hi:[0,1]
    v_pk_mul_f32 v[96:97], v[76:77], v[68:69] op_sel:[0,0] op_sel_hi:[0,1]
    v_pk_fma_f32 v[70:71], v[70:71], v[68:69], v[90:91] op_sel:[1,1,0] op_sel_hi:[1,0,1] neg_lo:[1,0,0]
    v_pk_fma_f32 v[72:73], v[72:73], v[68:69], v[92:93] op_sel:[1,1,0] op_sel_hi:[1,0,1] neg_lo:[1,0,0]
    v_pk_fma_f32 v[74:75], v[74:75], v[68:69], v[94:95] op_sel:[1,1,0] op_sel_hi:[1,0,1] neg_lo:[1,0,0]
    v_pk_fma_f32 v[76:77], v[76:77], v[68:69], v[96:97] op_sel:[1,1,0] op_sel_hi:[1,0,1] neg_lo:[1,0,0]
    v_pk_mul_f32 v[90:91], v[78:79], v[68:69] op_sel:[0,0] op_sel_hi:[0,1]
    v_pk_mul_f32 v[92:93], v[80:81], v[68:69] op_sel:[0,0] op_sel_hi:[0,1]
    v_pk_mul_f32 v[94:95], v[82:83], v[68:69] op_sel:[0,0] op_sel_hi:[0,1]
    v_pk_mul_f32 v[96:97], v[84:85], v[68:69] op_sel:[0,0] op_sel_hi:[0,1]
    v_pk_fma_f32 v[78:79], v[78:79], v[68:69], v[90:91] op_sel:[1,1,0] op_sel_hi:[1,0,1] neg_lo:[1,0,0]
    v_pk_fma_f32 v[80:81], v[80:81], v[68:69], v[92:93] op_sel:[1,1,0] op_sel_hi:[1,0,1] neg_lo:[1,0,0]
    v_pk_fma_f32 v[82:83], v[82:83], v[68:69], v[94:95] op_sel:[1,1,0] op_sel_hi:[1,0,1] neg_lo:[1,0,0]
    v_pk_fma_f32 v[84:85], v[84:85], v[68:69], v[96:97] op_sel:[1,1,0] op_sel_hi:[1,0,1] neg_lo:[1,0,0]
    v_cvt_pk_bf16_f32 v98, v70, v71
    v_cvt_pk_bf16_f32 v99, v72, v73
    ds_write2_b32 v10, v98, v99 offset0:0 offset1:68
    v_cvt_pk_bf16_f32 v100, v74, v75
    v_cvt_pk_bf16_f32 v101, v76, v77
    ds_write2_b32 v10, v100, v101 offset0:136 offset1:204
    v_cvt_pk_bf16_f32 v102, v78, v79
    v_cvt_pk_bf16_f32 v103, v80, v81
    ds_write2_b32 v11, v102, v103 offset0:0 offset1:68
    v_cvt_pk_bf16_f32 v98, v82, v83
    v_cvt_pk_bf16_f32 v99, v84, v85
    ds_write2_b32 v11, v98, v99 offset0:136 offset1:204
    ds_read_b128 v[120:123], v12 offset:0
    ds_read_b128 v[124:127], v12 offset:64
    ds_read_b128 v[128:131], v12 offset:128
    ds_read_b128 v[132:135], v12 offset:192
    v_pk_mul_f32 v[90:91], v[70:71], v[68:69] op_sel:[0,0] op_sel_hi:[0,1]
    v_pk_mul_f32 v[92:93], v[74:75], v[68:69] op_sel:[0,0] op_sel_hi:[0,1]
    v_pk_mul_f32 v[94:95], v[78:79], v[68:69] op_sel:[0,0] op_sel_hi:[0,1]
    v_pk_mul_f32 v[96:97], v[82:83], v[68:69] op_sel:[0,0] op_sel_hi:[0,1]
    v_pk_fma_f32 v[70:71], v[70:71], v[68:69], v[90:91] op_sel:[1,1,0] op_sel_hi:[1,0,1] neg_lo:[1,0,0]
    v_pk_fma_f32 v[74:75], v[74:75], v[68:69], v[92:93] op_sel:[1,1,0] op_sel_hi:[1,0,1] neg_lo:[1,0,0]
    v_pk_fma_f32 v[78:79], v[78:79], v[68:69], v[94:95] op_sel:[1,1,0] op_sel_hi:[1,0,1] neg_lo:[1,0,0]
    v_pk_fma_f32 v[82:83], v[82:83], v[68:69], v[96:97] op_sel:[1,1,0] op_sel_hi:[1,0,1] neg_lo:[1,0,0]
    v_cvt_pk_bf16_f32 v100, v70, v71
    v_cvt_pk_bf16_f32 v101, v74, v75
    ds_write2_b32 v8, v100, v101 offset0:0 offset1:68
    v_cvt_pk_bf16_f32 v102, v78, v79
    v_cvt_pk_bf16_f32 v103, v82, v83
    ds_write2_b32 v8, v102, v103 offset0:136 offset1:204
    v_pk_mul_f32 v[90:91], v[70:71], v[68:69] op_sel:[0,0] op_sel_hi:[0,1]
    v_pk_mul_f32 v[92:93], v[74:75], v[68:69] op_sel:[0,0] op_sel_hi:[0,1]
    v_pk_mul_f32 v[94:95], v[78:79], v[68:69] op_sel:[0,0] op_sel_hi:[0,1]
    v_pk_mul_f32 v[96:97], v[82:83], v[68:69] op_sel:[0,0] op_sel_hi:[0,1]
    v_pk_fma_f32 v[70:71], v[70:71], v[68:69], v[90:91] op_sel:[1,1,0] op_sel_hi:[1,0,1] neg_lo:[1,0,0]
    v_pk_fma_f32 v[74:75], v[74:75], v[68:69], v[92:93] op_sel:[1,1,0] op_sel_hi:[1,0,1] neg_lo:[1,0,0]
    v_pk_fma_f32 v[78:79], v[78:79], v[68:69], v[94:95] op_sel:[1,1,0] op_sel_hi:[1,0,1] neg_lo:[1,0,0]
    v_pk_fma_f32 v[82:83], v[82:83], v[68:69], v[96:97] op_sel:[1,1,0] op_sel_hi:[1,0,1] neg_lo:[1,0,0]
    v_cvt_pk_bf16_f32 v98, v70, v71
    v_cvt_pk_bf16_f32 v99, v74, v75
    s_waitcnt lgkmcnt(5)
    v_mfma_f32_16x16x32_bf16 v[170:173], v[120:123], v[104:107], v[170:173]
    ds_write2_b32 v9, v98, v99 offset0:0 offset1:68
    v_cvt_pk_bf16_f32 v100, v78, v79
    v_cvt_pk_bf16_f32 v101, v82, v83
    ds_write2_b32 v9, v100, v101 offset0:136 offset1:204
    v_pk_mul_f32 v[90:91], v[70:71], v[68:69] op_sel:[0,0] op_sel_hi:[0,1]
    s_waitcnt lgkmcnt(6)
    v_mfma_f32_16x16x32_bf16 v[170:173], v[124:127], v[108:111], v[170:173]
    v_pk_mul_f32 v[92:93], v[78:79], v[68:69] op_sel:[0,0] op_sel_hi:[0,1]
    v_pk_fma_f32 v[70:71], v[70:71], v[68:69], v[90:91] op_sel:[1,1,0] op_sel_hi:[1,0,1] neg_lo:[1,0,0]
    v_pk_fma_f32 v[78:79], v[78:79], v[68:69], v[92:93] op_sel:[1,1,0] op_sel_hi:[1,0,1] neg_lo:[1,0,0]
    v_cvt_pk_bf16_f32 v102, v70, v71
    v_cvt_pk_bf16_f32 v103, v78, v79
    s_waitcnt lgkmcnt(5)
    v_mfma_f32_16x16x32_bf16 v[170:173], v[128:131], v[112:115], v[170:173]
    ds_write2_b32 v10, v102, v103 offset0:0 offset1:68
    v_pk_mul_f32 v[90:91], v[70:71], v[68:69] op_sel:[0,0] op_sel_hi:[0,1]
    v_pk_mul_f32 v[92:93], v[78:79], v[68:69] op_sel:[0,0] op_sel_hi:[0,1]
    v_pk_fma_f32 v[70:71], v[70:71], v[68:69], v[90:91] op_sel:[1,1,0] op_sel_hi:[1,0,1] neg_lo:[1,0,0]
    v_pk_fma_f32 v[78:79], v[78:79], v[68:69], v[92:93] op_sel:[1,1,0] op_sel_hi:[1,0,1] neg_lo:[1,0,0]
    s_waitcnt lgkmcnt(5)
    v_mfma_f32_16x16x32_bf16 v[170:173], v[132:135], v[116:119], v[170:173]
    v_cvt_pk_bf16_f32 v98, v70, v71
    v_cvt_pk_bf16_f32 v99, v78, v79
    ds_write2_b32 v10, v98, v99 offset0:136 offset1:204
    v_pk_mul_f32 v[90:91], v[70:71], v[68:69] op_sel:[0,0] op_sel_hi:[0,1]
    v_pk_mul_f32 v[92:93], v[78:79], v[68:69] op_sel:[0,0] op_sel_hi:[0,1]
    v_pk_fma_f32 v[70:71], v[70:71], v[68:69], v[90:91] op_sel:[1,1,0] op_sel_hi:[1,0,1] neg_lo:[1,0,0]
    v_pk_fma_f32 v[78:79], v[78:79], v[68:69], v[92:93] op_sel:[1,1,0] op_sel_hi:[1,0,1] neg_lo:[1,0,0]
    v_cvt_pk_bf16_f32 v100, v70, v71
    v_cvt_pk_bf16_f32 v101, v78, v79
    ds_write2_b32 v11, v100, v101 offset0:0 offset1:68
    v_pk_mul_f32 v[90:91], v[70:71], v[68:69] op_sel:[0,0] op_sel_hi:[0,1]
    v_pk_mul_f32 v[92:93], v[78:79], v[68:69] op_sel:[0,0] op_sel_hi:[0,1]
    v_pk_fma_f32 v[70:71], v[70:71], v[68:69], v[90:91] op_sel:[1,1,0] op_sel_hi:[1,0,1] neg_lo:[1,0,0]
    v_pk_fma_f32 v[78:79], v[78:79], v[68:69], v[92:93] op_sel:[1,1,0] op_sel_hi:[1,0,1] neg_lo:[1,0,0]
    v_cvt_pk_bf16_f32 v102, v70, v71
    v_cvt_pk_bf16_f32 v103, v78, v79
    ds_write2_b32 v11, v102, v103 offset0:136 offset1:204
    ds_read_b128 v[120:123], v12 offset:0
    ds_read_b128 v[124:127], v12 offset:64
    ds_read_b128 v[128:131], v12 offset:128
    ds_read_b128 v[132:135], v12 offset:192
    v_pk_mul_f32 v[90:91], v[70:71], v[68:69] op_sel:[0,0] op_sel_hi:[0,1]
    v_pk_mul_f32 v[92:93], v[68:69], v[68:69] op_sel:[0,0] op_sel_hi:[0,1]
    v_pk_fma_f32 v[70:71], v[70:71], v[68:69], v[90:91] op_sel:[1,1,0] op_sel_hi:[1,0,1] neg_lo:[1,0,0]
    v_pk_fma_f32 v[62:63], v[68:69], v[68:69], v[92:93] op_sel:[1,1,0] op_sel_hi:[1,0,1] neg_lo:[1,0,0]
    v_pk_mul_f32 v[90:91], v[70:71], v[68:69] op_sel:[0,0] op_sel_hi:[0,1]
    v_pk_fma_f32 v[72:73], v[70:71], v[68:69], v[90:91] op_sel:[1,1,0] op_sel_hi:[1,0,1] neg_lo:[1,0,0]
    v_cvt_pk_bf16_f32 v98, v70, v71
    v_cvt_pk_bf16_f32 v99, v72, v73
    ds_write2_b32 v8, v98, v99 offset0:0 offset1:68
    v_pk_mul_f32 v[90:91], v[70:71], v[62:63] op_sel:[0,0] op_sel_hi:[0,1]
    v_pk_mul_f32 v[92:93], v[72:73], v[62:63] op_sel:[0,0] op_sel_hi:[0,1]
    v_pk_fma_f32 v[70:71], v[70:71], v[62:63], v[90:91] op_sel:[1,1,0] op_sel_hi:[1,0,1] neg_lo:[1,0,0]
    v_pk_fma_f32 v[72:73], v[72:73], v[62:63], v[92:93] op_sel:[1,1,0] op_sel_hi:[1,0,1] neg_lo:[1,0,0]
    v_cvt_pk_bf16_f32 v100, v70, v71
    v_cvt_pk_bf16_f32 v101, v72, v73
    ds_write2_b32 v8, v100, v101 offset0:136 offset1:204
    v_pk_mul_f32 v[90:91], v[70:71], v[62:63] op_sel:[0,0] op_sel_hi:[0,1]
    v_pk_mul_f32 v[92:93], v[72:73], v[62:63] op_sel:[0,0] op_sel_hi:[0,1]
    v_pk_fma_f32 v[70:71], v[70:71], v[62:63], v[90:91] op_sel:[1,1,0] op_sel_hi:[1,0,1] neg_lo:[1,0,0]
    v_pk_fma_f32 v[72:73], v[72:73], v[62:63], v[92:93] op_sel:[1,1,0] op_sel_hi:[1,0,1] neg_lo:[1,0,0]
    v_cvt_pk_bf16_f32 v102, v70, v71
    v_cvt_pk_bf16_f32 v103, v72, v73
    ds_write2_b32 v9, v102, v103 offset0:0 offset1:68
    v_pk_mul_f32 v[90:91], v[70:71], v[62:63] op_sel:[0,0] op_sel_hi:[0,1]
    s_waitcnt lgkmcnt(6)
    v_mfma_f32_16x16x32_bf16 v[174:177], v[120:123], v[104:107], v[174:177]
    v_pk_mul_f32 v[92:93], v[72:73], v[62:63] op_sel:[0,0] op_sel_hi:[0,1]
    v_pk_fma_f32 v[70:71], v[70:71], v[62:63], v[90:91] op_sel:[1,1,0] op_sel_hi:[1,0,1] neg_lo:[1,0,0]
    v_pk_fma_f32 v[72:73], v[72:73], v[62:63], v[92:93] op_sel:[1,1,0] op_sel_hi:[1,0,1] neg_lo:[1,0,0]
    v_cvt_pk_bf16_f32 v98, v70, v71
    v_cvt_pk_bf16_f32 v99, v72, v73
    s_waitcnt lgkmcnt(5)
    v_mfma_f32_16x16x32_bf16 v[174:177], v[124:127], v[108:111], v[174:177]
    ds_write2_b32 v9, v98, v99 offset0:136 offset1:204
    v_pk_mul_f32 v[90:91], v[70:71], v[62:63] op_sel:[0,0] op_sel_hi:[0,1]
    v_pk_fma_f32 v[70:71], v[70:71], v[62:63], v[90:91] op_sel:[1,1,0] op_sel_hi:[1,0,1] neg_lo:[1,0,0]
    v_cvt_pk_bf16_f32 v100, v70, v71
    ds_write_b32 v10, v100 offset:0
    s_waitcnt lgkmcnt(6)
    v_mfma_f32_16x16x32_bf16 v[174:177], v[128:131], v[112:115], v[174:177]
    s_waitcnt lgkmcnt(5)
    v_mfma_f32_16x16x32_bf16 v[174:177], v[132:135], v[116:119], v[174:177]
    ds_read_b128 v[120:123], v12 offset:0
    ds_read_b128 v[124:127], v12 offset:64
    ds_read_b128 v[128:131], v12 offset:128
    ds_read_b128 v[132:135], v12 offset:192
    s_sub_u32 s64, s52, 5
    s_mul_i32 s65, s64, 1552
    s_add_u32 s65, s65, 154112
    v_and_b32 v4, 15, v0
    v_lshrrev_b32 v5, 4, v0
    v_lshrrev_b32 v6, 1, v5
    v_and_b32 v7, 1, v5
    v_lshlrev_b32 v8, 8, v6
    v_lshl_add_u32 v8, v7, 3, v8
    v_lshl_add_u32 v8, v4, 4, v8
    v_add_u32 v8, s65, v8
    v_lshlrev_b32 v9, 7, v5
    v_lshl_add_u32 v9, v4, 3, v9
    v_add_u32 v10, 4, v9
    v_lshlrev_b32 v11, 7, v7
    v_lshl_add_u32 v11, v4, 2, v11
    v_add_u32 v11, 256, v11
    v_add_u32 v12, 64, v11
    v_cmp_lt_u32 vcc, 1, v5
    v_lshlrev_b32 v13, 7, v5
    v_lshl_add_u32 v13, v4, 1, v13
    v_cndmask_b32 v9, v9, v11, vcc
    v_cndmask_b32 v10, v10, v12, vcc
    s_waitcnt lgkmcnt(3)
    v_mfma_f32_16x16x32_bf16 v[178:181], v[120:123], v[104:107], v[178:181]
    v_add_u32 v13, s65, v13
    v_add_u32 v9, s65, v9
    v_add_u32 v10, s65, v10
    v_mov_b32 v2, 0
    v_mov_b32 v3, 0
    s_waitcnt lgkmcnt(2)
    v_mfma_f32_16x16x32_bf16 v[178:181], v[124:127], v[108:111], v[178:181]
    v_mov_b32 v4, s65
    s_waitcnt lgkmcnt(1)
    v_mfma_f32_16x16x32_bf16 v[178:181], v[128:131], v[112:115], v[178:181]
    s_waitcnt lgkmcnt(0)
    v_mfma_f32_16x16x32_bf16 v[178:181], v[132:135], v[116:119], v[178:181]
    s_sub_u32 s62, s52, 5
    s_add_u32 s62, s62, s58
    s_cmp_eq_u32 s52, 7
    s_cselect_b32 s62, s59, s62
    s_and_b32 s62, s62, 1
    s_lshl_b32 s62, s62, 4
    s_lshr_b32 s77, s77, s62
    s_lshl_b32 s77, s77, 16
    s_mov_b64 exec, 1
    v_add_f32 v170, s77, v170
    s_mov_b64 exec, -1
    v_cvt_pk_bf16_f32 v98, v170, v171
    v_cvt_pk_bf16_f32 v99, v172, v173
    v_cvt_pk_bf16_f32 v100, v174, v175
    v_cvt_pk_bf16_f32 v101, v176, v177
    v_cvt_pk_bf16_f32 v102, v178, v179
    v_cvt_pk_bf16_f32 v103, v180, v181
    ds_write_b64 v4, v[2:3]
    ds_write_b64 v8, v[98:99] offset:8
    ds_write_b32 v9, v100 offset:520
    ds_write_b32 v10, v101 offset:520
    ds_write_b16 v13, v102 offset:1032
    ds_write_b16_d16_hi v13, v102 offset:1064
    ds_write_b16 v13, v103 offset:1096
    ds_write_b16_d16_hi v13, v103 offset:1128
    s_branch L_k_done
L_cut_q_main:
    s_mov_b32 s69, 0
L_ev_2:
    ds_read_b32 v2, v249 offset:32
    s_add_u32 s69, s69, 1
    s_waitcnt lgkmcnt(0)
    v_cmp_eq_u32 vcc, v2, v15
    s_cmp_ge_u32 s69, 1000000
    s_cbranch_scc1 L_evd_2
    s_nop 1
    s_and_b32 s62, vcc_lo, 15
    s_cmp_eq_u32 s62, 15
    s_cbranch_scc1 L_evd_2
    s_sleep 1
    s_branch L_ev_2
L_evd_2:
    s_lshr_b32 s62, s56, 1
    s_and_b32 s63, s52, 2
    s_add_u32 s62, s62, s63
    s_add_u32 s62, s62, 0
    s_and_b32 s62, s62, 3
    s_lshl_b32 s62, s62, 11
    s_add_u32 s63, s62, 40960
    v_add_u32 v2, s62, v246
    v_add_u32 v3, s62, v247
    v_add_u32 v4, s63, v246
    v_add_u32 v5, s63, v247
    ds_read_b128 v[32:35], v2 offset:0
    ds_read_b128 v[36:39], v3 offset:0
    ds_read_b128 v[40:43], v2 offset:8192
    ds_read_b128 v[44:47], v3 offset:8192
    ds_read_b128 v[48:51], v2 offset:16384
    ds_read_b128 v[52:55], v3 offset:16384
    ds_read_b128 v[56:59], v2 offset:24576
    ds_read_b128 v[60:63], v3 offset:24576
    ds_read_b128 v[64:67], v2 offset:32768
    ds_read_b128 v[68:71], v3 offset:32768
    ds_read_b128 v[72:75], v4 offset:0
    ds_read_b128 v[76:79], v5 offset:0
    ds_read_b128 v[80:83], v4 offset:8192
    ds_read_b128 v[84:87], v5 offset:8192
    ds_read_b128 v[88:91], v4 offset:16384
    ds_read_b128 v[92:95], v5 offset:16384
    ds_read_b128 v[16:19], v4 offset:24576
    ds_read_b128 v[20:23], v5 offset:24576
    ds_read_b128 v[24:27], v4 offset:32768
    ds_read_b128 v[28:31], v5 offset:32768
    s_lshr_b32 s62, s56, 1
    s_and_b32 s63, s52, 2
    s_add_u32 s62, s62, s63
    s_add_u32 s62, s62, 1
    s_and_b32 s62, s62, 3
    s_lshl_b32 s62, s62, 11
    s_add_u32 s63, s62, 40960
    v_add_u32 v2, s62, v246
    v_add_u32 v3, s62, v247
    v_add_u32 v4, s63, v246
    v_add_u32 v5, s63, v247
    ds_read_b128 v[96:99], v2 offset:0
    ds_read_b128 v[100:103], v3 offset:0
    ds_read_b128 v[104:107], v2 offset:8192
    ds_read_b128 v[108:111], v3 offset:8192
    ds_read_b128 v[112:115], v2 offset:16384
    ds_read_b128 v[116:119], v3 offset:16384
    ds_read_b128 v[120:123], v2 offset:24576
    ds_read_b128 v[124:127], v3 offset:24576
    ds_read_b128 v[128:131], v2 offset:32768
    ds_read_b128 v[132:135], v3 offset:32768
    ds_read_b128 v[136:139], v4 offset:0
    ds_read_b128 v[140:143], v5 offset:0
    ds_read_b128 v[160:163], v4 offset:8192
    ds_read_b128 v[164:167], v5 offset:8192
    ds_read_b128 v[168:171], v4 offset:16384
    ds_read_b128 v[172:175], v5 offset:16384
    ds_read_b128 v[144:147], v4 offset:24576
    ds_read_b128 v[148:151], v5 offset:24576
    ds_read_b128 v[152:155], v4 offset:32768
    ds_read_b128 v[156:159], v5 offset:32768
    s_waitcnt vmcnt(0) lgkmcnt(0)
    s_mov_b64 exec, 1
    ds_write_b32 v248, v15 offset:64
    s_mov_b64 exec, -1
    s_cmp_lg_u32 s52, 0
    s_cbranch_scc1 L_q_nokv0
    s_mov_b32 s69, 0
L_ev_3:
    ds_read_b32 v2, v249 offset:64
    s_add_u32 s69, s69, 1
    s_waitcnt lgkmcnt(0)
    v_cmp_eq_u32 vcc, v2, v15
    s_cmp_ge_u32 s69, 1000000
    s_cbranch_scc1 L_evd_3
    s_nop 1
    s_and_b32 s62, vcc_lo, 15
    s_cmp_eq_u32 s62, 15
    s_cbranch_scc1 L_evd_3
    s_sleep 1
    s_branch L_ev_3
L_evd_3:
    v_lshlrev_b32 v3, 10, v0
    s_lshl_b32 s62, s2, 2
    s_add_u32 s62, s62, 8192
    s_mov_b64 exec, 0xff
    buffer_store_dword v15, v3, s[44:47], s62 offen sc1
    s_mov_b64 exec, -1
    s_branch L_q_go
L_q_nokv0:
    s_mov_b32 s69, 0
L_ev_4:
    ds_read_b32 v2, v249 offset:64
    s_add_u32 s69, s69, 1
    s_waitcnt lgkmcnt(0)
    v_cmp_eq_u32 vcc, v2, v15
    s_cmp_ge_u32 s69, 1000000
    s_cbranch_scc1 L_evd_4
    s_nop 1
    s_and_b32 s62, vcc_lo, 15
    s_cmp_eq_u32 s62, 15
    s_cbranch_scc1 L_evd_4
    s_sleep 1
    s_branch L_ev_4
L_evd_4:
L_q_go:
    s_setprio 2
    s_bitcmp1_b32 s52, 0
    s_cbranch_scc1 L_q_three
    s_mov_b32 s40, s6
    s_mov_b32 s41, s7
    s_mov_b32 s42, 819200
    s_mov_b32 s43, 0x00020000
    s_lshl_b32 s90, s52, 10
    s_add_u32 s90, s90, 0
    s_mul_i32 s91, s56, 160
    s_add_u32 s91, s91, 0
    s_lshr_b32 s64, s52, 1
    s_add_u32 s64, s64, 0
    s_mul_i32 s92, s64, 5120
    s_add_u32 s92, s92, 4096
    s_mul_i32 s93, s64, 40960
    s_mul_i32 s64, s56, 160
    s_add_u32 s93, s93, s64
    v_add_u32 v6, 51200, v14
    ds_read_b64_tr_b16 v[176:177], v6 offset:30720
    ds_read_b64_tr_b16 v[178:179], v6 offset:32000
    ds_read_b64_tr_b16 v[180:181], v6 offset:30752
    ds_read_b64_tr_b16 v[182:183], v6 offset:32032
    s_waitcnt lgkmcnt(2)
    v_mfma_f32_16x16x32_bf16 v[200:203], v[176:179], v[16:19], 0
    s_mov_b32 m0, s90
    s_add_u32 s90, s90, 5120
    buffer_load_dwordx4 v245, s[40:43], s91 offen lds
    s_add_u32 s91, s91, 40960
    v_mfma_f32_16x16x32_bf16 v[212:215], v[176:179], v[144:147], 0
    ds_read_b64_tr_b16 v[188:189], v6 offset:35840
    ds_read_b64_tr_b16 v[190:191], v6 offset:37120
    s_waitcnt lgkmcnt(2)
    v_mfma_f32_16x16x32_bf16 v[204:207], v[180:183], v[16:19], 0
    s_mov_b32 m0, s90
    s_add_u32 s90, s90, 5120
    buffer_load_dwordx4 v245, s[40:43], s91 offen lds
    s_add_u32 s91, s91, 40960
    v_mfma_f32_16x16x32_bf16 v[216:219], v[180:183], v[144:147], 0
    ds_read_b64_tr_b16 v[192:193], v6 offset:35872
    ds_read_b64_tr_b16 v[194:195], v6 offset:37152
    s_waitcnt lgkmcnt(2)
    v_mfma_f32_16x16x32_bf16 v[200:203], v[188:191], v[20:23], v[200:203]
    s_mov_b32 m0, s92
    s_add_u32 s92, s92, 10240
    buffer_load_dwordx4 v8, s[40:43], s93 offen lds
    s_add_u32 s93, s93, 81920
    v_mfma_f32_16x16x32_bf16 v[212:215], v[188:191], v[148:151], v[212:215]
    ds_read_b64_tr_b16 v[176:177], v6 offset:40960
    ds_read_b64_tr_b16 v[178:179], v6 offset:42240
    s_waitcnt lgkmcnt(2)
    v_mfma_f32_16x16x32_bf16 v[204:207], v[192:195], v[20:23], v[204:207]
    s_mov_b32 m0, s90
    s_add_u32 s90, s90, 5120
    buffer_load_dwordx4 v245, s[40:43], s91 offen lds
    s_add_u32 s91, s91, 40960
    v_mfma_f32_16x16x32_bf16 v[216:219], v[192:195], v[148:151], v[216:219]
    ds_read_b64_tr_b16 v[180:181], v6 offset:40992
    ds_read_b64_tr_b16 v[182:183], v6 offset:42272
    s_waitcnt lgkmcnt(2)
    v_mfma_f32_16x16x32_bf16 v[200:203], v[176:179], v[24:27], v[200:203]
    s_mov_b32 m0, s90
    s_add_u32 s90, s90, 5120
    buffer_load_dwordx4 v245, s[40:43], s91 offen lds
    s_add_u32 s91, s91, 40960
    v_mfma_f32_16x16x32_bf16 v[212:215], v[176:179], v[152:155], v[212:215]
    ds_read_b64_tr_b16 v[188:189], v6 offset:46080
    ds_read_b64_tr_b16 v[190:191], v6 offset:47360
    s_waitcnt lgkmcnt(2)
    v_mfma_f32_16x16x32_bf16 v[204:207], v[180:183], v[24:27], v[204:207]
    s_mov_b32 m0, s92
    s_add_u32 s92, s92, 10240
    buffer_load_dwordx4 v8, s[40:43], s93 offen lds
    s_add_u32 s93, s93, 81920
    v_mfma_f32_16x16x32_bf16 v[216:219], v[180:183], v[152:155], v[216:219]
    ds_read_b64_tr_b16 v[192:193], v6 offset:46112
    ds_read_b64_tr_b16 v[194:195], v6 offset:47392
    s_waitcnt lgkmcnt(2)
    v_mfma_f32_16x16x32_bf16 v[200:203], v[188:191], v[28:31], v[200:203]
    v_mfma_f32_16x16x32_bf16 v[212:215], v[188:191], v[156:159], v[212:215]
    s_waitcnt lgkmcnt(0)
    v_mfma_f32_16x16x32_bf16 v[204:207], v[192:195], v[28:31], v[204:207]
    v_mfma_f32_16x16x32_bf16 v[216:219], v[192:195], v[156:159], v[216:219]
    s_waitcnt lgkmcnt(0)
    s_mov_b64 exec, 1
    ds_write_b32 v248, v15 offset:256
    s_mov_b64 exec, -1
    s_mov_b32 m0, s90
    s_add_u32 s90, s90, 5120
    buffer_load_dwordx4 v245, s[40:43], s91 offen lds
    s_add_u32 s91, s91, 40960
    s_mov_b32 m0, s90
    s_add_u32 s90, s90, 5120
    buffer_load_dwordx4 v245, s[40:43], s91 offen lds
    s_add_u32 s91, s91, 40960
    s_mov_b32 m0, s92
    s_add_u32 s92, s92, 10240
    buffer_load_dwordx4 v8, s[40:43], s93 offen lds
    s_add_u32 s93, s93, 81920
    s_mov_b32 m0, s90
    s_add_u32 s90, s90, 5120
    buffer_load_dwordx4 v245, s[40:43], s91 offen lds
    s_add_u32 s91, s91, 40960
    s_mov_b32 m0, s90
    s_add_u32 s90, s90, 5120
    buffer_load_dwordx4 v245, s[40:43], s91 offen lds
    s_add_u32 s91, s91, 40960
    s_mov_b32 m0, s92
    s_add_u32 s92, s92, 10240
    buffer_load_dwordx4 v8, s[40:43], s93 offen lds
    s_add_u32 s93, s93, 81920
    s_mov_b32 m0, s90
    s_add_u32 s90, s90, 5120
    buffer_load_dwordx4 v245, s[40:43], s91 offen lds
    s_add_u32 s91, s91, 40960
    s_mov_b32 m0, s90
    s_add_u32 s90, s90, 5120
    buffer_load_dwordx4 v245, s[40:43], s91 offen lds
    s_add_u32 s91, s91, 40960
    s_mov_b32 m0, s92
    s_add_u32 s92, s92, 10240
    buffer_load_dwordx4 v8, s[40:43], s93 offen lds
    s_add_u32 s93, s93, 81920
    s_mov_b32 m0, s90
    s_add_u32 s90, s90, 5120
    buffer_load_dwordx4 v245, s[40:43], s91 offen lds
    s_add_u32 s91, s91, 40960
    s_mov_b32 m0, s90
    s_add_u32 s90, s90, 5120
    buffer_load_dwordx4 v245, s[40:43], s91 offen lds
    s_add_u32 s91, s91, 40960
    s_mov_b32 m0, s92
    s_add_u32 s92, s92, 10240
    buffer_load_dwordx4 v8, s[40:43], s93 offen lds
    s_add_u32 s93, s93, 81920
    s_mov_b32 m0, s90
    s_add_u32 s90, s90, 5120
    buffer_load_dwordx4 v245, s[40:43], s91 offen lds
    s_add_u32 s91, s91, 40960
    s_mov_b32 m0, s90
    s_add_u32 s90, s90, 5120
    buffer_load_dwordx4 v245, s[40:43], s91 offen lds
    s_add_u32 s91, s91, 40960
    s_mov_b32 m0, s92
    s_add_u32 s92, s92, 10240
    buffer_load_dwordx4 v8, s[40:43], s93 offen lds
    s_add_u32 s93, s93, 81920
    s_mov_b32 m0, s90
    s_add_u32 s90, s90, 5120
    buffer_load_dwordx4 v245, s[40:43], s91 offen lds
    s_add_u32 s91, s91, 40960
    s_mov_b32 m0, s90
    s_add_u32 s90, s90, 5120
    buffer_load_dwordx4 v245, s[40:43], s91 offen lds
    s_add_u32 s91, s91, 40960
    s_mov_b32 m0, s92
    s_add_u32 s92, s92, 10240
    buffer_load_dwordx4 v8, s[40:43], s93 offen lds
    s_add_u32 s93, s93, 81920
    s_mul_i32 s62, s71, 5120
    v_add_u32 v153, s62, v1
    v_lshl_add_u32 v154, v0, 3, s62
    v_and_b32 v2, 31, v0
    v_lshrrev_b32 v3, 5, v0
    v_mul_u32_u24 v3, 320, v3
    v_lshl_add_u32 v2, v2, 4, v3
    v_add_u32 v155, s62, v2
    v_mov_b32 v152, 0xdddd
    v_mov_b32 v144, 0
    v_mov_b32 v145, 0
    v_mov_b32 v146, 0
    v_mov_b32 v147, 0
    v_mov_b32 v148, 0
    v_mov_b32 v149, 0
    v_mov_b32 v150, 0
    v_mov_b32 v151, 0
    s_mov_b32 exec_lo, 0x00100000
    s_mov_b32 exec_hi, 0x00100000
    v_mov_b32 v144, 0x3f803f80
    v_mov_b32 v145, 0x3f803f80
    v_mov_b32 v146, 0x3f803f80
    v_mov_b32 v147, 0x3f803f80
    v_mov_b32 v148, 0x3f803f80
    v_mov_b32 v149, 0x3f803f80
    v_mov_b32 v150, 0x3f803f80
    v_mov_b32 v151, 0x3f803f80
    s_mov_b64 exec, -1
    s_waitcnt vmcnt(12)
    s_mov_b64 exec, 1
    ds_write_b32 v248, v15 offset:96
    s_mov_b64 exec, -1
    s_mov_b32 s69, 0
L_ev_5:
    ds_read_b32 v2, v249 offset:96
    s_add_u32 s69, s69, 1
    s_waitcnt lgkmcnt(0)
    v_cmp_eq_u32 vcc, v2, v15
    s_cmp_ge_u32 s69, 1000000
    s_cbranch_scc1 L_evd_5
    s_nop 1
    s_and_b32 s62, vcc_lo, 15
    s_cmp_eq_u32 s62, 15
    s_cbranch_scc1 L_evd_5
    s_sleep 1
    s_branch L_ev_5
L_evd_5:
    s_cmp_lg_u32 s52, 2
    s_cbranch_scc1 L_q_nopoll
    s_lshl_b32 s62, s53, 10
    s_add_u32 s62, s62, 8192
    v_add_u32 v7, s62, v1
    buffer_load_dwordx4 v[220:223], v7, s[44:47], 0 offen sc1
L_q_nopoll:
    ds_read_b64_tr_b16 v[176:177], v14 offset:0
    ds_read_b64_tr_b16 v[178:179], v14 offset:1280
    ds_read_b64_tr_b16 v[180:181], v14 offset:32
    ds_read_b64_tr_b16 v[182:183], v14 offset:1312
    ds_read_b64_tr_b16 v[188:189], v14 offset:5120
    ds_read_b64_tr_b16 v[190:191], v14 offset:6400
    ds_read_b64_tr_b16 v[192:193], v14 offset:5152
    ds_read_b64_tr_b16 v[194:195], v14 offset:6432
    s_waitcnt lgkmcnt(6)
    v_mfma_f32_16x16x32_bf16 v[200:203], v[176:179], v[32:35], v[200:203]
    v_mfma_f32_16x16x32_bf16 v[212:215], v[176:179], v[96:99], v[212:215]
    ds_read_b64_tr_b16 v[16:17], v14 offset:10240
    ds_read_b64_tr_b16 v[18:19], v14 offset:11520
    s_waitcnt lgkmcnt(6)
    v_mfma_f32_16x16x32_bf16 v[204:207], v[180:183], v[32:35], v[204:207]
    v_mfma_f32_16x16x32_bf16 v[216:219], v[180:183], v[96:99], v[216:219]
    ds_read_b64_tr_b16 v[20:21], v14 offset:10272
    ds_read_b64_tr_b16 v[22:23], v14 offset:11552
    s_waitcnt lgkmcnt(6)
    v_mfma_f32_16x16x32_bf16 v[200:203], v[188:191], v[36:39], v[200:203]
    v_mfma_f32_16x16x32_bf16 v[212:215], v[188:191], v[100:103], v[212:215]
    ds_read_b64_tr_b16 v[176:177], v14 offset:15360
    ds_read_b64_tr_b16 v[178:179], v14 offset:16640
    s_waitcnt lgkmcnt(6)
    v_mfma_f32_16x16x32_bf16 v[204:207], v[192:195], v[36:39], v[204:207]
    v_mfma_f32_16x16x32_bf16 v[216:219], v[192:195], v[100:103], v[216:219]
    ds_read_b64_tr_b16 v[180:181], v14 offset:15392
    ds_read_b64_tr_b16 v[182:183], v14 offset:16672
    s_waitcnt lgkmcnt(6)
    v_mfma_f32_16x16x32_bf16 v[200:203], v[16:19], v[40:43], v[200:203]
    v_mfma_f32_16x16x32_bf16 v[212:215], v[16:19], v[104:107], v[212:215]
    ds_read_b64_tr_b16 v[188:189], v14 offset:20480
    ds_read_b64_tr_b16 v[190:191], v14 offset:21760
    s_waitcnt lgkmcnt(6)
    v_mfma_f32_16x16x32_bf16 v[204:207], v[20:23], v[40:43], v[204:207]
    v_mfma_f32_16x16x32_bf16 v[216:219], v[20:23], v[104:107], v[216:219]
    ds_read_b64_tr_b16 v[192:193], v14 offset:20512
    ds_read_b64_tr_b16 v[194:195], v14 offset:21792
    s_waitcnt lgkmcnt(6)
    v_mfma_f32_16x16x32_bf16 v[200:203], v[176:179], v[44:47], v[200:203]
    v_mfma_f32_16x16x32_bf16 v[212:215], v[176:179], v[108:111], v[212:215]
    ds_read_b64_tr_b16 v[16:17], v14 offset:25600
    ds_read_b64_tr_b16 v[18:19], v14 offset:26880
    s_waitcnt lgkmcnt(6)
    v_mfma_f32_16x16x32_bf16 v[204:207], v[180:183], v[44:47], v[204:207]
    v_mfma_f32_16x16x32_bf16 v[216:219], v[180:183], v[108:111], v[216:219]
    ds_read_b64_tr_b16 v[20:21], v14 offset:25632
    ds_read_b64_tr_b16 v[22:23], v14 offset:26912
    s_waitcnt lgkmcnt(6)
    v_mfma_f32_16x16x32_bf16 v[200:203], v[188:191], v[48:51], v[200:203]
    v_mfma_f32_16x16x32_bf16 v[212:215], v[188:191], v[112:115], v[212:215]
    ds_read_b64_tr_b16 v[176:177], v14 offset:30720
    ds_read_b64_tr_b16 v[178:179], v14 offset:32000
    s_waitcnt lgkmcnt(6)
    v_mfma_f32_16x16x32_bf16 v[204:207], v[192:195], v[48:51], v[204:207]
    v_mfma_f32_16x16x32_bf16 v[216:219], v[192:195], v[112:115], v[216:219]
    ds_read_b64_tr_b16 v[180:181], v14 offset:30752
    ds_read_b64_tr_b16 v[182:183], v14 offset:32032
    s_waitcnt lgkmcnt(6)
    v_mfma_f32_16x16x32_bf16 v[200:203], v[16:19], v[52:55], v[200:203]
    v_mfma_f32_16x16x32_bf16 v[212:215], v[16:19], v[116:119], v[212:215]
    ds_read_b64_tr_b16 v[188:189], v14 offset:35840
    ds_read_b64_tr_b16 v[190:191], v14 offset:37120
    s_waitcnt lgkmcnt(6)
    v_mfma_f32_16x16x32_bf16 v[204:207], v[20:23], v[52:55], v[204:207]
    v_mfma_f32_16x16x32_bf16 v[216:219], v[20:23], v[116:119], v[216:219]
    ds_read_b64_tr_b16 v[192:193], v14 offset:35872
    ds_read_b64_tr_b16 v[194:195], v14 offset:37152
    s_waitcnt lgkmcnt(6)
    v_mfma_f32_16x16x32_bf16 v[200:203], v[176:179], v[56:59], v[200:203]
    v_mfma_f32_16x16x32_bf16 v[212:215], v[176:179], v[120:123], v[212:215]
    s_waitcnt lgkmcnt(4)
    v_mfma_f32_16x16x32_bf16 v[204:207], v[180:183], v[56:59], v[204:207]
    v_mfma_f32_16x16x32_bf16 v[216:219], v[180:183], v[120:123], v[216:219]
    s_waitcnt lgkmcnt(2)
    v_mfma_f32_16x16x32_bf16 v[200:203], v[188:191], v[60:63], v[200:203]
    v_mfma_f32_16x16x32_bf16 v[212:215], v[188:191], v[124:127], v[212:215]
    s_waitcnt lgkmcnt(0)
    v_mfma_f32_16x16x32_bf16 v[204:207], v[192:195], v[60:63], v[204:207]
    v_mfma_f32_16x16x32_bf16 v[216:219], v[192:195], v[124:127], v[216:219]
    s_waitcnt vmcnt(0)
    s_cmp_lg_u32 s52, 2
    s_cbranch_scc1 L_q_kvok
    s_mov_b32 s69, 0
    s_branch L_pollc_kv
L_poll_kv:
    buffer_load_dwordx4 v[220:223], v7, s[44:47], 0 offen sc1
    s_waitcnt vmcnt(0)
L_pollc_kv:
    v_xor_b32 v220, s57, v220
    v_xor_b32 v221, s57, v221
    v_xor_b32 v222, s57, v222
    v_xor_b32 v223, s57, v223
    v_or_b32 v220, v220, v221
    v_or3_b32 v220, v220, v222, v223
    v_cmp_ne_u32 vcc, 0, v220
    s_add_u32 s69, s69, 1
    s_nop 2
    s_cmp_eq_u64 vcc, 0
    s_cbranch_scc1 L_polld_kv
    s_cmp_lt_u32 s69, 1000000
    s_cbranch_scc1 L_poll_kv
L_polld_kv:
L_q_kvok:
    s_mov_b64 exec, 1
    ds_write_b32 v248, v15 offset:128
    s_mov_b64 exec, -1
    s_mov_b32 s69, 0
L_ev_6:
    ds_read_b32 v2, v249 offset:128
    s_add_u32 s69, s69, 1
    s_waitcnt lgkmcnt(0)
    v_cmp_eq_u32 vcc, v2, v15
    s_cmp_ge_u32 s69, 1000000
    s_cbranch_scc1 L_evd_6
    s_nop 1
    s_and_b32 s62, vcc_lo, 255
    s_cmp_eq_u32 s62, 255
    s_cbranch_scc1 L_evd_6
    s_sleep 1
    s_branch L_ev_6
L_evd_6:
    s_lshl_b32 s90, s52, 10
    s_add_u32 s91, s90, 65536
    ds_read_b64_tr_b16 v[176:177], v14 offset:40960
    ds_read_b64_tr_b16 v[178:179], v14 offset:42240
    ds_read_b64_tr_b16 v[180:181], v14 offset:40992
    ds_read_b64_tr_b16 v[182:183], v14 offset:42272
    ds_read_b64_tr_b16 v[188:189], v14 offset:46080
    ds_read_b64_tr_b16 v[190:191], v14 offset:47360
    ds_read_b64_tr_b16 v[192:193], v14 offset:46112
    ds_read_b64_tr_b16 v[194:195], v14 offset:47392
    s_waitcnt lgkmcnt(6)
    v_mfma_f32_16x16x32_bf16 v[200:203], v[176:179], v[64:67], v[200:203]
    s_mov_b32 m0, s90
    s_add_u32 s90, s90, 4096
    buffer_load_dwordx4 v1, s[44:47], s91 offen sc1 lds
    s_add_u32 s91, s91, 4096
    v_mfma_f32_16x16x32_bf16 v[212:215], v[176:179], v[128:131], v[212:215]
    ds_read_b64_tr_b16 v[16:17], v6 offset:0
    ds_read_b64_tr_b16 v[18:19], v6 offset:1280
    s_waitcnt lgkmcnt(6)
    v_mfma_f32_16x16x32_bf16 v[204:207], v[180:183], v[64:67], v[204:207]
    s_mov_b32 m0, s90
    s_add_u32 s90, s90, 4096
    buffer_load_dwordx4 v1, s[44:47], s91 offen sc1 lds
    s_add_u32 s91, s91, 4096
    v_mfma_f32_16x16x32_bf16 v[216:219], v[180:183], v[128:131], v[216:219]
    ds_read_b64_tr_b16 v[20:21], v6 offset:32
    ds_read_b64_tr_b16 v[22:23], v6 offset:1312
    s_waitcnt lgkmcnt(6)
    v_mfma_f32_16x16x32_bf16 v[200:203], v[188:191], v[68:71], v[200:203]
    s_mov_b32 m0, s90
    s_add_u32 s90, s90, 4096
    buffer_load_dwordx4 v1, s[44:47], s91 offen sc1 lds
    s_add_u32 s91, s91, 4096
    v_mfma_f32_16x16x32_bf16 v[212:215], v[188:191], v[132:135], v[212:215]
    ds_read_b64_tr_b16 v[176:177], v6 offset:5120
    ds_read_b64_tr_b16 v[178:179], v6 offset:6400
    s_waitcnt lgkmcnt(6)
    v_mfma_f32_16x16x32_bf16 v[204:207], v[192:195], v[68:71], v[204:207]
    s_mov_b32 m0, s90
    s_add_u32 s90, s90, 4096
    buffer_load_dwordx4 v1, s[44:47], s91 offen sc1 lds
    s_add_u32 s91, s91, 4096
    v_mfma_f32_16x16x32_bf16 v[216:219], v[192:195], v[132:135], v[216:219]
    ds_read_b64_tr_b16 v[180:181], v6 offset:5152
    ds_read_b64_tr_b16 v[182:183], v6 offset:6432
    s_waitcnt lgkmcnt(6)
    v_mfma_f32_16x16x32_bf16 v[200:203], v[16:19], v[72:75], v[200:203]
    s_mov_b32 m0, s90
    s_add_u32 s90, s90, 4096
    buffer_load_dwordx4 v1, s[44:47], s91 offen sc1 lds
    s_add_u32 s91, s91, 4096
    v_mfma_f32_16x16x32_bf16 v[212:215], v[16:19], v[136:139], v[212:215]
    ds_read_b64_tr_b16 v[188:189], v6 offset:10240
    ds_read_b64_tr_b16 v[190:191], v6 offset:11520
    s_waitcnt lgkmcnt(6)
    v_mfma_f32_16x16x32_bf16 v[204:207], v[20:23], v[72:75], v[204:207]
    s_mov_b32 m0, s90
    s_add_u32 s90, s90, 4096
    buffer_load_dwordx4 v1, s[44:47], s91 offen sc1 lds
    s_add_u32 s91, s91, 4096
    v_mfma_f32_16x16x32_bf16 v[216:219], v[20:23], v[136:139], v[216:219]
    ds_read_b64_tr_b16 v[192:193], v6 offset:10272
    ds_read_b64_tr_b16 v[194:195], v6 offset:11552
    s_waitcnt lgkmcnt(6)
    v_mfma_f32_16x16x32_bf16 v[200:203], v[176:179], v[76:79], v[200:203]
    s_mov_b32 m0, s90
    s_add_u32 s90, s90, 4096
    buffer_load_dwordx4 v1, s[44:47], s91 offen sc1 lds
    s_add_u32 s91, s91, 4096
    v_mfma_f32_16x16x32_bf16 v[212:215], v[176:179], v[140:143], v[212:215]
    ds_read_b64_tr_b16 v[16:17], v6 offset:15360
    ds_read_b64_tr_b16 v[18:19], v6 offset:16640
    s_waitcnt lgkmcnt(6)
    v_mfma_f32_16x16x32_bf16 v[204:207], v[180:183], v[76:79], v[204:207]
    s_mov_b32 m0, s90
    s_add_u32 s90, s90, 4096
    buffer_load_dwordx4 v1, s[44:47], s91 offen sc1 lds
    s_add_u32 s91, s91, 4096
    v_mfma_f32_16x16x32_bf16 v[216:219], v[180:183], v[140:143], v[216:219]
    ds_read_b64_tr_b16 v[20:21], v6 offset:15392
    ds_read_b64_tr_b16 v[22:23], v6 offset:16672
    s_waitcnt lgkmcnt(6)
    v_mfma_f32_16x16x32_bf16 v[200:203], v[188:191], v[80:83], v[200:203]
    s_mov_b32 m0, s90
    s_add_u32 s90, s90, 4096
    buffer_load_dwordx4 v1, s[44:47], s91 offen sc1 lds
    s_add_u32 s91, s91, 4096
    v_mfma_f32_16x16x32_bf16 v[212:215], v[188:191], v[160:163], v[212:215]
    ds_read_b64_tr_b16 v[176:177], v6 offset:20480
    ds_read_b64_tr_b16 v[178:179], v6 offset:21760
    s_waitcnt lgkmcnt(6)
    v_mfma_f32_16x16x32_bf16 v[204:207], v[192:195], v[80:83], v[204:207]
    s_mov_b32 m0, s90
    s_add_u32 s90, s90, 4096
    buffer_load_dwordx4 v1, s[44:47], s91 offen sc1 lds
    s_add_u32 s91, s91, 4096
    v_mfma_f32_16x16x32_bf16 v[216:219], v[192:195], v[160:163], v[216:219]
    ds_read_b64_tr_b16 v[180:181], v6 offset:20512
    ds_read_b64_tr_b16 v[182:183], v6 offset:21792
    s_waitcnt lgkmcnt(6)
    v_mfma_f32_16x16x32_bf16 v[200:203], v[16:19], v[84:87], v[200:203]
    v_mfma_f32_16x16x32_bf16 v[212:215], v[16:19], v[164:167], v[212:215]
    ds_read_b64_tr_b16 v[188:189], v6 offset:25600
    ds_read_b64_tr_b16 v[190:191], v6 offset:26880
    s_waitcnt lgkmcnt(6)
    v_mfma_f32_16x16x32_bf16 v[204:207], v[20:23], v[84:87], v[204:207]
    v_mfma_f32_16x16x32_bf16 v[216:219], v[20:23], v[164:167], v[216:219]
    ds_read_b64_tr_b16 v[192:193], v6 offset:25632
    ds_read_b64_tr_b16 v[194:195], v6 offset:26912
    s_waitcnt lgkmcnt(6)
    v_mfma_f32_16x16x32_bf16 v[200:203], v[176:179], v[88:91], v[200:203]
    v_mfma_f32_16x16x32_bf16 v[212:215], v[176:179], v[168:171], v[212:215]
    s_waitcnt lgkmcnt(4)
    v_mfma_f32_16x16x32_bf16 v[204:207], v[180:183], v[88:91], v[204:207]
    v_mfma_f32_16x16x32_bf16 v[216:219], v[180:183], v[168:171], v[216:219]
    s_waitcnt lgkmcnt(2)
    v_mfma_f32_16x16x32_bf16 v[200:203], v[188:191], v[92:95], v[200:203]
    v_mfma_f32_16x16x32_bf16 v[212:215], v[188:191], v[172:175], v[212:215]
    s_waitcnt lgkmcnt(0)
    v_mfma_f32_16x16x32_bf16 v[204:207], v[192:195], v[92:95], v[204:207]
    v_mfma_f32_16x16x32_bf16 v[216:219], v[192:195], v[172:175], v[216:219]
    s_setprio 3
    s_nop 7
    v_cvt_pk_bf16_f32 v200, v200, v201
    v_cvt_pk_bf16_f32 v201, v202, v203
    ds_write_b64 v13, v[200:201] offset:0
    v_cvt_pk_bf16_f32 v204, v204, v205
    v_cvt_pk_bf16_f32 v205, v206, v207
    ds_write_b64 v13, v[204:205] offset:32
    v_cvt_pk_bf16_f32 v212, v212, v213
    v_cvt_pk_bf16_f32 v213, v214, v215
    ds_write_b64 v13, v[212:213] offset:2560
    v_cvt_pk_bf16_f32 v216, v216, v217
    v_cvt_pk_bf16_f32 v217, v218, v219
    ds_write_b64 v13, v[216:217] offset:2592
    s_branch L_q_kv
L_q_three:
    s_mov_b32 s40, s6
    s_mov_b32 s41, s7
    s_mov_b32 s42, 819200
    s_mov_b32 s43, 0x00020000
    s_lshl_b32 s90, s52, 10
    s_add_u32 s90, s90, 0
    s_mul_i32 s91, s56, 160
    s_add_u32 s91, s91, 0
    v_add_u32 v6, 51200, v14
    ds_read_b64_tr_b16 v[176:177], v6 offset:30720
    ds_read_b64_tr_b16 v[178:179], v6 offset:32000
    ds_read_b64_tr_b16 v[180:181], v6 offset:30752
    ds_read_b64_tr_b16 v[182:183], v6 offset:32032
    ds_read_b64_tr_b16 v[184:185], v6 offset:30784
    ds_read_b64_tr_b16 v[186:187], v6 offset:32064
    s_waitcnt lgkmcnt(4)
    v_mfma_f32_16x16x32_bf16 v[200:203], v[176:179], v[16:19], 0
    s_mov_b32 m0, s90
    s_add_u32 s90, s90, 5120
    buffer_load_dwordx4 v245, s[40:43], s91 offen lds
    s_add_u32 s91, s91, 40960
    v_mfma_f32_16x16x32_bf16 v[212:215], v[176:179], v[144:147], 0
    ds_read_b64_tr_b16 v[188:189], v6 offset:35840
    ds_read_b64_tr_b16 v[190:191], v6 offset:37120
    s_waitcnt lgkmcnt(4)
    v_mfma_f32_16x16x32_bf16 v[204:207], v[180:183], v[16:19], 0
    s_mov_b32 m0, s90
    s_add_u32 s90, s90, 5120
    buffer_load_dwordx4 v245, s[40:43], s91 offen lds
    s_add_u32 s91, s91, 40960
    v_mfma_f32_16x16x32_bf16 v[216:219], v[180:183], v[144:147], 0
    ds_read_b64_tr_b16 v[192:193], v6 offset:35872
    ds_read_b64_tr_b16 v[194:195], v6 offset:37152
    s_waitcnt lgkmcnt(4)
    v_mfma_f32_16x16x32_bf16 v[208:211], v[184:187], v[16:19], 0
    s_mov_b32 m0, s90
    s_add_u32 s90, s90, 5120
    buffer_load_dwordx4 v245, s[40:43], s91 offen lds
    s_add_u32 s91, s91, 40960
    v_mfma_f32_16x16x32_bf16 v[220:223], v[184:187], v[144:147], 0
    ds_read_b64_tr_b16 v[196:197], v6 offset:35904
    ds_read_b64_tr_b16 v[198:199], v6 offset:37184
    s_waitcnt lgkmcnt(4)
    v_mfma_f32_16x16x32_bf16 v[200:203], v[188:191], v[20:23], v[200:203]
    s_mov_b32 m0, s90
    s_add_u32 s90, s90, 5120
    buffer_load_dwordx4 v245, s[40:43], s91 offen lds
    s_add_u32 s91, s91, 40960
    v_mfma_f32_16x16x32_bf16 v[212:215], v[188:191], v[148:151], v[212:215]
    ds_read_b64_tr_b16 v[176:177], v6 offset:40960
    ds_read_b64_tr_b16 v[178:179], v6 offset:42240
    s_waitcnt lgkmcnt(4)
    v_mfma_f32_16x16x32_bf16 v[204:207], v[192:195], v[20:23], v[204:207]
    s_mov_b32 m0, s90
    s_add_u32 s90, s90, 5120
    buffer_load_dwordx4 v245, s[40:43], s91 offen lds
    s_add_u32 s91, s91, 40960
    v_mfma_f32_16x16x32_bf16 v[216:219], v[192:195], v[148:151], v[216:219]
    ds_read_b64_tr_b16 v[180:181], v6 offset:40992
    ds_read_b64_tr_b16 v[182:183], v6 offset:42272
    s_waitcnt lgkmcnt(4)
    v_mfma_f32_16x16x32_bf16 v[208:211], v[196:199], v[20:23], v[208:211]
    s_mov_b32 m0, s90
    s_add_u32 s90, s90, 5120
    buffer_load_dwordx4 v245, s[40:43], s91 offen lds
    s_add_u32 s91, s91, 40960
    v_mfma_f32_16x16x32_bf16 v[220:223], v[196:199], v[148:151], v[220:223]
    ds_read_b64_tr_b16 v[184:185], v6 offset:41024
    ds_read_b64_tr_b16 v[186:187], v6 offset:42304
    s_waitcnt lgkmcnt(4)
    v_mfma_f32_16x16x32_bf16 v[200:203], v[176:179], v[24:27], v[200:203]
    v_mfma_f32_16x16x32_bf16 v[212:215], v[176:179], v[152:155], v[212:215]
    ds_read_b64_tr_b16 v[188:189], v6 offset:46080
    ds_read_b64_tr_b16 v[190:191], v6 offset:47360
    s_waitcnt lgkmcnt(4)
    v_mfma_f32_16x16x32_bf16 v[204:207], v[180:183], v[24:27], v[204:207]
    v_mfma_f32_16x16x32_bf16 v[216:219], v[180:183], v[152:155], v[216:219]
    ds_read_b64_tr_b16 v[192:193], v6 offset:46112
    ds_read_b64_tr_b16 v[194:195], v6 offset:47392
    s_waitcnt lgkmcnt(4)
    v_mfma_f32_16x16x32_bf16 v[208:211], v[184:187], v[24:27], v[208:211]
    v_mfma_f32_16x16x32_bf16 v[220:223], v[184:187], v[152:155], v[220:223]
    ds_read_b64_tr_b16 v[196:197], v6 offset:46144
    ds_read_b64_tr_b16 v[198:199], v6 offset:47424
    s_waitcnt lgkmcnt(4)
    v_mfma_f32_16x16x32_bf16 v[200:203], v[188:191], v[28:31], v[200:203]
    v_mfma_f32_16x16x32_bf16 v[212:215], v[188:191], v[156:159], v[212:215]
    s_waitcnt lgkmcnt(2)
    v_mfma_f32_16x16x32_bf16 v[204:207], v[192:195], v[28:31], v[204:207]
    v_mfma_f32_16x16x32_bf16 v[216:219], v[192:195], v[156:159], v[216:219]
    s_waitcnt lgkmcnt(0)
    v_mfma_f32_16x16x32_bf16 v[208:211], v[196:199], v[28:31], v[208:211]
    v_mfma_f32_16x16x32_bf16 v[220:223], v[196:199], v[156:159], v[220:223]
    s_waitcnt lgkmcnt(0)
    s_mov_b64 exec, 1
    ds_write_b32 v248, v15 offset:256
    s_mov_b64 exec, -1
    s_mov_b32 m0, s90
    s_add_u32 s90, s90, 5120
    buffer_load_dwordx4 v245, s[40:43], s91 offen lds
    s_add_u32 s91, s91, 40960
    s_mov_b32 m0, s90
    s_add_u32 s90, s90, 5120
    buffer_load_dwordx4 v245, s[40:43], s91 offen lds
    s_add_u32 s91, s91, 40960
    s_mov_b32 m0, s90
    s_add_u32 s90, s90, 5120
    buffer_load_dwordx4 v245, s[40:43], s91 offen lds
    s_add_u32 s91, s91, 40960
    s_mov_b32 m0, s90
    s_add_u32 s90, s90, 5120
    buffer_load_dwordx4 v245, s[40:43], s91 offen lds
    s_add_u32 s91, s91, 40960
    s_mov_b32 m0, s90
    s_add_u32 s90, s90, 5120
    buffer_load_dwordx4 v245, s[40:43], s91 offen lds
    s_add_u32 s91, s91, 40960
    s_mov_b32 m0, s90
    s_add_u32 s90, s90, 5120
    buffer_load_dwordx4 v245, s[40:43], s91 offen lds
    s_add_u32 s91, s91, 40960
    s_mov_b32 m0, s90
    s_add_u32 s90, s90, 5120
    buffer_load_dwordx4 v245, s[40:43], s91 offen lds
    s_add_u32 s91, s91, 40960
    s_mov_b32 m0, s90
    s_add_u32 s90, s90, 5120
    buffer_load_dwordx4 v245, s[40:43], s91 offen lds
    s_add_u32 s91, s91, 40960
    s_mov_b32 m0, s90
    s_add_u32 s90, s90, 5120
    buffer_load_dwordx4 v245, s[40:43], s91 offen lds
    s_add_u32 s91, s91, 40960
    s_mov_b32 m0, s90
    s_add_u32 s90, s90, 5120
    buffer_load_dwordx4 v245, s[40:43], s91 offen lds
    s_add_u32 s91, s91, 40960
    s_mul_i32 s62, s71, 5120
    v_add_u32 v153, s62, v1
    v_lshl_add_u32 v154, v0, 3, s62
    v_and_b32 v2, 31, v0
    v_lshrrev_b32 v3, 5, v0
    v_mul_u32_u24 v3, 320, v3
    v_lshl_add_u32 v2, v2, 4, v3
    v_add_u32 v155, s62, v2
    v_mov_b32 v152, 0xdddd
    v_mov_b32 v144, 0
    v_mov_b32 v145, 0
    v_mov_b32 v146, 0
    v_mov_b32 v147, 0
    v_mov_b32 v148, 0
    v_mov_b32 v149, 0
    v_mov_b32 v150, 0
    v_mov_b32 v151, 0
    s_mov_b32 exec_lo, 0x00100000
    s_mov_b32 exec_hi, 0x00100000
    v_mov_b32 v144, 0x3f803f80
    v_mov_b32 v145, 0x3f803f80
    v_mov_b32 v146, 0x3f803f80
    v_mov_b32 v147, 0x3f803f80
    v_mov_b32 v148, 0x3f803f80
    v_mov_b32 v149, 0x3f803f80
    v_mov_b32 v150, 0x3f803f80
    v_mov_b32 v151, 0x3f803f80
    s_mov_b64 exec, -1
    s_waitcnt vmcnt(8)
    s_mov_b64 exec, 1
    ds_write_b32 v248, v15 offset:96
    s_mov_b64 exec, -1
    s_mov_b32 s69, 0
L_ev_7:
    ds_read_b32 v2, v249 offset:96
    s_add_u32 s69, s69, 1
    s_waitcnt lgkmcnt(0)
    v_cmp_eq_u32 vcc, v2, v15
    s_cmp_ge_u32 s69, 1000000
    s_cbranch_scc1 L_evd_7
    s_nop 1
    s_and_b32 s62, vcc_lo, 15
    s_cmp_eq_u32 s62, 15
    s_cbranch_scc1 L_evd_7
    s_sleep 1
    s_branch L_ev_7
L_evd_7:
    ds_read_b64_tr_b16 v[176:177], v14 offset:0
    ds_read_b64_tr_b16 v[178:179], v14 offset:1280
    ds_read_b64_tr_b16 v[180:181], v14 offset:32
    ds_read_b64_tr_b16 v[182:183], v14 offset:1312
    ds_read_b64_tr_b16 v[184:185], v14 offset:64
    ds_read_b64_tr_b16 v[186:187], v14 offset:1344
    ds_read_b64_tr_b16 v[188:189], v14 offset:5120
    ds_read_b64_tr_b16 v[190:191], v14 offset:6400
    ds_read_b64_tr_b16 v[192:193], v14 offset:5152
    ds_read_b64_tr_b16 v[194:195], v14 offset:6432
    ds_read_b64_tr_b16 v[196:197], v14 offset:5184
    ds_read_b64_tr_b16 v[198:199], v14 offset:6464
    s_waitcnt lgkmcnt(10)
    v_mfma_f32_16x16x32_bf16 v[200:203], v[176:179], v[32:35], v[200:203]
    v_mfma_f32_16x16x32_bf16 v[212:215], v[176:179], v[96:99], v[212:215]
    ds_read_b64_tr_b16 v[16:17], v14 offset:10240
    ds_read_b64_tr_b16 v[18:19], v14 offset:11520
    s_waitcnt lgkmcnt(10)
    v_mfma_f32_16x16x32_bf16 v[204:207], v[180:183], v[32:35], v[204:207]
    v_mfma_f32_16x16x32_bf16 v[216:219], v[180:183], v[96:99], v[216:219]
    ds_read_b64_tr_b16 v[20:21], v14 offset:10272
    ds_read_b64_tr_b16 v[22:23], v14 offset:11552
    s_waitcnt lgkmcnt(10)
    v_mfma_f32_16x16x32_bf16 v[208:211], v[184:187], v[32:35], v[208:211]
    v_mfma_f32_16x16x32_bf16 v[220:223], v[184:187], v[96:99], v[220:223]
    ds_read_b64_tr_b16 v[24:25], v14 offset:10304
    ds_read_b64_tr_b16 v[26:27], v14 offset:11584
    s_waitcnt lgkmcnt(10)
    v_mfma_f32_16x16x32_bf16 v[200:203], v[188:191], v[36:39], v[200:203]
    v_mfma_f32_16x16x32_bf16 v[212:215], v[188:191], v[100:103], v[212:215]
    ds_read_b64_tr_b16 v[176:177], v14 offset:15360
    ds_read_b64_tr_b16 v[178:179], v14 offset:16640
    s_waitcnt lgkmcnt(10)
    v_mfma_f32_16x16x32_bf16 v[204:207], v[192:195], v[36:39], v[204:207]
    v_mfma_f32_16x16x32_bf16 v[216:219], v[192:195], v[100:103], v[216:219]
    ds_read_b64_tr_b16 v[180:181], v14 offset:15392
    ds_read_b64_tr_b16 v[182:183], v14 offset:16672
    s_waitcnt lgkmcnt(10)
    v_mfma_f32_16x16x32_bf16 v[208:211], v[196:199], v[36:39], v[208:211]
    v_mfma_f32_16x16x32_bf16 v[220:223], v[196:199], v[100:103], v[220:223]
    ds_read_b64_tr_b16 v[184:185], v14 offset:15424
    ds_read_b64_tr_b16 v[186:187], v14 offset:16704
    s_waitcnt lgkmcnt(10)
    v_mfma_f32_16x16x32_bf16 v[200:203], v[16:19], v[40:43], v[200:203]
    v_mfma_f32_16x16x32_bf16 v[212:215], v[16:19], v[104:107], v[212:215]
    ds_read_b64_tr_b16 v[188:189], v14 offset:20480
    ds_read_b64_tr_b16 v[190:191], v14 offset:21760
    s_waitcnt lgkmcnt(10)
    v_mfma_f32_16x16x32_bf16 v[204:207], v[20:23], v[40:43], v[204:207]
    v_mfma_f32_16x16x32_bf16 v[216:219], v[20:23], v[104:107], v[216:219]
    ds_read_b64_tr_b16 v[192:193], v14 offset:20512
    ds_read_b64_tr_b16 v[194:195], v14 offset:21792
    s_waitcnt lgkmcnt(10)
    v_mfma_f32_16x16x32_bf16 v[208:211], v[24:27], v[40:43], v[208:211]
    v_mfma_f32_16x16x32_bf16 v[220:223], v[24:27], v[104:107], v[220:223]
    ds_read_b64_tr_b16 v[196:197], v14 offset:20544
    ds_read_b64_tr_b16 v[198:199], v14 offset:21824
    s_waitcnt lgkmcnt(10)
    v_mfma_f32_16x16x32_bf16 v[200:203], v[176:179], v[44:47], v[200:203]
    v_mfma_f32_16x16x32_bf16 v[212:215], v[176:179], v[108:111], v[212:215]
    ds_read_b64_tr_b16 v[16:17], v14 offset:25600
    ds_read_b64_tr_b16 v[18:19], v14 offset:26880
    s_waitcnt lgkmcnt(10)
    v_mfma_f32_16x16x32_bf16 v[204:207], v[180:183], v[44:47], v[204:207]
    v_mfma_f32_16x16x32_bf16 v[216:219], v[180:183], v[108:111], v[216:219]
    ds_read_b64_tr_b16 v[20:21], v14 offset:25632
    ds_read_b64_tr_b16 v[22:23], v14 offset:26912
    s_waitcnt lgkmcnt(10)
    v_mfma_f32_16x16x32_bf16 v[208:211], v[184:187], v[44:47], v[208:211]
    v_mfma_f32_16x16x32_bf16 v[220:223], v[184:187], v[108:111], v[220:223]
    ds_read_b64_tr_b16 v[24:25], v14 offset:25664
    ds_read_b64_tr_b16 v[26:27], v14 offset:26944
    s_waitcnt lgkmcnt(10)
    v_mfma_f32_16x16x32_bf16 v[200:203], v[188:191], v[48:51], v[200:203]
    v_mfma_f32_16x16x32_bf16 v[212:215], v[188:191], v[112:115], v[212:215]
    ds_read_b64_tr_b16 v[176:177], v14 offset:30720
    ds_read_b64_tr_b16 v[178:179], v14 offset:32000
    s_waitcnt lgkmcnt(10)
    v_mfma_f32_16x16x32_bf16 v[204:207], v[192:195], v[48:51], v[204:207]
    v_mfma_f32_16x16x32_bf16 v[216:219], v[192:195], v[112:115], v[216:219]
    ds_read_b64_tr_b16 v[180:181], v14 offset:30752
    ds_read_b64_tr_b16 v[182:183], v14 offset:32032
    s_waitcnt lgkmcnt(10)
    v_mfma_f32_16x16x32_bf16 v[208:211], v[196:199], v[48:51], v[208:211]
    v_mfma_f32_16x16x32_bf16 v[220:223], v[196:199], v[112:115], v[220:223]
    ds_read_b64_tr_b16 v[184:185], v14 offset:30784
    ds_read_b64_tr_b16 v[186:187], v14 offset:32064
    s_waitcnt lgkmcnt(10)
    v_mfma_f32_16x16x32_bf16 v[200:203], v[16:19], v[52:55], v[200:203]
    v_mfma_f32_16x16x32_bf16 v[212:215], v[16:19], v[116:119], v[212:215]
    ds_read_b64_tr_b16 v[188:189], v14 offset:35840
    ds_read_b64_tr_b16 v[190:191], v14 offset:37120
    s_waitcnt lgkmcnt(10)
    v_mfma_f32_16x16x32_bf16 v[204:207], v[20:23], v[52:55], v[204:207]
    v_mfma_f32_16x16x32_bf16 v[216:219], v[20:23], v[116:119], v[216:219]
    ds_read_b64_tr_b16 v[192:193], v14 offset:35872
    ds_read_b64_tr_b16 v[194:195], v14 offset:37152
    s_waitcnt lgkmcnt(10)
    v_mfma_f32_16x16x32_bf16 v[208:211], v[24:27], v[52:55], v[208:211]
    v_mfma_f32_16x16x32_bf16 v[220:223], v[24:27], v[116:119], v[220:223]
    ds_read_b64_tr_b16 v[196:197], v14 offset:35904
    ds_read_b64_tr_b16 v[198:199], v14 offset:37184
    s_waitcnt lgkmcnt(10)
    v_mfma_f32_16x16x32_bf16 v[200:203], v[176:179], v[56:59], v[200:203]
    v_mfma_f32_16x16x32_bf16 v[212:215], v[176:179], v[120:123], v[212:215]
    s_waitcnt lgkmcnt(8)
    v_mfma_f32_16x16x32_bf16 v[204:207], v[180:183], v[56:59], v[204:207]
    v_mfma_f32_16x16x32_bf16 v[216:219], v[180:183], v[120:123], v[216:219]
    s_waitcnt lgkmcnt(6)
    v_mfma_f32_16x16x32_bf16 v[208:211], v[184:187], v[56:59], v[208:211]
    v_mfma_f32_16x16x32_bf16 v[220:223], v[184:187], v[120:123], v[220:223]
    s_waitcnt lgkmcnt(4)
    v_mfma_f32_16x16x32_bf16 v[200:203], v[188:191], v[60:63], v[200:203]
    v_mfma_f32_16x16x32_bf16 v[212:215], v[188:191], v[124:127], v[212:215]
    s_waitcnt lgkmcnt(2)
    v_mfma_f32_16x16x32_bf16 v[204:207], v[192:195], v[60:63], v[204:207]
    v_mfma_f32_16x16x32_bf16 v[216:219], v[192:195], v[124:127], v[216:219]
    s_waitcnt lgkmcnt(0)
    v_mfma_f32_16x16x32_bf16 v[208:211], v[196:199], v[60:63], v[208:211]
    v_mfma_f32_16x16x32_bf16 v[220:223], v[196:199], v[124:127], v[220:223]
    s_waitcnt vmcnt(0)
    s_mov_b64 exec, 1
    ds_write_b32 v248, v15 offset:128
    s_mov_b64 exec, -1
    s_mov_b32 s69, 0
L_ev_8:
    ds_read_b32 v2, v249 offset:128
    s_add_u32 s69, s69, 1
    s_waitcnt lgkmcnt(0)
    v_cmp_eq_u32 vcc, v2, v15
    s_cmp_ge_u32 s69, 1000000
    s_cbranch_scc1 L_evd_8
    s_nop 1
    s_and_b32 s62, vcc_lo, 255
    s_cmp_eq_u32 s62, 255
    s_cbranch_scc1 L_evd_8
    s_sleep 1
    s_branch L_ev_8
L_evd_8:
    s_lshl_b32 s90, s52, 10
    s_add_u32 s91, s90, 65536
    ds_read_b64_tr_b16 v[176:177], v14 offset:40960
    ds_read_b64_tr_b16 v[178:179], v14 offset:42240
    ds_read_b64_tr_b16 v[180:181], v14 offset:40992
    ds_read_b64_tr_b16 v[182:183], v14 offset:42272
    ds_read_b64_tr_b16 v[184:185], v14 offset:41024
    ds_read_b64_tr_b16 v[186:187], v14 offset:42304
    ds_read_b64_tr_b16 v[188:189], v14 offset:46080
    ds_read_b64_tr_b16 v[190:191], v14 offset:47360
    ds_read_b64_tr_b16 v[192:193], v14 offset:46112
    ds_read_b64_tr_b16 v[194:195], v14 offset:47392
    ds_read_b64_tr_b16 v[196:197], v14 offset:46144
    ds_read_b64_tr_b16 v[198:199], v14 offset:47424
    s_waitcnt lgkmcnt(10)
    v_mfma_f32_16x16x32_bf16 v[200:203], v[176:179], v[64:67], v[200:203]
    s_mov_b32 m0, s90
    s_add_u32 s90, s90, 4096
    buffer_load_dwordx4 v1, s[44:47], s91 offen sc1 lds
    s_add_u32 s91, s91, 4096
    v_mfma_f32_16x16x32_bf16 v[212:215], v[176:179], v[128:131], v[212:215]
    ds_read_b64_tr_b16 v[16:17], v6 offset:0
    ds_read_b64_tr_b16 v[18:19], v6 offset:1280
    s_waitcnt lgkmcnt(10)
    v_mfma_f32_16x16x32_bf16 v[204:207], v[180:183], v[64:67], v[204:207]
    s_mov_b32 m0, s90
    s_add_u32 s90, s90, 4096
    buffer_load_dwordx4 v1, s[44:47], s91 offen sc1 lds
    s_add_u32 s91, s91, 4096
    v_mfma_f32_16x16x32_bf16 v[216:219], v[180:183], v[128:131], v[216:219]
    ds_read_b64_tr_b16 v[20:21], v6 offset:32
    ds_read_b64_tr_b16 v[22:23], v6 offset:1312
    s_waitcnt lgkmcnt(10)
    v_mfma_f32_16x16x32_bf16 v[208:211], v[184:187], v[64:67], v[208:211]
    v_mfma_f32_16x16x32_bf16 v[220:223], v[184:187], v[128:131], v[220:223]
    ds_read_b64_tr_b16 v[24:25], v6 offset:64
    ds_read_b64_tr_b16 v[26:27], v6 offset:1344
    s_waitcnt lgkmcnt(10)
    v_mfma_f32_16x16x32_bf16 v[200:203], v[188:191], v[68:71], v[200:203]
    s_mov_b32 m0, s90
    s_add_u32 s90, s90, 4096
    buffer_load_dwordx4 v1, s[44:47], s91 offen sc1 lds
    s_add_u32 s91, s91, 4096
    v_mfma_f32_16x16x32_bf16 v[212:215], v[188:191], v[132:135], v[212:215]
    ds_read_b64_tr_b16 v[176:177], v6 offset:5120
    ds_read_b64_tr_b16 v[178:179], v6 offset:6400
    s_waitcnt lgkmcnt(10)
    v_mfma_f32_16x16x32_bf16 v[204:207], v[192:195], v[68:71], v[204:207]
    s_mov_b32 m0, s90
    s_add_u32 s90, s90, 4096
    buffer_load_dwordx4 v1, s[44:47], s91 offen sc1 lds
    s_add_u32 s91, s91, 4096
    v_mfma_f32_16x16x32_bf16 v[216:219], v[192:195], v[132:135], v[216:219]
    ds_read_b64_tr_b16 v[180:181], v6 offset:5152
    ds_read_b64_tr_b16 v[182:183], v6 offset:6432
    s_waitcnt lgkmcnt(10)
    v_mfma_f32_16x16x32_bf16 v[208:211], v[196:199], v[68:71], v[208:211]
    v_mfma_f32_16x16x32_bf16 v[220:223], v[196:199], v[132:135], v[220:223]
    ds_read_b64_tr_b16 v[184:185], v6 offset:5184
    ds_read_b64_tr_b16 v[186:187], v6 offset:6464
    s_waitcnt lgkmcnt(10)
    v_mfma_f32_16x16x32_bf16 v[200:203], v[16:19], v[72:75], v[200:203]
    s_mov_b32 m0, s90
    s_add_u32 s90, s90, 4096
    buffer_load_dwordx4 v1, s[44:47], s91 offen sc1 lds
    s_add_u32 s91, s91, 4096
    v_mfma_f32_16x16x32_bf16 v[212:215], v[16:19], v[136:139], v[212:215]
    ds_read_b64_tr_b16 v[188:189], v6 offset:10240
    ds_read_b64_tr_b16 v[190:191], v6 offset:11520
    s_waitcnt lgkmcnt(10)
    v_mfma_f32_16x16x32_bf16 v[204:207], v[20:23], v[72:75], v[204:207]
    s_mov_b32 m0, s90
    s_add_u32 s90, s90, 4096
    buffer_load_dwordx4 v1, s[44:47], s91 offen sc1 lds
    s_add_u32 s91, s91, 4096
    v_mfma_f32_16x16x32_bf16 v[216:219], v[20:23], v[136:139], v[216:219]
    ds_read_b64_tr_b16 v[192:193], v6 offset:10272
    ds_read_b64_tr_b16 v[194:195], v6 offset:11552
    s_waitcnt lgkmcnt(10)
    v_mfma_f32_16x16x32_bf16 v[208:211], v[24:27], v[72:75], v[208:211]
    v_mfma_f32_16x16x32_bf16 v[220:223], v[24:27], v[136:139], v[220:223]
    ds_read_b64_tr_b16 v[196:197], v6 offset:10304
    ds_read_b64_tr_b16 v[198:199], v6 offset:11584
    s_waitcnt lgkmcnt(10)
    v_mfma_f32_16x16x32_bf16 v[200:203], v[176:179], v[76:79], v[200:203]
    s_mov_b32 m0, s90
    s_add_u32 s90, s90, 4096
    buffer_load_dwordx4 v1, s[44:47], s91 offen sc1 lds
    s_add_u32 s91, s91, 4096
    v_mfma_f32_16x16x32_bf16 v[212:215], v[176:179], v[140:143], v[212:215]
    ds_read_b64_tr_b16 v[16:17], v6 offset:15360
    ds_read_b64_tr_b16 v[18:19], v6 offset:16640
    s_waitcnt lgkmcnt(10)
    v_mfma_f32_16x16x32_bf16 v[204:207], v[180:183], v[76:79], v[204:207]
    s_mov_b32 m0, s90
    s_add_u32 s90, s90, 4096
    buffer_load_dwordx4 v1, s[44:47], s91 offen sc1 lds
    s_add_u32 s91, s91, 4096
    v_mfma_f32_16x16x32_bf16 v[216:219], v[180:183], v[140:143], v[216:219]
    ds_read_b64_tr_b16 v[20:21], v6 offset:15392
    ds_read_b64_tr_b16 v[22:23], v6 offset:16672
    s_waitcnt lgkmcnt(10)
    v_mfma_f32_16x16x32_bf16 v[208:211], v[184:187], v[76:79], v[208:211]
    v_mfma_f32_16x16x32_bf16 v[220:223], v[184:187], v[140:143], v[220:223]
    ds_read_b64_tr_b16 v[24:25], v6 offset:15424
    ds_read_b64_tr_b16 v[26:27], v6 offset:16704
    s_waitcnt lgkmcnt(10)
    v_mfma_f32_16x16x32_bf16 v[200:203], v[188:191], v[80:83], v[200:203]
    s_mov_b32 m0, s90
    s_add_u32 s90, s90, 4096
    buffer_load_dwordx4 v1, s[44:47], s91 offen sc1 lds
    s_add_u32 s91, s91, 4096
    v_mfma_f32_16x16x32_bf16 v[212:215], v[188:191], v[160:163], v[212:215]
    ds_read_b64_tr_b16 v[176:177], v6 offset:20480
    ds_read_b64_tr_b16 v[178:179], v6 offset:21760
    s_waitcnt lgkmcnt(10)
    v_mfma_f32_16x16x32_bf16 v[204:207], v[192:195], v[80:83], v[204:207]
    s_mov_b32 m0, s90
    s_add_u32 s90, s90, 4096
    buffer_load_dwordx4 v1, s[44:47], s91 offen sc1 lds
    s_add_u32 s91, s91, 4096
    v_mfma_f32_16x16x32_bf16 v[216:219], v[192:195], v[160:163], v[216:219]
    ds_read_b64_tr_b16 v[180:181], v6 offset:20512
    ds_read_b64_tr_b16 v[182:183], v6 offset:21792
    s_waitcnt lgkmcnt(10)
    v_mfma_f32_16x16x32_bf16 v[208:211], v[196:199], v[80:83], v[208:211]
    v_mfma_f32_16x16x32_bf16 v[220:223], v[196:199], v[160:163], v[220:223]
    ds_read_b64_tr_b16 v[184:185], v6 offset:20544
    ds_read_b64_tr_b16 v[186:187], v6 offset:21824
    s_waitcnt lgkmcnt(10)
    v_mfma_f32_16x16x32_bf16 v[200:203], v[16:19], v[84:87], v[200:203]
    v_mfma_f32_16x16x32_bf16 v[212:215], v[16:19], v[164:167], v[212:215]
    ds_read_b64_tr_b16 v[188:189], v6 offset:25600
    ds_read_b64_tr_b16 v[190:191], v6 offset:26880
    s_waitcnt lgkmcnt(10)
    v_mfma_f32_16x16x32_bf16 v[204:207], v[20:23], v[84:87], v[204:207]
    v_mfma_f32_16x16x32_bf16 v[216:219], v[20:23], v[164:167], v[216:219]
    ds_read_b64_tr_b16 v[192:193], v6 offset:25632
    ds_read_b64_tr_b16 v[194:195], v6 offset:26912
    s_waitcnt lgkmcnt(10)
    v_mfma_f32_16x16x32_bf16 v[208:211], v[24:27], v[84:87], v[208:211]
    v_mfma_f32_16x16x32_bf16 v[220:223], v[24:27], v[164:167], v[220:223]
    ds_read_b64_tr_b16 v[196:197], v6 offset:25664
    ds_read_b64_tr_b16 v[198:199], v6 offset:26944
    s_waitcnt lgkmcnt(10)
    v_mfma_f32_16x16x32_bf16 v[200:203], v[176:179], v[88:91], v[200:203]
    v_mfma_f32_16x16x32_bf16 v[212:215], v[176:179], v[168:171], v[212:215]
    s_waitcnt lgkmcnt(8)
    v_mfma_f32_16x16x32_bf16 v[204:207], v[180:183], v[88:91], v[204:207]
    v_mfma_f32_16x16x32_bf16 v[216:219], v[180:183], v[168:171], v[216:219]
    s_waitcnt lgkmcnt(6)
    v_mfma_f32_16x16x32_bf16 v[208:211], v[184:187], v[88:91], v[208:211]
    v_mfma_f32_16x16x32_bf16 v[220:223], v[184:187], v[168:171], v[220:223]
    s_waitcnt lgkmcnt(4)
    v_mfma_f32_16x16x32_bf16 v[200:203], v[188:191], v[92:95], v[200:203]
    v_mfma_f32_16x16x32_bf16 v[212:215], v[188:191], v[172:175], v[212:215]
    s_waitcnt lgkmcnt(2)
    v_mfma_f32_16x16x32_bf16 v[204:207], v[192:195], v[92:95], v[204:207]
    v_mfma_f32_16x16x32_bf16 v[216:219], v[192:195], v[172:175], v[216:219]
    s_waitcnt lgkmcnt(0)
    v_mfma_f32_16x16x32_bf16 v[208:211], v[196:199], v[92:95], v[208:211]
    v_mfma_f32_16x16x32_bf16 v[220:223], v[196:199], v[172:175], v[220:223]
    s_setprio 3
    s_nop 7
    v_cvt_pk_bf16_f32 v200, v200, v201
    v_cvt_pk_bf16_f32 v201, v202, v203
    ds_write_b64 v13, v[200:201] offset:0
    v_cvt_pk_bf16_f32 v204, v204, v205
    v_cvt_pk_bf16_f32 v205, v206, v207
    ds_write_b64 v13, v[204:205] offset:32
    v_cvt_pk_bf16_f32 v208, v208, v209
    v_cvt_pk_bf16_f32 v209, v210, v211
    ds_write_b64 v13, v[208:209] offset:64
    v_cvt_pk_bf16_f32 v212, v212, v213
    v_cvt_pk_bf16_f32 v213, v214, v215
    ds_write_b64 v13, v[212:213] offset:2560
    v_cvt_pk_bf16_f32 v216, v216, v217
    v_cvt_pk_bf16_f32 v217, v218, v219
    ds_write_b64 v13, v[216:217] offset:2592
    v_cvt_pk_bf16_f32 v220, v220, v221
    v_cvt_pk_bf16_f32 v221, v222, v223
    ds_write_b64 v13, v[220:221] offset:2624
L_q_kv:
    s_waitcnt vmcnt(0) lgkmcnt(0)
    s_mov_b64 exec, 1
    ds_write_b32 v248, v15 offset:320
    s_mov_b64 exec, -1
    s_or_b32 s64, s2, s52
    s_cmp_lg_u32 s64, 0
    s_cbranch_scc1 L_q_nn
    v_mov_b32 v2, 0
    s_mov_b64 exec, 1
    buffer_store_dword v15, v2, s[44:47], 0 offen
    s_mov_b64 exec, -1
L_q_nn:
    s_setprio 0
    s_mov_b32 s69, 0
L_ev_9:
    ds_read_b32 v2, v249 offset:320
    s_add_u32 s69, s69, 1
    s_waitcnt lgkmcnt(0)
    v_cmp_eq_u32 vcc, v2, v15
    s_cmp_ge_u32 s69, 1000000
    s_cbranch_scc1 L_evd_9
    s_nop 1
    s_and_b32 s62, vcc_lo, 15
    s_cmp_eq_u32 s62, 15
    s_cbranch_scc1 L_evd_9
    s_sleep 1
    s_branch L_ev_9
L_evd_9:
    ds_read2_b64 v[156:159], v224 offset0:0 offset1:1
    ds_read2_b64 v[160:163], v224 offset0:10 offset1:11
    ds_read_b64 v[164:165], v225 offset:32
    v_mov_b32 v64, 0
    v_mov_b32 v65, 0
    v_mov_b32 v66, 0
    v_mov_b32 v67, 0
    v_mov_b32 v68, 0
    v_mov_b32 v69, 0
    v_mov_b32 v70, 0
    v_mov_b32 v71, 0
    s_nop 0
    v_mfma_f32_32x32x16_bf16 v[104:119], v[64:67], v[64:67], 0
    v_mfma_f32_32x32x16_bf16 v[120:135], v[64:67], v[64:67], 0
    ds_read_b128 v[136:139], v153
    ds_read_b64 v[140:141], v154 offset:2048
    s_waitcnt lgkmcnt(0)
    v_mfma_f32_32x32x16_bf16 v[8:23], v[136:139], v[156:159], 0
    v_mfma_f32_32x32x16_bf16 v[24:39], v[136:139], v[160:163], 0
    ds_read_b128 v[136:139], v153 offset:1024
    s_mov_b64 exec, s[60:61]
    ds_read_b128 v[144:147], v155 offset:2560
    s_mov_b64 exec, -1
    s_nop 7
    v_mfma_f32_32x32x4bf16_1k v[8:39], v[140:141], v[164:165], v[8:39] cbsz:1 abid:0
    s_nop 15
    s_nop 2
    s_branch L_join
L_cut_u_main:
    s_call_b64 s[92:93], L_sub_kaddr
    s_mov_b32 s69, 0
L_ev_10:
    ds_read_b32 v2, v249 offset:32
    s_add_u32 s69, s69, 1
    s_waitcnt lgkmcnt(0)
    v_cmp_eq_u32 vcc, v2, v15
    s_cmp_ge_u32 s69, 1000000
    s_cbranch_scc1 L_evd_10
    s_nop 1
    s_and_b32 s62, vcc_lo, 15
    s_cmp_eq_u32 s62, 15
    s_cbranch_scc1 L_evd_10
    s_sleep 1
    s_branch L_ev_10
L_evd_10:
    s_lshl_b32 s62, s53, 8
    s_add_u32 s62, s62, 4096
    v_lshl_add_u32 v3, v0, 2, s62
    s_mov_b32 exec_lo, 0xffffffff
    s_mov_b32 exec_hi, 0
    s_mov_b32 s69, 0
L_poll_u:
    buffer_load_dword v4, v3, s[44:47], 0 offen sc1
    s_waitcnt vmcnt(0)
L_pollc_u:
    v_xor_b32 v4, s57, v4
    v_cmp_ne_u32 vcc, 0, v4
    s_add_u32 s69, s69, 1
    s_nop 2
    s_cmp_eq_u64 vcc, 0
    s_cbranch_scc1 L_polld_u
    s_sleep 4
    s_cmp_lt_u32 s69, 1000000
    s_cbranch_scc1 L_poll_u
L_polld_u:
    s_mov_b64 exec, -1
    s_add_u32 s62, s58, 0
    s_lshl_b32 s62, s62, 12
    s_add_u32 s62, s62, 262144
    buffer_load_dwordx4 v[104:107], v1, s[44:47], s62 offen offset:0 sc1
    buffer_load_dwordx4 v[108:111], v1, s[44:47], s62 offen offset:1024 sc1
    buffer_load_dwordx4 v[112:115], v1, s[44:47], s62 offen offset:2048 sc1
    buffer_load_dwordx4 v[116:119], v1, s[44:47], s62 offen offset:3072 sc1
    s_add_u32 s62, s58, 1
    s_lshl_b32 s62, s62, 12
    s_add_u32 s62, s62, 262144
    buffer_load_dwordx4 v[120:123], v1, s[44:47], s62 offen offset:0 sc1
    buffer_load_dwordx4 v[124:127], v1, s[44:47], s62 offen offset:1024 sc1
    buffer_load_dwordx4 v[128:131], v1, s[44:47], s62 offen offset:2048 sc1
    buffer_load_dwordx4 v[132:135], v1, s[44:47], s62 offen offset:3072 sc1
    s_mov_b32 s62, s59
    s_lshl_b32 s62, s62, 12
    s_add_u32 s62, s62, 262144
    buffer_load_dwordx4 v[198:201], v1, s[44:47], s62 offen offset:0 sc1
    buffer_load_dwordx4 v[202:205], v1, s[44:47], s62 offen offset:1024 sc1
    buffer_load_dwordx4 v[206:209], v1, s[44:47], s62 offen offset:2048 sc1
    buffer_load_dwordx4 v[210:213], v1, s[44:47], s62 offen offset:3072 sc1
    s_setprio 1
    s_branch L_k_exp
L_k_done:
    s_waitcnt lgkmcnt(0)
    s_mov_b64 exec, 1
    ds_write_b32 v248, v15 offset:224
    s_mov_b64 exec, -1
L_k_exp:
    s_mov_b32 s69, 0
L_ev_11:
    ds_read_b32 v2, v249 offset:224
    s_add_u32 s69, s69, 1
    s_waitcnt lgkmcnt(0)
    v_cmp_eq_u32 vcc, v2, v15
    s_cmp_ge_u32 s69, 1000000
    s_cbranch_scc1 L_evd_11
    s_nop 1
    s_and_b32 s62, vcc_lo, 245
    s_cmp_eq_u32 s62, 245
    s_cbranch_scc1 L_evd_11
    s_sleep 1
    s_branch L_ev_11
L_evd_11:
    s_sub_u32 s64, s52, 4
    s_lshl_b32 s65, s64, 10
    s_add_u32 s65, s65, 102400
    v_add_u32 v4, s65, v1
    ds_read_u16 v60, v186 offset:0
    ds_read_u16_d16_hi v66, v187 offset:0
    ds_read_u16 v61, v188 offset:0
    ds_read_u16_d16_hi v67, v189 offset:0
    ds_read_u16 v62, v190 offset:0
    ds_read_u16_d16_hi v68, v191 offset:0
    ds_read_u16 v63, v192 offset:0
    ds_read_u16_d16_hi v69, v193 offset:0
    ds_read_u16 v64, v194 offset:0
    ds_read_u16_d16_hi v70, v195 offset:0
    ds_read_u16 v65, v196 offset:0
    ds_read_u16_d16_hi v71, v197 offset:0
    ds_read_u16 v72, v186 offset:1552
    ds_read_u16_d16_hi v78, v187 offset:1552
    ds_read_u16 v73, v188 offset:1552
    ds_read_u16_d16_hi v79, v189 offset:1552
    ds_read_u16 v74, v190 offset:1552
    ds_read_u16_d16_hi v80, v191 offset:1552
    ds_read_u16 v75, v192 offset:1552
    ds_read_u16_d16_hi v81, v193 offset:1552
    ds_read_u16 v76, v194 offset:1552
    ds_read_u16_d16_hi v82, v195 offset:1552
    ds_read_u16 v77, v196 offset:1552
    ds_read_u16_d16_hi v83, v197 offset:1552
    ds_read_u16 v84, v186 offset:3104
    ds_read_u16_d16_hi v90, v187 offset:3104
    ds_read_u16 v85, v188 offset:3104
    ds_read_u16_d16_hi v91, v189 offset:3104
    ds_read_u16 v86, v190 offset:3104
    ds_read_u16_d16_hi v92, v191 offset:3104
    ds_read_u16 v87, v192 offset:3104
    ds_read_u16_d16_hi v93, v193 offset:3104
    ds_read_u16 v88, v194 offset:3104
    ds_read_u16_d16_hi v94, v195 offset:3104
    ds_read_u16 v89, v196 offset:3104
    ds_read_u16_d16_hi v95, v197 offset:3104
    s_waitcnt lgkmcnt(15)
    v_or_b32 v136, v61, v67
    v_or_b32 v137, v62, v68
    v_or_b32 v138, v63, v69
    v_or_b32 v139, v64, v70
    v_or_b32 v60, v60, v66
    v_or_b32 v61, v61, v67
    v_or_b32 v62, v62, v68
    v_or_b32 v63, v63, v69
    v_or_b32 v64, v64, v70
    v_or_b32 v65, v65, v71
    ds_write_b128 v4, v[136:139] offset:8320
    v_alignbit_b32 v140, v61, v60, 16
    v_alignbit_b32 v141, v62, v61, 16
    v_alignbit_b32 v142, v63, v62, 16
    v_alignbit_b32 v143, v64, v63, 16
    ds_write_b128 v4, v[60:63] offset:0
    v_alignbit_b32 v156, v62, v61, 16
    v_alignbit_b32 v157, v63, v62, 16
    v_alignbit_b32 v158, v64, v63, 16
    v_alignbit_b32 v159, v65, v64, 16
    ds_write_b128 v4, v[140:143] offset:4160
    ds_write_b128 v4, v[156:159] offset:12480
    s_waitcnt lgkmcnt(15)
    v_or_b32 v136, v73, v79
    v_or_b32 v137, v74, v80
    v_or_b32 v138, v75, v81
    v_or_b32 v139, v76, v82
    v_or_b32 v72, v72, v78
    v_or_b32 v73, v73, v79
    v_or_b32 v74, v74, v80
    v_or_b32 v75, v75, v81
    v_or_b32 v76, v76, v82
    v_or_b32 v77, v77, v83
    ds_write_b128 v4, v[136:139] offset:24960
    v_alignbit_b32 v140, v73, v72, 16
    v_alignbit_b32 v141, v74, v73, 16
    v_alignbit_b32 v142, v75, v74, 16
    v_alignbit_b32 v143, v76, v75, 16
    ds_write_b128 v4, v[72:75] offset:16640
    v_alignbit_b32 v156, v74, v73, 16
    v_alignbit_b32 v157, v75, v74, 16
    v_alignbit_b32 v158, v76, v75, 16
    v_alignbit_b32 v159, v77, v76, 16
    ds_write_b128 v4, v[140:143] offset:20800
    ds_write_b128 v4, v[156:159] offset:29120
    s_waitcnt lgkmcnt(8)
    v_or_b32 v136, v85, v91
    v_or_b32 v137, v86, v92
    v_or_b32 v138, v87, v93
    v_or_b32 v139, v88, v94
    v_or_b32 v84, v84, v90
    v_or_b32 v85, v85, v91
    v_or_b32 v86, v86, v92
    v_or_b32 v87, v87, v93
    v_or_b32 v88, v88, v94
    v_or_b32 v89, v89, v95
    ds_write_b128 v4, v[136:139] offset:41600
    v_alignbit_b32 v140, v85, v84, 16
    v_alignbit_b32 v141, v86, v85, 16
    v_alignbit_b32 v142, v87, v86, 16
    v_alignbit_b32 v143, v88, v87, 16
    ds_write_b128 v4, v[84:87] offset:33280
    v_alignbit_b32 v156, v86, v85, 16
    v_alignbit_b32 v157, v87, v86, 16
    v_alignbit_b32 v158, v88, v87, 16
    v_alignbit_b32 v159, v89, v88, 16
    ds_write_b128 v4, v[140:143] offset:37440
    ds_write_b128 v4, v[156:159] offset:45760
    s_cmp_lg_u32 s52, 5
    s_cbranch_scc1 L_exp_done
    v_lshrrev_b32 v5, 3, v0
    v_mul_u32_u24 v6, 16640, v5
    v_bfe_u32 v7, v0, 1, 2
    v_mul_u32_u24 v7, 4160, v7
    v_and_b32 v8, 1, v0
    v_lshl_add_u32 v7, v8, 4, v7
    v_add_u32 v6, v6, v7
    v_add_u32 v6, 106496, v6
    v_mov_b32 v8, 0
    v_mov_b32 v9, 0
    v_mov_b32 v10, 0
    v_mov_b32 v11, 0
    v_mul_u32_u24 v12, 1552, v0
    v_add_u32 v12, 154120, v12
    v_mul_u32_u24 v13, 16640, v0
    s_mov_b64 exec, 7
    ds_read_u16 v12, v12
    s_mov_b64 exec, 0xffffff
    ds_write_b128 v6, v[8:11]
    s_mov_b64 exec, 7
    v_add_u32 v13, 106496, v13
    s_waitcnt lgkmcnt(0)
    ds_write_b16 v13, v12
    s_mov_b64 exec, -1
L_exp_done:
    s_waitcnt lgkmcnt(0)
    s_mov_b64 exec, 1
    ds_write_b32 v248, v15 offset:128
    s_mov_b64 exec, -1
    s_cmp_eq_u32 s52, 5
    s_cbranch_scc1 L_k_c0
    s_cmp_eq_u32 s52, 6
    s_cbranch_scc1 L_k_c0
    s_mov_b32 s69, 0
L_ev_12:
    ds_read_b32 v2, v249 offset:256
    s_add_u32 s69, s69, 1
    s_waitcnt lgkmcnt(0)
    v_cmp_eq_u32 vcc, v2, v15
    s_cmp_ge_u32 s69, 1000000
    s_cbranch_scc1 L_evd_12
    s_nop 1
    s_and_b32 s62, vcc_lo, 15
    s_cmp_eq_u32 s62, 15
    s_cbranch_scc1 L_evd_12
    s_sleep 1
    s_branch L_ev_12
L_evd_12:
    s_cmp_eq_u32 s52, 4
    s_cbranch_scc1 L_k_ut
    v_lshlrev_b32 v2, 3, v0
    v_add_u32 v2, 81920, v2
    v_mov_b32 v4, 0
    v_mov_b32 v5, 0
    ds_write_b64 v2, v[4:5] offset:0
    ds_write_b64 v2, v[4:5] offset:4608
    ds_write_b64 v2, v[4:5] offset:9216
    s_branch L_k_c0
L_k_ut:
    v_add_u32 v2, 82432, v1
    s_waitcnt vmcnt(0)
    ds_write_b128 v2, v[104:107] offset:4608
    ds_write_b128 v2, v[108:111] offset:5632
    ds_write_b128 v2, v[112:115] offset:6656
    ds_write_b128 v2, v[116:119] offset:7680
    ds_write_b128 v2, v[120:123] offset:9216
    ds_write_b128 v2, v[124:127] offset:10240
    ds_write_b128 v2, v[128:131] offset:11264
    ds_write_b128 v2, v[132:135] offset:12288
    ds_write_b128 v2, v[198:201] offset:0
    ds_write_b128 v2, v[202:205] offset:1024
    ds_write_b128 v2, v[206:209] offset:2048
    ds_write_b128 v2, v[210:213] offset:3072
L_k_c0:
    s_waitcnt lgkmcnt(0)
    s_mov_b64 exec, 1
    ds_write_b32 v248, v15 offset:160
    s_mov_b64 exec, -1
    s_mov_b32 s69, 0
L_ev_13:
    ds_read_b32 v2, v249 offset:160
    s_add_u32 s69, s69, 1
    s_waitcnt lgkmcnt(0)
    v_cmp_eq_u32 vcc, v2, v15
    s_cmp_ge_u32 s69, 1000000
    s_cbranch_scc1 L_evd_13
    s_nop 1
    s_and_b32 s62, vcc_lo, 240
    s_cmp_eq_u32 s62, 240
    s_cbranch_scc1 L_evd_13
    s_sleep 1
    s_branch L_ev_13
L_evd_13:
    s_setprio 1
    ds_read_b128 v[104:107], v243 offset:192
    ds_read_b64 v[72:73], v242 offset:3776
    ds_read_b64 v[74:75], v242 offset:3784
    ds_read_b128 v[108:111], v243 offset:704
    ds_read_b64 v[76:77], v242 offset:3264
    ds_read_b64 v[78:79], v242 offset:3272
    ds_read_b128 v[112:115], v243 offset:1216
    ds_read_b64 v[80:81], v242 offset:2752
    ds_read_b64 v[82:83], v242 offset:2760
    ds_read_b128 v[116:119], v243 offset:1728
    ds_read_b64 v[84:85], v242 offset:2240
    ds_read_b64 v[86:87], v242 offset:2248
    ds_read_b128 v[120:123], v243 offset:2240
    ds_read_b64 v[88:89], v242 offset:1728
    ds_read_b64 v[90:91], v242 offset:1736
    s_waitcnt lgkmcnt(12)
    v_mfma_f32_16x16x32_bf16 v[8:11], v[72:75], v[104:107], 0
    ds_read_b128 v[124:127], v243 offset:2752
    s_waitcnt lgkmcnt(10)
    v_mfma_f32_16x16x32_bf16 v[12:15], v[72:75], v[108:111], 0
    ds_read_b64 v[92:93], v242 offset:1216
    v_mfma_f32_16x16x32_bf16 v[12:15], v[76:79], v[104:107], v[12:15]
    ds_read_b64 v[94:95], v242 offset:1224
    s_waitcnt lgkmcnt(9)
    v_mfma_f32_16x16x32_bf16 v[16:19], v[72:75], v[112:115], 0
    ds_read_b128 v[128:131], v243 offset:3264
    v_mfma_f32_16x16x32_bf16 v[16:19], v[76:79], v[108:111], v[16:19]
    ds_read_b64 v[96:97], v242 offset:704
    v_mfma_f32_16x16x32_bf16 v[16:19], v[80:83], v[104:107], v[16:19]
    ds_read_b64 v[98:99], v242 offset:712
    s_waitcnt lgkmcnt(9)
    v_mfma_f32_16x16x32_bf16 v[20:23], v[72:75], v[116:119], 0
    ds_read_b128 v[132:135], v243 offset:3776
    v_mfma_f32_16x16x32_bf16 v[20:23], v[76:79], v[112:115], v[20:23]
    ds_read_b64 v[100:101], v242 offset:192
    v_mfma_f32_16x16x32_bf16 v[20:23], v[80:83], v[108:111], v[20:23]
    ds_read_b64 v[102:103], v242 offset:200
    v_mfma_f32_16x16x32_bf16 v[20:23], v[84:87], v[104:107], v[20:23]
    ds_read_b128 v[192:195], v243 offset:128
    s_waitcnt lgkmcnt(10)
    v_mfma_f32_16x16x32_bf16 v[24:27], v[72:75], v[120:123], 0
    ds_read_b64 v[160:161], v242 offset:3712
    v_mfma_f32_16x16x32_bf16 v[24:27], v[76:79], v[116:119], v[24:27]
    ds_read_b64 v[162:163], v242 offset:3720
    v_mfma_f32_16x16x32_bf16 v[24:27], v[80:83], v[112:115], v[24:27]
    ds_read_b128 v[196:199], v243 offset:640
    v_mfma_f32_16x16x32_bf16 v[24:27], v[84:87], v[108:111], v[24:27]
    ds_read_b64 v[164:165], v242 offset:3200
    v_mfma_f32_16x16x32_bf16 v[24:27], v[88:91], v[104:107], v[24:27]
    ds_read_b64 v[166:167], v242 offset:3208
    s_waitcnt lgkmcnt(12)
    v_mfma_f32_16x16x32_bf16 v[28:31], v[72:75], v[124:127], 0
    ds_read_b128 v[200:203], v243 offset:1152
    v_mfma_f32_16x16x32_bf16 v[28:31], v[76:79], v[120:123], v[28:31]
    ds_read_b64 v[168:169], v242 offset:2688
    v_mfma_f32_16x16x32_bf16 v[28:31], v[80:83], v[116:119], v[28:31]
    ds_read_b64 v[170:171], v242 offset:2696
    v_mfma_f32_16x16x32_bf16 v[28:31], v[84:87], v[112:115], v[28:31]
    ds_read_b128 v[204:207], v243 offset:1664
    v_mfma_f32_16x16x32_bf16 v[28:31], v[88:91], v[108:111], v[28:31]
    ds_read_b64 v[172:173], v242 offset:2176
    v_mfma_f32_16x16x32_bf16 v[28:31], v[92:95], v[104:107], v[28:31]
    ds_read_b64 v[174:175], v242 offset:2184
    s_waitcnt lgkmcnt(15)
    v_mfma_f32_16x16x32_bf16 v[32:35], v[72:75], v[128:131], 0
    ds_read_b128 v[208:211], v243 offset:2176
    v_mfma_f32_16x16x32_bf16 v[32:35], v[76:79], v[124:127], v[32:35]
    ds_read_b64 v[176:177], v242 offset:1664
    v_mfma_f32_16x16x32_bf16 v[32:35], v[80:83], v[120:123], v[32:35]
    ds_read_b64 v[178:179], v242 offset:1672
    v_mfma_f32_16x16x32_bf16 v[32:35], v[84:87], v[116:119], v[32:35]
    ds_read_b128 v[212:215], v243 offset:2688
    v_mfma_f32_16x16x32_bf16 v[32:35], v[88:91], v[112:115], v[32:35]
    ds_read_b64 v[180:181], v242 offset:1152
    v_mfma_f32_16x16x32_bf16 v[32:35], v[92:95], v[108:111], v[32:35]
    ds_read_b64 v[182:183], v242 offset:1160
    v_mfma_f32_16x16x32_bf16 v[32:35], v[96:99], v[104:107], v[32:35]
    ds_read_b128 v[216:219], v243 offset:3200
    s_waitcnt lgkmcnt(15)
    v_mfma_f32_16x16x32_bf16 v[36:39], v[72:75], v[132:135], 0
    ds_read_b64 v[184:185], v242 offset:640
    v_mfma_f32_16x16x32_bf16 v[36:39], v[76:79], v[128:131], v[36:39]
    ds_read_b64 v[186:187], v242 offset:648
    v_mfma_f32_16x16x32_bf16 v[36:39], v[80:83], v[124:127], v[36:39]
    ds_read_b128 v[220:223], v243 offset:3712
    v_mfma_f32_16x16x32_bf16 v[36:39], v[84:87], v[120:123], v[36:39]
    ds_read_b64 v[188:189], v242 offset:128
    v_mfma_f32_16x16x32_bf16 v[36:39], v[88:91], v[116:119], v[36:39]
    ds_read_b64 v[190:191], v242 offset:136
    v_mfma_f32_16x16x32_bf16 v[36:39], v[92:95], v[112:115], v[36:39]
    v_mfma_f32_16x16x32_bf16 v[36:39], v[96:99], v[108:111], v[36:39]
    v_mfma_f32_16x16x32_bf16 v[36:39], v[100:103], v[104:107], v[36:39]
    s_waitcnt lgkmcnt(15)
    v_mfma_f32_16x16x32_bf16 v[8:11], v[160:163], v[192:195], v[8:11]
    s_waitcnt lgkmcnt(15)
    v_mfma_f32_16x16x32_bf16 v[12:15], v[160:163], v[196:199], v[12:15]
    v_mfma_f32_16x16x32_bf16 v[12:15], v[164:167], v[192:195], v[12:15]
    s_waitcnt lgkmcnt(15)
    v_mfma_f32_16x16x32_bf16 v[16:19], v[160:163], v[200:203], v[16:19]
    v_mfma_f32_16x16x32_bf16 v[16:19], v[164:167], v[196:199], v[16:19]
    v_mfma_f32_16x16x32_bf16 v[16:19], v[168:171], v[192:195], v[16:19]
    s_waitcnt lgkmcnt(12)
    v_mfma_f32_16x16x32_bf16 v[20:23], v[160:163], v[204:207], v[20:23]
    ds_read_b128 v[104:107], v243 offset:64
    v_mfma_f32_16x16x32_bf16 v[20:23], v[164:167], v[200:203], v[20:23]
    ds_read_b64 v[72:73], v242 offset:3648
    v_mfma_f32_16x16x32_bf16 v[20:23], v[168:171], v[196:199], v[20:23]
    ds_read_b64 v[74:75], v242 offset:3656
    v_mfma_f32_16x16x32_bf16 v[20:23], v[172:175], v[192:195], v[20:23]
    ds_read_b128 v[108:111], v243 offset:576
    s_waitcnt lgkmcnt(13)
    v_mfma_f32_16x16x32_bf16 v[24:27], v[160:163], v[208:211], v[24:27]
    ds_read_b64 v[76:77], v242 offset:3136
    v_mfma_f32_16x16x32_bf16 v[24:27], v[164:167], v[204:207], v[24:27]
    ds_read_b64 v[78:79], v242 offset:3144
    v_mfma_f32_16x16x32_bf16 v[24:27], v[168:171], v[200:203], v[24:27]
    ds_read_b128 v[112:115], v243 offset:1088
    v_mfma_f32_16x16x32_bf16 v[24:27], v[172:175], v[196:199], v[24:27]
    ds_read_b64 v[80:81], v242 offset:2624
    v_mfma_f32_16x16x32_bf16 v[24:27], v[176:179], v[192:195], v[24:27]
    ds_read_b64 v[82:83], v242 offset:2632
    s_waitcnt lgkmcnt(15)
    v_mfma_f32_16x16x32_bf16 v[28:31], v[160:163], v[212:215], v[28:31]
    ds_read_b128 v[116:119], v243 offset:1600
    v_mfma_f32_16x16x32_bf16 v[28:31], v[164:167], v[208:211], v[28:31]
    ds_read_b64 v[84:85], v242 offset:2112
    v_mfma_f32_16x16x32_bf16 v[28:31], v[168:171], v[204:207], v[28:31]
    ds_read_b64 v[86:87], v242 offset:2120
    v_mfma_f32_16x16x32_bf16 v[28:31], v[172:175], v[200:203], v[28:31]
    ds_read_b128 v[120:123], v243 offset:2112
    v_mfma_f32_16x16x32_bf16 v[28:31], v[176:179], v[196:199], v[28:31]
    ds_read_b64 v[88:89], v242 offset:1600
    v_mfma_f32_16x16x32_bf16 v[28:31], v[180:183], v[192:195], v[28:31]
    ds_read_b64 v[90:91], v242 offset:1608
    s_waitcnt lgkmcnt(15)
    v_mfma_f32_16x16x32_bf16 v[32:35], v[160:163], v[216:219], v[32:35]
    ds_read_b128 v[124:127], v243 offset:2624
    v_mfma_f32_16x16x32_bf16 v[32:35], v[164:167], v[212:215], v[32:35]
    ds_read_b64 v[92:93], v242 offset:1088
    v_mfma_f32_16x16x32_bf16 v[32:35], v[168:171], v[208:211], v[32:35]
    ds_read_b64 v[94:95], v242 offset:1096
    v_mfma_f32_16x16x32_bf16 v[32:35], v[172:175], v[204:207], v[32:35]
    ds_read_b128 v[128:131], v243 offset:3136
    v_mfma_f32_16x16x32_bf16 v[32:35], v[176:179], v[200:203], v[32:35]
    ds_read_b64 v[96:97], v242 offset:576
    v_mfma_f32_16x16x32_bf16 v[32:35], v[180:183], v[196:199], v[32:35]
    ds_read_b64 v[98:99], v242 offset:584
    v_mfma_f32_16x16x32_bf16 v[32:35], v[184:187], v[192:195], v[32:35]
    ds_read_b128 v[132:135], v243 offset:3648
    s_waitcnt lgkmcnt(15)
    v_mfma_f32_16x16x32_bf16 v[36:39], v[160:163], v[220:223], v[36:39]
    ds_read_b64 v[100:101], v242 offset:64
    v_mfma_f32_16x16x32_bf16 v[36:39], v[164:167], v[216:219], v[36:39]
    ds_read_b64 v[102:103], v242 offset:72
    v_mfma_f32_16x16x32_bf16 v[36:39], v[168:171], v[212:215], v[36:39]
    v_mfma_f32_16x16x32_bf16 v[36:39], v[172:175], v[208:211], v[36:39]
    v_mfma_f32_16x16x32_bf16 v[36:39], v[176:179], v[204:207], v[36:39]
    v_mfma_f32_16x16x32_bf16 v[36:39], v[180:183], v[200:203], v[36:39]
    v_mfma_f32_16x16x32_bf16 v[36:39], v[184:187], v[196:199], v[36:39]
    v_mfma_f32_16x16x32_bf16 v[36:39], v[188:191], v[192:195], v[36:39]
    s_waitcnt lgkmcnt(15)
    v_mfma_f32_16x16x32_bf16 v[8:11], v[72:75], v[104:107], v[8:11]
    s_waitcnt lgkmcnt(15)
    v_mfma_f32_16x16x32_bf16 v[12:15], v[72:75], v[108:111], v[12:15]
    v_mfma_f32_16x16x32_bf16 v[12:15], v[76:79], v[104:107], v[12:15]
    s_waitcnt lgkmcnt(15)
    v_mfma_f32_16x16x32_bf16 v[16:19], v[72:75], v[112:115], v[16:19]
    v_mfma_f32_16x16x32_bf16 v[16:19], v[76:79], v[108:111], v[16:19]
    v_mfma_f32_16x16x32_bf16 v[16:19], v[80:83], v[104:107], v[16:19]
    s_waitcnt lgkmcnt(12)
    v_mfma_f32_16x16x32_bf16 v[20:23], v[72:75], v[116:119], v[20:23]
    ds_read_b128 v[192:195], v243 offset:0
    v_mfma_f32_16x16x32_bf16 v[20:23], v[76:79], v[112:115], v[20:23]
    ds_read_b64 v[160:161], v242 offset:3584
    v_mfma_f32_16x16x32_bf16 v[20:23], v[80:83], v[108:111], v[20:23]
    ds_read_b64 v[162:163], v242 offset:3592
    v_mfma_f32_16x16x32_bf16 v[20:23], v[84:87], v[104:107], v[20:23]
    ds_read_b128 v[196:199], v243 offset:512
    s_waitcnt lgkmcnt(13)
    v_mfma_f32_16x16x32_bf16 v[24:27], v[72:75], v[120:123], v[24:27]
    ds_read_b64 v[164:165], v242 offset:3072
    v_mfma_f32_16x16x32_bf16 v[24:27], v[76:79], v[116:119], v[24:27]
    ds_read_b64 v[166:167], v242 offset:3080
    v_mfma_f32_16x16x32_bf16 v[24:27], v[80:83], v[112:115], v[24:27]
    ds_read_b128 v[200:203], v243 offset:1024
    v_mfma_f32_16x16x32_bf16 v[24:27], v[84:87], v[108:111], v[24:27]
    ds_read_b64 v[168:169], v242 offset:2560
    v_mfma_f32_16x16x32_bf16 v[24:27], v[88:91], v[104:107], v[24:27]
    ds_read_b64 v[170:171], v242 offset:2568
    s_waitcnt lgkmcnt(15)
    v_mfma_f32_16x16x32_bf16 v[28:31], v[72:75], v[124:127], v[28:31]
    ds_read_b128 v[204:207], v243 offset:1536
    v_mfma_f32_16x16x32_bf16 v[28:31], v[76:79], v[120:123], v[28:31]
    ds_read_b64 v[172:173], v242 offset:2048
    v_mfma_f32_16x16x32_bf16 v[28:31], v[80:83], v[116:119], v[28:31]
    ds_read_b64 v[174:175], v242 offset:2056
    v_mfma_f32_16x16x32_bf16 v[28:31], v[84:87], v[112:115], v[28:31]
    ds_read_b128 v[208:211], v243 offset:2048
    v_mfma_f32_16x16x32_bf16 v[28:31], v[88:91], v[108:111], v[28:31]
    ds_read_b64 v[176:177], v242 offset:1536
    v_mfma_f32_16x16x32_bf16 v[28:31], v[92:95], v[104:107], v[28:31]
    ds_read_b64 v[178:179], v242 offset:1544
    s_waitcnt lgkmcnt(15)
    v_mfma_f32_16x16x32_bf16 v[32:35], v[72:75], v[128:131], v[32:35]
    ds_read_b128 v[212:215], v243 offset:2560
    v_mfma_f32_16x16x32_bf16 v[32:35], v[76:79], v[124:127], v[32:35]
    ds_read_b64 v[180:181], v242 offset:1024
    v_mfma_f32_16x16x32_bf16 v[32:35], v[80:83], v[120:123], v[32:35]
    ds_read_b64 v[182:183], v242 offset:1032
    v_mfma_f32_16x16x32_bf16 v[32:35], v[84:87], v[116:119], v[32:35]
    ds_read_b128 v[216:219], v243 offset:3072
    v_mfma_f32_16x16x32_bf16 v[32:35], v[88:91], v[112:115], v[32:35]
    ds_read_b64 v[184:185], v242 offset:512
    v_mfma_f32_16x16x32_bf16 v[32:35], v[92:95], v[108:111], v[32:35]
    ds_read_b64 v[186:187], v242 offset:520
    v_mfma_f32_16x16x32_bf16 v[32:35], v[96:99], v[104:107], v[32:35]
    ds_read_b128 v[220:223], v243 offset:3584
    s_waitcnt lgkmcnt(15)
    v_mfma_f32_16x16x32_bf16 v[36:39], v[72:75], v[132:135], v[36:39]
    ds_read_b64 v[188:189], v242 offset:0
    v_mfma_f32_16x16x32_bf16 v[36:39], v[76:79], v[128:131], v[36:39]
    ds_read_b64 v[190:191], v242 offset:8
    v_mfma_f32_16x16x32_bf16 v[36:39], v[80:83], v[124:127], v[36:39]
    v_mfma_f32_16x16x32_bf16 v[36:39], v[84:87], v[120:123], v[36:39]
    v_mfma_f32_16x16x32_bf16 v[36:39], v[88:91], v[116:119], v[36:39]
    v_mfma_f32_16x16x32_bf16 v[36:39], v[92:95], v[112:115], v[36:39]
    v_mfma_f32_16x16x32_bf16 v[36:39], v[96:99], v[108:111], v[36:39]
    v_mfma_f32_16x16x32_bf16 v[36:39], v[100:103], v[104:107], v[36:39]
    s_waitcnt lgkmcnt(15)
    v_mfma_f32_16x16x32_bf16 v[8:11], v[160:163], v[192:195], v[8:11]
    s_waitcnt lgkmcnt(15)
    v_mfma_f32_16x16x32_bf16 v[12:15], v[160:163], v[196:199], v[12:15]
    v_mfma_f32_16x16x32_bf16 v[12:15], v[164:167], v[192:195], v[12:15]
    s_waitcnt lgkmcnt(15)
    v_mfma_f32_16x16x32_bf16 v[16:19], v[160:163], v[200:203], v[16:19]
    v_mfma_f32_16x16x32_bf16 v[16:19], v[164:167], v[196:199], v[16:19]
    v_mfma_f32_16x16x32_bf16 v[16:19], v[168:171], v[192:195], v[16:19]
    s_waitcnt lgkmcnt(12)
    v_mfma_f32_16x16x32_bf16 v[20:23], v[160:163], v[204:207], v[20:23]
    ds_read_b128 v[104:107], v247 offset:192
    v_mfma_f32_16x16x32_bf16 v[20:23], v[164:167], v[200:203], v[20:23]
    ds_read_b64 v[72:73], v246 offset:3776
    v_mfma_f32_16x16x32_bf16 v[20:23], v[168:171], v[196:199], v[20:23]
    ds_read_b64 v[74:75], v246 offset:3784
    v_mfma_f32_16x16x32_bf16 v[20:23], v[172:175], v[192:195], v[20:23]
    ds_read_b128 v[108:111], v247 offset:704
    s_waitcnt lgkmcnt(13)
    v_mfma_f32_16x16x32_bf16 v[24:27], v[160:163], v[208:211], v[24:27]
    ds_read_b64 v[76:77], v246 offset:3264
    v_mfma_f32_16x16x32_bf16 v[24:27], v[164:167], v[204:207], v[24:27]
    ds_read_b64 v[78:79], v246 offset:3272
    v_mfma_f32_16x16x32_bf16 v[24:27], v[168:171], v[200:203], v[24:27]
    ds_read_b128 v[112:115], v247 offset:1216
    v_mfma_f32_16x16x32_bf16 v[24:27], v[172:175], v[196:199], v[24:27]
    ds_read_b64 v[80:81], v246 offset:2752
    v_mfma_f32_16x16x32_bf16 v[24:27], v[176:179], v[192:195], v[24:27]
    ds_read_b64 v[82:83], v246 offset:2760
    s_waitcnt lgkmcnt(15)
    v_mfma_f32_16x16x32_bf16 v[28:31], v[160:163], v[212:215], v[28:31]
    ds_read_b128 v[116:119], v247 offset:1728
    v_mfma_f32_16x16x32_bf16 v[28:31], v[164:167], v[208:211], v[28:31]
    ds_read_b64 v[84:85], v246 offset:2240
    v_mfma_f32_16x16x32_bf16 v[28:31], v[168:171], v[204:207], v[28:31]
    ds_read_b64 v[86:87], v246 offset:2248
    v_mfma_f32_16x16x32_bf16 v[28:31], v[172:175], v[200:203], v[28:31]
    ds_read_b128 v[120:123], v247 offset:2240
    v_mfma_f32_16x16x32_bf16 v[28:31], v[176:179], v[196:199], v[28:31]
    ds_read_b64 v[88:89], v246 offset:1728
    v_mfma_f32_16x16x32_bf16 v[28:31], v[180:183], v[192:195], v[28:31]
    ds_read_b64 v[90:91], v246 offset:1736
    s_waitcnt lgkmcnt(15)
    v_mfma_f32_16x16x32_bf16 v[32:35], v[160:163], v[216:219], v[32:35]
    ds_read_b128 v[124:127], v247 offset:2752
    v_mfma_f32_16x16x32_bf16 v[32:35], v[164:167], v[212:215], v[32:35]
    ds_read_b64 v[92:93], v246 offset:1216
    v_mfma_f32_16x16x32_bf16 v[32:35], v[168:171], v[208:211], v[32:35]
    ds_read_b64 v[94:95], v246 offset:1224
    v_mfma_f32_16x16x32_bf16 v[32:35], v[172:175], v[204:207], v[32:35]
    ds_read_b128 v[128:131], v247 offset:3264
    v_mfma_f32_16x16x32_bf16 v[32:35], v[176:179], v[200:203], v[32:35]
    ds_read_b64 v[96:97], v246 offset:704
    v_mfma_f32_16x16x32_bf16 v[32:35], v[180:183], v[196:199], v[32:35]
    ds_read_b64 v[98:99], v246 offset:712
    v_mfma_f32_16x16x32_bf16 v[32:35], v[184:187], v[192:195], v[32:35]
    ds_read_b128 v[132:135], v247 offset:3776
    s_waitcnt lgkmcnt(15)
    v_mfma_f32_16x16x32_bf16 v[36:39], v[160:163], v[220:223], v[36:39]
    ds_read_b64 v[100:101], v246 offset:192
    v_mfma_f32_16x16x32_bf16 v[36:39], v[164:167], v[216:219], v[36:39]
    ds_read_b64 v[102:103], v246 offset:200
    v_mfma_f32_16x16x32_bf16 v[36:39], v[168:171], v[212:215], v[36:39]
    v_mfma_f32_16x16x32_bf16 v[36:39], v[172:175], v[208:211], v[36:39]
    v_mfma_f32_16x16x32_bf16 v[36:39], v[176:179], v[204:207], v[36:39]
    v_mfma_f32_16x16x32_bf16 v[36:39], v[180:183], v[200:203], v[36:39]
    v_mfma_f32_16x16x32_bf16 v[36:39], v[184:187], v[196:199], v[36:39]
    v_mfma_f32_16x16x32_bf16 v[36:39], v[188:191], v[192:195], v[36:39]
    s_sub_u32 s62, s52, 4
    s_lshl_b32 s63, s62, 13
    s_add_u32 s63, s63, 102912
    s_lshl_b32 s62, s62, 12
    s_add_u32 s62, s62, 86528
    v_add_u32 v3, s63, v244
    v_add_u32 v4, s62, v244
    v_mov_b32 v5, s57
    s_mov_b64 exec, 1
    ds_write_b32 v248, v5 offset:192
    s_mov_b64 exec, -1
    s_bitcmp1_b32 s54, 0
    s_cbranch_scc1 L_conv_odd
    s_waitcnt lgkmcnt(15)
    v_mfma_f32_16x16x32_bf16 v[40:43], v[72:75], v[104:107], 0
    ds_read_b128 v[192:195], v247 offset:128
    ds_read_b64 v[160:161], v246 offset:3712
    s_waitcnt lgkmcnt(15)
    v_mfma_f32_16x16x32_bf16 v[48:51], v[72:75], v[112:115], 0
    ds_read_b64 v[162:163], v246 offset:3720
    ds_read_b128 v[196:199], v247 offset:640
    v_mfma_f32_16x16x32_bf16 v[48:51], v[76:79], v[108:111], v[48:51]
    ds_read_b64 v[164:165], v246 offset:3200
    ds_read_b64 v[166:167], v246 offset:3208
    v_mfma_f32_16x16x32_bf16 v[48:51], v[80:83], v[104:107], v[48:51]
    ds_read_b128 v[200:203], v247 offset:1152
    ds_read_b64 v[168:169], v246 offset:2688
    s_waitcnt lgkmcnt(14)
    v_mfma_f32_16x16x32_bf16 v[60:63], v[72:75], v[124:127], 0
    ds_read_b64 v[170:171], v246 offset:2696
    ds_read_b128 v[204:207], v247 offset:1664
    v_mfma_f32_16x16x32_bf16 v[60:63], v[76:79], v[120:123], v[60:63]
    ds_read_b64 v[172:173], v246 offset:2176
    ds_read_b64 v[174:175], v246 offset:2184
    v_mfma_f32_16x16x32_bf16 v[60:63], v[80:83], v[116:119], v[60:63]
    ds_read_b128 v[208:211], v247 offset:2176
    ds_read_b64 v[176:177], v246 offset:1664
    v_mfma_f32_16x16x32_bf16 v[60:63], v[84:87], v[112:115], v[60:63]
    ds_read_b64 v[178:179], v246 offset:1672
    ds_read_b128 v[212:215], v247 offset:2688
    v_mfma_f32_16x16x32_bf16 v[60:63], v[88:91], v[108:111], v[60:63]
    ds_read_b64 v[180:181], v246 offset:1152
    ds_read_b64 v[182:183], v246 offset:1160
    v_mfma_f32_16x16x32_bf16 v[60:63], v[92:95], v[104:107], v[60:63]
    ds_read_b128 v[216:219], v247 offset:3200
    ds_read_b64 v[184:185], v246 offset:640
    s_waitcnt lgkmcnt(15)
    v_mfma_f32_16x16x32_bf16 v[68:71], v[72:75], v[132:135], 0
    ds_read_b64 v[186:187], v246 offset:648
    ds_read_b128 v[220:223], v247 offset:3712
    v_mfma_f32_16x16x32_bf16 v[68:71], v[76:79], v[128:131], v[68:71]
    ds_read_b64 v[188:189], v246 offset:128
    ds_read_b64 v[190:191], v246 offset:136
    v_mfma_f32_16x16x32_bf16 v[68:71], v[80:83], v[124:127], v[68:71]
    v_mfma_f32_16x16x32_bf16 v[68:71], v[84:87], v[120:123], v[68:71]
    v_mfma_f32_16x16x32_bf16 v[68:71], v[88:91], v[116:119], v[68:71]
    v_mfma_f32_16x16x32_bf16 v[68:71], v[92:95], v[112:115], v[68:71]
    v_mfma_f32_16x16x32_bf16 v[68:71], v[96:99], v[108:111], v[68:71]
    v_mfma_f32_16x16x32_bf16 v[68:71], v[100:103], v[104:107], v[68:71]
    s_mov_b32 s69, 0
L_ev_14:
    ds_read_b32 v2, v249 offset:192
    s_add_u32 s69, s69, 1
    s_waitcnt lgkmcnt(0)
    v_cmp_eq_u32 vcc, v2, v5
    s_cmp_ge_u32 s69, 1000000
    s_cbranch_scc1 L_evd_14
    s_nop 1
    s_and_b32 s62, vcc_lo, 240
    s_cmp_eq_u32 s62, 240
    s_cbranch_scc1 L_evd_14
    s_sleep 1
    s_branch L_ev_14
L_evd_14:
    v_mfma_f32_16x16x32_bf16 v[40:43], v[160:163], v[192:195], v[40:43]
    v_mfma_f32_16x16x32_bf16 v[48:51], v[160:163], v[200:203], v[48:51]
    ds_write_b128 v3, v[8:11] offset:0
    v_mfma_f32_16x16x32_bf16 v[48:51], v[164:167], v[196:199], v[48:51]
    v_mfma_f32_16x16x32_bf16 v[48:51], v[168:171], v[192:195], v[48:51]
    ds_write_b128 v3, v[12:15] offset:1024
    v_mfma_f32_16x16x32_bf16 v[60:63], v[160:163], v[212:215], v[60:63]
    v_mfma_f32_16x16x32_bf16 v[60:63], v[164:167], v[208:211], v[60:63]
    ds_write_b128 v3, v[16:19] offset:2048
    v_mfma_f32_16x16x32_bf16 v[60:63], v[168:171], v[204:207], v[60:63]
    v_mfma_f32_16x16x32_bf16 v[60:63], v[172:175], v[200:203], v[60:63]
    ds_write_b128 v3, v[20:23] offset:3072
    v_mfma_f32_16x16x32_bf16 v[60:63], v[176:179], v[196:199], v[60:63]
    v_mfma_f32_16x16x32_bf16 v[60:63], v[180:183], v[192:195], v[60:63]
    ds_write_b128 v3, v[24:27] offset:4096
    v_mfma_f32_16x16x32_bf16 v[68:71], v[160:163], v[220:223], v[68:71]
    v_mfma_f32_16x16x32_bf16 v[68:71], v[164:167], v[216:219], v[68:71]
    ds_write_b128 v3, v[28:31] offset:5120
    v_mfma_f32_16x16x32_bf16 v[68:71], v[168:171], v[212:215], v[68:71]
    v_mfma_f32_16x16x32_bf16 v[68:71], v[172:175], v[208:211], v[68:71]
    ds_write_b128 v3, v[32:35] offset:6144
    v_mfma_f32_16x16x32_bf16 v[68:71], v[176:179], v[204:207], v[68:71]
    v_mfma_f32_16x16x32_bf16 v[68:71], v[180:183], v[200:203], v[68:71]
    ds_write_b128 v3, v[36:39] offset:7168
    v_mfma_f32_16x16x32_bf16 v[68:71], v[184:187], v[196:199], v[68:71]
    v_mfma_f32_16x16x32_bf16 v[68:71], v[188:191], v[192:195], v[68:71]
    s_nop 7
    ds_write_b128 v4, v[40:43] offset:0
    ds_write_b128 v4, v[48:51] offset:1024
    ds_write_b128 v4, v[60:63] offset:2048
    ds_write_b128 v4, v[68:71] offset:3072
    s_branch L_conv_done
L_conv_odd:
    s_waitcnt lgkmcnt(15)
    v_mfma_f32_16x16x32_bf16 v[44:47], v[72:75], v[108:111], 0
    ds_read_b128 v[192:195], v247 offset:128
    ds_read_b64 v[160:161], v246 offset:3712
    v_mfma_f32_16x16x32_bf16 v[44:47], v[76:79], v[104:107], v[44:47]
    ds_read_b64 v[162:163], v246 offset:3720
    ds_read_b128 v[196:199], v247 offset:640
    s_waitcnt lgkmcnt(15)
    v_mfma_f32_16x16x32_bf16 v[52:55], v[72:75], v[116:119], 0
    ds_read_b64 v[164:165], v246 offset:3200
    ds_read_b64 v[166:167], v246 offset:3208
    v_mfma_f32_16x16x32_bf16 v[52:55], v[76:79], v[112:115], v[52:55]
    ds_read_b128 v[200:203], v247 offset:1152
    ds_read_b64 v[168:169], v246 offset:2688
    v_mfma_f32_16x16x32_bf16 v[52:55], v[80:83], v[108:111], v[52:55]
    ds_read_b64 v[170:171], v246 offset:2696
    ds_read_b128 v[204:207], v247 offset:1664
    v_mfma_f32_16x16x32_bf16 v[52:55], v[84:87], v[104:107], v[52:55]
    ds_read_b64 v[172:173], v246 offset:2176
    ds_read_b64 v[174:175], v246 offset:2184
    s_waitcnt lgkmcnt(15)
    v_mfma_f32_16x16x32_bf16 v[56:59], v[72:75], v[120:123], 0
    ds_read_b128 v[208:211], v247 offset:2176
    ds_read_b64 v[176:177], v246 offset:1664
    v_mfma_f32_16x16x32_bf16 v[56:59], v[76:79], v[116:119], v[56:59]
    ds_read_b64 v[178:179], v246 offset:1672
    ds_read_b128 v[212:215], v247 offset:2688
    v_mfma_f32_16x16x32_bf16 v[56:59], v[80:83], v[112:115], v[56:59]
    ds_read_b64 v[180:181], v246 offset:1152
    ds_read_b64 v[182:183], v246 offset:1160
    v_mfma_f32_16x16x32_bf16 v[56:59], v[84:87], v[108:111], v[56:59]
    ds_read_b128 v[216:219], v247 offset:3200
    ds_read_b64 v[184:185], v246 offset:640
    v_mfma_f32_16x16x32_bf16 v[56:59], v[88:91], v[104:107], v[56:59]
    ds_read_b64 v[186:187], v246 offset:648
    ds_read_b128 v[220:223], v247 offset:3712
    s_waitcnt lgkmcnt(15)
    v_mfma_f32_16x16x32_bf16 v[64:67], v[72:75], v[128:131], 0
    ds_read_b64 v[188:189], v246 offset:128
    ds_read_b64 v[190:191], v246 offset:136
    v_mfma_f32_16x16x32_bf16 v[64:67], v[76:79], v[124:127], v[64:67]
    v_mfma_f32_16x16x32_bf16 v[64:67], v[80:83], v[120:123], v[64:67]
    v_mfma_f32_16x16x32_bf16 v[64:67], v[84:87], v[116:119], v[64:67]
    v_mfma_f32_16x16x32_bf16 v[64:67], v[88:91], v[112:115], v[64:67]
    v_mfma_f32_16x16x32_bf16 v[64:67], v[92:95], v[108:111], v[64:67]
    v_mfma_f32_16x16x32_bf16 v[64:67], v[96:99], v[104:107], v[64:67]
    s_mov_b32 s69, 0
L_ev_15:
    ds_read_b32 v2, v249 offset:192
    s_add_u32 s69, s69, 1
    s_waitcnt lgkmcnt(0)
    v_cmp_eq_u32 vcc, v2, v5
    s_cmp_ge_u32 s69, 1000000
    s_cbranch_scc1 L_evd_15
    s_nop 1
    s_and_b32 s62, vcc_lo, 240
    s_cmp_eq_u32 s62, 240
    s_cbranch_scc1 L_evd_15
    s_sleep 1
    s_branch L_ev_15
L_evd_15:
    v_mfma_f32_16x16x32_bf16 v[44:47], v[160:163], v[196:199], v[44:47]
    v_mfma_f32_16x16x32_bf16 v[44:47], v[164:167], v[192:195], v[44:47]
    ds_write_b128 v3, v[8:11] offset:0
    v_mfma_f32_16x16x32_bf16 v[52:55], v[160:163], v[204:207], v[52:55]
    v_mfma_f32_16x16x32_bf16 v[52:55], v[164:167], v[200:203], v[52:55]
    ds_write_b128 v3, v[12:15] offset:1024
    v_mfma_f32_16x16x32_bf16 v[52:55], v[168:171], v[196:199], v[52:55]
    v_mfma_f32_16x16x32_bf16 v[52:55], v[172:175], v[192:195], v[52:55]
    ds_write_b128 v3, v[16:19] offset:2048
    v_mfma_f32_16x16x32_bf16 v[56:59], v[160:163], v[208:211], v[56:59]
    v_mfma_f32_16x16x32_bf16 v[56:59], v[164:167], v[204:207], v[56:59]
    ds_write_b128 v3, v[20:23] offset:3072
    v_mfma_f32_16x16x32_bf16 v[56:59], v[168:171], v[200:203], v[56:59]
    v_mfma_f32_16x16x32_bf16 v[56:59], v[172:175], v[196:199], v[56:59]
    ds_write_b128 v3, v[24:27] offset:4096
    v_mfma_f32_16x16x32_bf16 v[56:59], v[176:179], v[192:195], v[56:59]
    v_mfma_f32_16x16x32_bf16 v[64:67], v[160:163], v[216:219], v[64:67]
    ds_write_b128 v3, v[28:31] offset:5120
    v_mfma_f32_16x16x32_bf16 v[64:67], v[164:167], v[212:215], v[64:67]
    v_mfma_f32_16x16x32_bf16 v[64:67], v[168:171], v[208:211], v[64:67]
    ds_write_b128 v3, v[32:35] offset:6144
    v_mfma_f32_16x16x32_bf16 v[64:67], v[172:175], v[204:207], v[64:67]
    v_mfma_f32_16x16x32_bf16 v[64:67], v[176:179], v[200:203], v[64:67]
    ds_write_b128 v3, v[36:39] offset:7168
    v_mfma_f32_16x16x32_bf16 v[64:67], v[180:183], v[196:199], v[64:67]
    v_mfma_f32_16x16x32_bf16 v[64:67], v[184:187], v[192:195], v[64:67]
    s_nop 7
    ds_write_b128 v4, v[44:47] offset:0
    ds_write_b128 v4, v[52:55] offset:1024
    ds_write_b128 v4, v[56:59] offset:2048
    ds_write_b128 v4, v[64:67] offset:3072
L_conv_done:
    s_mov_b32 s69, 0
L_ev_16:
    ds_read_b32 v2, v249 offset:320
    s_add_u32 s69, s69, 1
    s_waitcnt lgkmcnt(0)
    v_cmp_eq_u32 vcc, v2, v5
    s_cmp_ge_u32 s69, 1000000
    s_cbranch_scc1 L_evd_16
    s_nop 1
    s_and_b32 s62, vcc_lo, 15
    s_cmp_eq_u32 s62, 15
    s_cbranch_scc1 L_evd_16
    s_sleep 1
    s_branch L_ev_16
L_evd_16:
    s_mov_b64 exec, 1
    ds_write_b32 v248, v5 offset:352
    s_mov_b64 exec, -1
    ds_read2_b64 v[156:159], v224 offset0:0 offset1:1
    ds_read2_b64 v[160:163], v224 offset0:10 offset1:11
    ds_read_b64 v[164:165], v225 offset:32
    v_mov_b32 v64, 0
    v_mov_b32 v65, 0
    v_mov_b32 v66, 0
    v_mov_b32 v67, 0
    v_mov_b32 v68, 0
    v_mov_b32 v69, 0
    v_mov_b32 v70, 0
    v_mov_b32 v71, 0
    s_nop 0
    v_mfma_f32_32x32x16_bf16 v[104:119], v[64:67], v[64:67], 0
    v_mfma_f32_32x32x16_bf16 v[120:135], v[64:67], v[64:67], 0
    ds_read_b128 v[136:139], v153
    ds_read_b64 v[140:141], v154 offset:2048
    s_waitcnt lgkmcnt(0)
    v_mfma_f32_32x32x16_bf16 v[8:23], v[136:139], v[156:159], 0
    v_mfma_f32_32x32x16_bf16 v[24:39], v[136:139], v[160:163], 0
    ds_read_b128 v[136:139], v153 offset:1024
    s_mov_b64 exec, s[60:61]
    ds_read_b128 v[144:147], v155 offset:2560
    s_mov_b64 exec, -1
    s_nop 7
    v_mfma_f32_32x32x4bf16_1k v[8:39], v[140:141], v[164:165], v[8:39] cbsz:1 abid:0
    s_nop 15
    s_nop 2
    s_mov_b32 s69, 0
L_ev_17:
    ds_read_b32 v2, v249 offset:352
    s_add_u32 s69, s69, 1
    s_waitcnt lgkmcnt(0)
    v_cmp_eq_u32 vcc, v2, v5
    s_cmp_ge_u32 s69, 1000000
    s_cbranch_scc1 L_evd_17
    s_nop 1
    s_and_b32 s62, vcc_lo, 240
    s_cmp_eq_u32 s62, 240
    s_cbranch_scc1 L_evd_17
    s_sleep 1
    s_branch L_ev_17
L_evd_17:
    s_sub_u32 s65, s52, 4
    s_lshl_b32 s62, s65, 11
    s_add_u32 s62, s62, 102912
    v_add_u32 v2, s62, v251
    s_lshl_b32 s62, s65, 10
    s_add_u32 s62, s62, 86528
    v_add_u32 v3, s62, v251
    ds_read_b128 v[72:75], v2 offset:0
    ds_read_b128 v[76:79], v2 offset:8192
    ds_read_b128 v[80:83], v2 offset:16384
    ds_read_b128 v[84:87], v2 offset:24576
    ds_read_b128 v[88:91], v2 offset:1024
    ds_read_b128 v[92:95], v2 offset:9216
    ds_read_b128 v[96:99], v2 offset:17408
    ds_read_b128 v[100:103], v2 offset:25600
    ds_read_b128 v[166:169], v3 offset:0
    ds_read_b128 v[170:173], v3 offset:4096
    ds_read_b128 v[174:177], v3 offset:8192
    ds_read_b128 v[178:181], v3 offset:12288
    s_lshl_b32 s63, s58, 12
    s_add_u32 s63, s63, 2883584
    s_add_u32 s64, s63, 4096
    s_mov_b32 s67, 12
    s_bitcmp1_b32 s54, 0
    s_cselect_b32 s67, 3, s67
    s_lshr_b32 s67, s67, s65
    s_and_b32 s67, s67, 1
    s_lshl_b32 s67, s67, 9
    s_lshl_b32 s66, s59, 12
    s_add_u32 s66, s66, s67
    s_add_u32 s66, s66, 2883584
    s_waitcnt lgkmcnt(10)
    v_add_f32 v72, v72, v76
    v_add_f32 v73, v73, v77
    v_add_f32 v74, v74, v78
    v_add_f32 v75, v75, v79
    v_cvt_pk_bf16_f32 v76, v72, v73
    v_cvt_pk_bf16_f32 v77, v74, v75
    buffer_store_dwordx2 v[76:77], v252, s[44:47], s63 offen offset:0 sc1
    s_waitcnt lgkmcnt(8)
    v_add_f32 v80, v80, v84
    v_add_f32 v81, v81, v85
    v_add_f32 v82, v82, v86
    v_add_f32 v83, v83, v87
    v_cvt_pk_bf16_f32 v84, v80, v81
    v_cvt_pk_bf16_f32 v85, v82, v83
    buffer_store_dwordx2 v[84:85], v252, s[44:47], s64 offen offset:0 sc1
    s_waitcnt lgkmcnt(6)
    v_add_f32 v88, v88, v92
    v_add_f32 v89, v89, v93
    v_add_f32 v90, v90, v94
    v_add_f32 v91, v91, v95
    v_cvt_pk_bf16_f32 v92, v88, v89
    v_cvt_pk_bf16_f32 v93, v90, v91
    buffer_store_dwordx2 v[92:93], v252, s[44:47], s63 offen offset:512 sc1
    s_waitcnt lgkmcnt(4)
    v_add_f32 v96, v96, v100
    v_add_f32 v97, v97, v101
    v_add_f32 v98, v98, v102
    v_add_f32 v99, v99, v103
    v_cvt_pk_bf16_f32 v100, v96, v97
    v_cvt_pk_bf16_f32 v101, v98, v99
    buffer_store_dwordx2 v[100:101], v252, s[44:47], s64 offen offset:512 sc1
    s_waitcnt lgkmcnt(0)
    v_add_f32 v166, v166, v170
    v_add_f32 v174, v174, v178
    v_add_f32 v167, v167, v171
    v_add_f32 v175, v175, v179
    v_add_f32 v168, v168, v172
    v_add_f32 v176, v176, v180
    v_add_f32 v169, v169, v173
    v_add_f32 v177, v177, v181
    v_add_f32 v166, v166, v174
    v_add_f32 v167, v167, v175
    v_add_f32 v168, v168, v176
    v_add_f32 v169, v169, v177
    v_cvt_pk_bf16_f32 v170, v166, v167
    v_cvt_pk_bf16_f32 v171, v168, v169
    buffer_store_dwordx2 v[170:171], v252, s[44:47], s66 offen sc1
    s_setprio 3
L_join:
    s_mov_b32 s48, s28
    s_mov_b32 s49, s29
    s_mov_b32 s50, 5242880
    s_mov_b32 s51, 0x00020000
    s_lshl_b32 s90, s52, 10
    s_add_u32 s90, s90, 40960
    s_add_u32 s91, s90, 65536
    s_waitcnt lgkmcnt(1)
    v_mfma_f32_32x32x16_bf16 v[40:55], v[136:139], v[156:159], 0
    v_exp_f32 v8, v8
    v_exp_f32 v9, v9
    v_exp_f32 v10, v10
    v_exp_f32 v11, v11
    v_smfmac_f32_32x32x32_bf16 v[120:135], v[148:151], v[64:71], v152
    s_mov_b64 exec, s[60:61]
    ds_read_b128 v[148:151], v155 offset:3200
    s_mov_b64 exec, -1
    v_exp_f32 v12, v12
    v_exp_f32 v13, v13
    v_exp_f32 v14, v14
    v_exp_f32 v15, v15
    v_mfma_f32_32x32x16_bf16 v[56:71], v[136:139], v[160:163], 0
    ds_read_b128 v[136:139], v153 offset:10240
    v_exp_f32 v16, v16
    v_exp_f32 v17, v17
    v_exp_f32 v18, v18
    v_exp_f32 v19, v19
    s_waitcnt lgkmcnt(2)
    v_smfmac_f32_32x32x32_bf16 v[104:119], v[144:147], v[8:15], v152
    s_mov_b32 m0, s90
    s_add_u32 s90, s90, 8192
    buffer_load_dwordx4 v1, s[44:47], s91 offen sc1 lds
    s_add_u32 s91, s91, 8192
    v_exp_f32 v20, v20
    v_exp_f32 v21, v21
    v_exp_f32 v22, v22
    v_exp_f32 v23, v23
    v_mfma_f32_32x32x4bf16_1k v[40:71], v[140:141], v[164:165], v[40:71] cbsz:1 abid:1
    ds_read_b64 v[140:141], v154 offset:12288
    v_exp_f32 v24, v24
    v_exp_f32 v25, v25
    v_exp_f32 v26, v26
    v_exp_f32 v27, v27
    s_mov_b32 m0, s90
    s_add_u32 s90, s90, 8192
    buffer_load_dwordx4 v1, s[44:47], s91 offen sc1 lds
    s_add_u32 s91, s91, 8192
    v_exp_f32 v28, v28
    v_exp_f32 v29, v29
    v_exp_f32 v30, v30
    v_exp_f32 v31, v31
    s_waitcnt lgkmcnt(2)
    v_smfmac_f32_32x32x32_bf16 v[104:119], v[148:151], v[16:23], v152
    v_exp_f32 v32, v32
    v_exp_f32 v33, v33
    v_exp_f32 v34, v34
    v_exp_f32 v35, v35
    v_smfmac_f32_32x32x32_bf16 v[120:135], v[144:147], v[24:31], v152
    s_mov_b64 exec, s[60:61]
    ds_read_b128 v[144:147], v155 offset:3840
    s_mov_b64 exec, -1
    s_mov_b32 m0, s90
    s_add_u32 s90, s90, 8192
    buffer_load_dwordx4 v1, s[44:47], s91 offen sc1 lds
    s_add_u32 s91, s91, 8192
    v_exp_f32 v36, v36
    v_exp_f32 v37, v37
    v_exp_f32 v38, v38
    v_exp_f32 v39, v39
    s_waitcnt lgkmcnt(1)
    v_mfma_f32_32x32x16_bf16 v[8:23], v[136:139], v[156:159], 0
    v_exp_f32 v40, v40
    v_exp_f32 v41, v41
    v_exp_f32 v42, v42
    v_exp_f32 v43, v43
    v_smfmac_f32_32x32x32_bf16 v[120:135], v[148:151], v[32:39], v152
    s_mov_b64 exec, s[60:61]
    ds_read_b128 v[148:151], v155 offset:4480
    s_mov_b64 exec, -1
    v_exp_f32 v44, v44
    v_exp_f32 v45, v45
    v_exp_f32 v46, v46
    v_exp_f32 v47, v47
    v_mfma_f32_32x32x16_bf16 v[24:39], v[136:139], v[160:163], 0
    ds_read_b128 v[136:139], v153 offset:11264
    v_exp_f32 v48, v48
    v_exp_f32 v49, v49
    v_exp_f32 v50, v50
    v_exp_f32 v51, v51
    s_waitcnt lgkmcnt(2)
    v_smfmac_f32_32x32x32_bf16 v[104:119], v[144:147], v[40:47], v152
    s_mov_b32 m0, s90
    s_add_u32 s90, s90, 8192
    buffer_load_dwordx4 v1, s[44:47], s91 offen sc1 lds
    s_add_u32 s91, s91, 8192
    v_exp_f32 v52, v52
    v_exp_f32 v53, v53
    v_exp_f32 v54, v54
    v_exp_f32 v55, v55
    v_mfma_f32_32x32x4bf16_1k v[8:39], v[140:141], v[164:165], v[8:39] cbsz:1 abid:0
    v_exp_f32 v56, v56
    v_exp_f32 v57, v57
    v_exp_f32 v58, v58
    v_exp_f32 v59, v59
    s_mov_b32 m0, s90
    s_add_u32 s90, s90, 8192
    buffer_load_dwordx4 v1, s[44:47], s91 offen sc1 lds
    s_add_u32 s91, s91, 8192
    v_exp_f32 v60, v60
    v_exp_f32 v61, v61
    v_exp_f32 v62, v62
    v_exp_f32 v63, v63
    s_waitcnt lgkmcnt(1)
    v_smfmac_f32_32x32x32_bf16 v[104:119], v[148:151], v[48:55], v152
    v_exp_f32 v64, v64
    v_exp_f32 v65, v65
    v_exp_f32 v66, v66
    v_exp_f32 v67, v67
    v_smfmac_f32_32x32x32_bf16 v[120:135], v[144:147], v[56:63], v152
    s_mov_b64 exec, s[60:61]
    ds_read_b128 v[144:147], v155 offset:12800
    s_mov_b64 exec, -1
    v_exp_f32 v68, v68
    v_exp_f32 v69, v69
    v_exp_f32 v70, v70
    v_exp_f32 v71, v71
    s_waitcnt lgkmcnt(1)
    v_mfma_f32_32x32x16_bf16 v[40:55], v[136:139], v[156:159], 0
    v_exp_f32 v8, v8
    v_exp_f32 v9, v9
    v_exp_f32 v10, v10
    v_exp_f32 v11, v11
    v_smfmac_f32_32x32x32_bf16 v[120:135], v[148:151], v[64:71], v152
    s_mov_b64 exec, s[60:61]
    ds_read_b128 v[148:151], v155 offset:13440
    s_mov_b64 exec, -1
    v_exp_f32 v12, v12
    v_exp_f32 v13, v13
    v_exp_f32 v14, v14
    v_exp_f32 v15, v15
    v_mfma_f32_32x32x16_bf16 v[56:71], v[136:139], v[160:163], 0
    ds_read_b128 v[136:139], v153 offset:20480
    v_exp_f32 v16, v16
    v_exp_f32 v17, v17
    v_exp_f32 v18, v18
    v_exp_f32 v19, v19
    s_waitcnt lgkmcnt(2)
    v_smfmac_f32_32x32x32_bf16 v[104:119], v[144:147], v[8:15], v152
    v_exp_f32 v20, v20
    v_exp_f32 v21, v21
    v_exp_f32 v22, v22
    v_exp_f32 v23, v23
    v_mfma_f32_32x32x4bf16_1k v[40:71], v[140:141], v[164:165], v[40:71] cbsz:1 abid:1
    ds_read_b64 v[140:141], v154 offset:22528
    v_exp_f32 v24, v24
    v_exp_f32 v25, v25
    v_exp_f32 v26, v26
    v_exp_f32 v27, v27
    v_exp_f32 v28, v28
    v_exp_f32 v29, v29
    v_exp_f32 v30, v30
    v_exp_f32 v31, v31
    s_waitcnt lgkmcnt(2)
    v_smfmac_f32_32x32x32_bf16 v[104:119], v[148:151], v[16:23], v152
    v_exp_f32 v32, v32
    v_exp_f32 v33, v33
    v_exp_f32 v34, v34
    v_exp_f32 v35, v35
    v_smfmac_f32_32x32x32_bf16 v[120:135], v[144:147], v[24:31], v152
    s_mov_b64 exec, s[60:61]
    ds_read_b128 v[144:147], v155 offset:14080
    s_mov_b64 exec, -1
    v_exp_f32 v36, v36
    v_exp_f32 v37, v37
    v_exp_f32 v38, v38
    v_exp_f32 v39, v39
    s_waitcnt lgkmcnt(1)
    v_mfma_f32_32x32x16_bf16 v[8:23], v[136:139], v[156:159], 0
    v_exp_f32 v40, v40
    v_exp_f32 v41, v41
    v_exp_f32 v42, v42
    v_exp_f32 v43, v43
    v_smfmac_f32_32x32x32_bf16 v[120:135], v[148:151], v[32:39], v152
    s_mov_b64 exec, s[60:61]
    ds_read_b128 v[148:151], v155 offset:14720
    s_mov_b64 exec, -1
    v_exp_f32 v44, v44
    v_exp_f32 v45, v45
    v_exp_f32 v46, v46
    v_exp_f32 v47, v47
    v_mfma_f32_32x32x16_bf16 v[24:39], v[136:139], v[160:163], 0
    ds_read_b128 v[136:139], v153 offset:21504
    v_exp_f32 v48, v48
    v_exp_f32 v49, v49
    v_exp_f32 v50, v50
    v_exp_f32 v51, v51
    s_waitcnt lgkmcnt(2)
    v_smfmac_f32_32x32x32_bf16 v[104:119], v[144:147], v[40:47], v152
    v_exp_f32 v52, v52
    v_exp_f32 v53, v53
    v_exp_f32 v54, v54
    v_exp_f32 v55, v55
    v_mfma_f32_32x32x4bf16_1k v[8:39], v[140:141], v[164:165], v[8:39] cbsz:1 abid:0
    v_exp_f32 v56, v56
    v_exp_f32 v57, v57
    v_exp_f32 v58, v58
    v_exp_f32 v59, v59
    v_exp_f32 v60, v60
    v_exp_f32 v61, v61
    v_exp_f32 v62, v62
    v_exp_f32 v63, v63
    s_waitcnt lgkmcnt(1)
    v_smfmac_f32_32x32x32_bf16 v[104:119], v[148:151], v[48:55], v152
    v_exp_f32 v64, v64
    v_exp_f32 v65, v65
    v_exp_f32 v66, v66
    v_exp_f32 v67, v67
    v_smfmac_f32_32x32x32_bf16 v[120:135], v[144:147], v[56:63], v152
    s_mov_b64 exec, s[60:61]
    ds_read_b128 v[144:147], v155 offset:23040
    s_mov_b64 exec, -1
    v_exp_f32 v68, v68
    v_exp_f32 v69, v69
    v_exp_f32 v70, v70
    v_exp_f32 v71, v71
    s_waitcnt lgkmcnt(1)
    v_mfma_f32_32x32x16_bf16 v[40:55], v[136:139], v[156:159], 0
    v_exp_f32 v8, v8
    v_exp_f32 v9, v9
    v_exp_f32 v10, v10
    v_exp_f32 v11, v11
    v_smfmac_f32_32x32x32_bf16 v[120:135], v[148:151], v[64:71], v152
    s_mov_b64 exec, s[60:61]
    ds_read_b128 v[148:151], v155 offset:23680
    s_mov_b64 exec, -1
    v_exp_f32 v12, v12
    v_exp_f32 v13, v13
    v_exp_f32 v14, v14
    v_exp_f32 v15, v15
    v_mfma_f32_32x32x16_bf16 v[56:71], v[136:139], v[160:163], 0
    ds_read_b128 v[136:139], v153 offset:30720
    v_exp_f32 v16, v16
    v_exp_f32 v17, v17
    v_exp_f32 v18, v18
    v_exp_f32 v19, v19
    s_waitcnt lgkmcnt(2)
    v_smfmac_f32_32x32x32_bf16 v[104:119], v[144:147], v[8:15], v152
    v_exp_f32 v20, v20
    v_exp_f32 v21, v21
    v_exp_f32 v22, v22
    v_exp_f32 v23, v23
    v_mfma_f32_32x32x4bf16_1k v[40:71], v[140:141], v[164:165], v[40:71] cbsz:1 abid:1
    ds_read_b64 v[140:141], v154 offset:32768
    v_exp_f32 v24, v24
    v_exp_f32 v25, v25
    v_exp_f32 v26, v26
    v_exp_f32 v27, v27
    v_exp_f32 v28, v28
    v_exp_f32 v29, v29
    v_exp_f32 v30, v30
    v_exp_f32 v31, v31
    s_waitcnt lgkmcnt(2)
    v_smfmac_f32_32x32x32_bf16 v[104:119], v[148:151], v[16:23], v152
    v_exp_f32 v32, v32
    v_exp_f32 v33, v33
    v_exp_f32 v34, v34
    v_exp_f32 v35, v35
    v_smfmac_f32_32x32x32_bf16 v[120:135], v[144:147], v[24:31], v152
    s_mov_b64 exec, s[60:61]
    ds_read_b128 v[144:147], v155 offset:24320
    s_mov_b64 exec, -1
    v_exp_f32 v36, v36
    v_exp_f32 v37, v37
    v_exp_f32 v38, v38
    v_exp_f32 v39, v39
    s_waitcnt lgkmcnt(1)
    v_mfma_f32_32x32x16_bf16 v[8:23], v[136:139], v[156:159], 0
    v_exp_f32 v40, v40
    v_exp_f32 v41, v41
    v_exp_f32 v42, v42
    v_exp_f32 v43, v43
    v_smfmac_f32_32x32x32_bf16 v[120:135], v[148:151], v[32:39], v152
    s_mov_b64 exec, s[60:61]
    ds_read_b128 v[148:151], v155 offset:24960
    s_mov_b64 exec, -1
    v_exp_f32 v44, v44
    v_exp_f32 v45, v45
    v_exp_f32 v46, v46
    v_exp_f32 v47, v47
    v_mfma_f32_32x32x16_bf16 v[24:39], v[136:139], v[160:163], 0
    ds_read_b128 v[136:139], v153 offset:31744
    v_exp_f32 v48, v48
    v_exp_f32 v49, v49
    v_exp_f32 v50, v50
    v_exp_f32 v51, v51
    s_waitcnt lgkmcnt(2)
    v_smfmac_f32_32x32x32_bf16 v[104:119], v[144:147], v[40:47], v152
    v_exp_f32 v52, v52
    v_exp_f32 v53, v53
    v_exp_f32 v54, v54
    v_exp_f32 v55, v55
    v_mfma_f32_32x32x4bf16_1k v[8:39], v[140:141], v[164:165], v[8:39] cbsz:1 abid:0
    v_exp_f32 v56, v56
    v_exp_f32 v57, v57
    v_exp_f32 v58, v58
    v_exp_f32 v59, v59
    v_exp_f32 v60, v60
    v_exp_f32 v61, v61
    v_exp_f32 v62, v62
    v_exp_f32 v63, v63
    s_waitcnt lgkmcnt(1)
    v_smfmac_f32_32x32x32_bf16 v[104:119], v[148:151], v[48:55], v152
    v_exp_f32 v64, v64
    v_exp_f32 v65, v65
    v_exp_f32 v66, v66
    v_exp_f32 v67, v67
    v_smfmac_f32_32x32x32_bf16 v[120:135], v[144:147], v[56:63], v152
    s_mov_b64 exec, s[60:61]
    ds_read_b128 v[144:147], v155 offset:33280
    s_mov_b64 exec, -1
    v_exp_f32 v68, v68
    v_exp_f32 v69, v69
    v_exp_f32 v70, v70
    v_exp_f32 v71, v71
    s_lshl_b32 s62, s53, 10
    s_lshl_b32 s63, s54, 5
    s_add_u32 s62, s62, s63
    s_lshl_b32 s63, s52, 2
    s_add_u32 s62, s62, s63
    s_add_u32 s62, s62, 16384
    v_mov_b32 v2, s57
    v_mov_b32 v3, 0
    s_waitcnt vmcnt(0)
    s_mov_b64 exec, 1
    buffer_store_dword v2, v3, s[44:47], s62 offen sc1
    s_mov_b64 exec, -1
    s_barrier
    s_setprio 0
    s_waitcnt lgkmcnt(1)
    v_mfma_f32_32x32x16_bf16 v[40:55], v[136:139], v[156:159], 0
    v_exp_f32 v8, v8
    v_exp_f32 v9, v9
    v_exp_f32 v10, v10
    v_exp_f32 v11, v11
    v_smfmac_f32_32x32x32_bf16 v[120:135], v[148:151], v[64:71], v152
    s_mov_b64 exec, s[60:61]
    ds_read_b128 v[148:151], v155 offset:33920
    s_mov_b64 exec, -1
    v_exp_f32 v12, v12
    v_exp_f32 v13, v13
    v_exp_f32 v14, v14
    v_exp_f32 v15, v15
    v_mfma_f32_32x32x16_bf16 v[56:71], v[136:139], v[160:163], 0
    ds_read_b128 v[136:139], v153 offset:40960
    v_exp_f32 v16, v16
    v_exp_f32 v17, v17
    v_exp_f32 v18, v18
    v_exp_f32 v19, v19
    s_waitcnt lgkmcnt(2)
    v_smfmac_f32_32x32x32_bf16 v[104:119], v[144:147], v[8:15], v152
    v_exp_f32 v20, v20
    v_exp_f32 v21, v21
    v_exp_f32 v22, v22
    v_exp_f32 v23, v23
    v_mfma_f32_32x32x4bf16_1k v[40:71], v[140:141], v[164:165], v[40:71] cbsz:1 abid:1
    ds_read_b64 v[140:141], v154 offset:43008
    v_exp_f32 v24, v24
    v_exp_f32 v25, v25
    v_exp_f32 v26, v26
    v_exp_f32 v27, v27
    v_exp_f32 v28, v28
    v_exp_f32 v29, v29
    v_exp_f32 v30, v30
    v_exp_f32 v31, v31
    s_waitcnt lgkmcnt(2)
    v_smfmac_f32_32x32x32_bf16 v[104:119], v[148:151], v[16:23], v152
    v_exp_f32 v32, v32
    v_exp_f32 v33, v33
    v_exp_f32 v34, v34
    v_exp_f32 v35, v35
    v_smfmac_f32_32x32x32_bf16 v[120:135], v[144:147], v[24:31], v152
    s_mov_b64 exec, s[60:61]
    ds_read_b128 v[144:147], v155 offset:34560
    s_mov_b64 exec, -1
    v_exp_f32 v36, v36
    v_exp_f32 v37, v37
    v_exp_f32 v38, v38
    v_exp_f32 v39, v39
    s_waitcnt lgkmcnt(1)
    v_mfma_f32_32x32x16_bf16 v[8:23], v[136:139], v[156:159], 0
    v_exp_f32 v40, v40
    v_exp_f32 v41, v41
    v_exp_f32 v42, v42
    v_exp_f32 v43, v43
    v_smfmac_f32_32x32x32_bf16 v[120:135], v[148:151], v[32:39], v152
    s_mov_b64 exec, s[60:61]
    ds_read_b128 v[148:151], v155 offset:35200
    s_mov_b64 exec, -1
    v_exp_f32 v44, v44
    v_exp_f32 v45, v45
    v_exp_f32 v46, v46
    v_exp_f32 v47, v47
    v_mfma_f32_32x32x16_bf16 v[24:39], v[136:139], v[160:163], 0
    ds_read_b128 v[136:139], v153 offset:41984
    v_exp_f32 v48, v48
    v_exp_f32 v49, v49
    v_exp_f32 v50, v50
    v_exp_f32 v51, v51
    s_waitcnt lgkmcnt(2)
    v_smfmac_f32_32x32x32_bf16 v[104:119], v[144:147], v[40:47], v152
    v_exp_f32 v52, v52
    v_exp_f32 v53, v53
    v_exp_f32 v54, v54
    v_exp_f32 v55, v55
    v_mfma_f32_32x32x4bf16_1k v[8:39], v[140:141], v[164:165], v[8:39] cbsz:1 abid:0
    v_exp_f32 v56, v56
    v_exp_f32 v57, v57
    v_exp_f32 v58, v58
    v_exp_f32 v59, v59
    v_exp_f32 v60, v60
    v_exp_f32 v61, v61
    v_exp_f32 v62, v62
    v_exp_f32 v63, v63
    s_waitcnt lgkmcnt(1)
    v_smfmac_f32_32x32x32_bf16 v[104:119], v[148:151], v[48:55], v152
    v_exp_f32 v64, v64
    v_exp_f32 v65, v65
    v_exp_f32 v66, v66
    v_exp_f32 v67, v67
    v_smfmac_f32_32x32x32_bf16 v[120:135], v[144:147], v[56:63], v152
    s_mov_b64 exec, s[60:61]
    ds_read_b128 v[144:147], v155 offset:43520
    s_mov_b64 exec, -1
    v_exp_f32 v68, v68
    v_exp_f32 v69, v69
    v_exp_f32 v70, v70
    v_exp_f32 v71, v71
    v_add_u32 v153, 40960, v153
    v_add_u32 v154, 40960, v154
    v_add_u32 v155, 40960, v155
    s_lshl_b32 s90, s52, 10
    s_add_u32 s90, s90, 81920
    s_add_u32 s91, s90, 65536
    s_setprio 3
    s_waitcnt lgkmcnt(1)
    v_mfma_f32_32x32x16_bf16 v[40:55], v[136:139], v[156:159], 0
    v_exp_f32 v8, v8
    v_exp_f32 v9, v9
    v_exp_f32 v10, v10
    v_exp_f32 v11, v11
    v_smfmac_f32_32x32x32_bf16 v[120:135], v[148:151], v[64:71], v152
    s_mov_b64 exec, s[60:61]
    ds_read_b128 v[148:151], v155 offset:3200
    s_mov_b64 exec, -1
    v_exp_f32 v12, v12
    v_exp_f32 v13, v13
    v_exp_f32 v14, v14
    v_exp_f32 v15, v15
    v_mfma_f32_32x32x16_bf16 v[56:71], v[136:139], v[160:163], 0
    ds_read_b128 v[136:139], v153 offset:10240
    v_exp_f32 v16, v16
    v_exp_f32 v17, v17
    v_exp_f32 v18, v18
    v_exp_f32 v19, v19
    s_waitcnt lgkmcnt(2)
    v_smfmac_f32_32x32x32_bf16 v[104:119], v[144:147], v[8:15], v152
    s_mov_b32 m0, s90
    s_add_u32 s90, s90, 8192
    buffer_load_dwordx4 v1, s[44:47], s91 offen sc1 lds
    s_add_u32 s91, s91, 8192
    v_exp_f32 v20, v20
    v_exp_f32 v21, v21
    v_exp_f32 v22, v22
    v_exp_f32 v23, v23
    v_mfma_f32_32x32x4bf16_1k v[40:71], v[140:141], v[164:165], v[40:71] cbsz:1 abid:1
    ds_read_b64 v[140:141], v154 offset:12288
    v_exp_f32 v24, v24
    v_exp_f32 v25, v25
    v_exp_f32 v26, v26
    v_exp_f32 v27, v27
    s_mov_b32 m0, s90
    s_add_u32 s90, s90, 8192
    buffer_load_dwordx4 v1, s[44:47], s91 offen sc1 lds
    s_add_u32 s91, s91, 8192
    v_exp_f32 v28, v28
    v_exp_f32 v29, v29
    v_exp_f32 v30, v30
    v_exp_f32 v31, v31
    s_waitcnt lgkmcnt(2)
    v_smfmac_f32_32x32x32_bf16 v[104:119], v[148:151], v[16:23], v152
    v_exp_f32 v32, v32
    v_exp_f32 v33, v33
    v_exp_f32 v34, v34
    v_exp_f32 v35, v35
    v_smfmac_f32_32x32x32_bf16 v[120:135], v[144:147], v[24:31], v152
    s_mov_b64 exec, s[60:61]
    ds_read_b128 v[144:147], v155 offset:3840
    s_mov_b64 exec, -1
    s_mov_b32 m0, s90
    s_add_u32 s90, s90, 8192
    buffer_load_dwordx4 v1, s[44:47], s91 offen sc1 lds
    s_add_u32 s91, s91, 8192
    v_exp_f32 v36, v36
    v_exp_f32 v37, v37
    v_exp_f32 v38, v38
    v_exp_f32 v39, v39
    s_waitcnt lgkmcnt(1)
    v_mfma_f32_32x32x16_bf16 v[8:23], v[136:139], v[156:159], 0
    v_exp_f32 v40, v40
    v_exp_f32 v41, v41
    v_exp_f32 v42, v42
    v_exp_f32 v43, v43
    v_smfmac_f32_32x32x32_bf16 v[120:135], v[148:151], v[32:39], v152
    s_mov_b64 exec, s[60:61]
    ds_read_b128 v[148:151], v155 offset:4480
    s_mov_b64 exec, -1
    v_exp_f32 v44, v44
    v_exp_f32 v45, v45
    v_exp_f32 v46, v46
    v_exp_f32 v47, v47
    v_mfma_f32_32x32x16_bf16 v[24:39], v[136:139], v[160:163], 0
    ds_read_b128 v[136:139], v153 offset:11264
    v_exp_f32 v48, v48
    v_exp_f32 v49, v49
    v_exp_f32 v50, v50
    v_exp_f32 v51, v51
    s_waitcnt lgkmcnt(2)
    v_smfmac_f32_32x32x32_bf16 v[104:119], v[144:147], v[40:47], v152
    s_mov_b32 m0, s90
    s_add_u32 s90, s90, 8192
    buffer_load_dwordx4 v1, s[44:47], s91 offen sc1 lds
    s_add_u32 s91, s91, 8192
    v_exp_f32 v52, v52
    v_exp_f32 v53, v53
    v_exp_f32 v54, v54
    v_exp_f32 v55, v55
    v_mfma_f32_32x32x4bf16_1k v[8:39], v[140:141], v[164:165], v[8:39] cbsz:1 abid:0
    v_exp_f32 v56, v56
    v_exp_f32 v57, v57
    v_exp_f32 v58, v58
    v_exp_f32 v59, v59
    s_mov_b32 m0, s90
    s_add_u32 s90, s90, 8192
    buffer_load_dwordx4 v1, s[44:47], s91 offen sc1 lds
    s_add_u32 s91, s91, 8192
    v_exp_f32 v60, v60
    v_exp_f32 v61, v61
    v_exp_f32 v62, v62
    v_exp_f32 v63, v63
    s_waitcnt lgkmcnt(1)
    v_smfmac_f32_32x32x32_bf16 v[104:119], v[148:151], v[48:55], v152
    v_exp_f32 v64, v64
    v_exp_f32 v65, v65
    v_exp_f32 v66, v66
    v_exp_f32 v67, v67
    v_smfmac_f32_32x32x32_bf16 v[120:135], v[144:147], v[56:63], v152
    s_mov_b64 exec, s[60:61]
    ds_read_b128 v[144:147], v155 offset:12800
    s_mov_b64 exec, -1
    s_mov_b32 m0, s90
    s_add_u32 s90, s90, 8192
    buffer_load_dwordx4 v1, s[44:47], s91 offen sc1 lds
    s_add_u32 s91, s91, 8192
    v_exp_f32 v68, v68
    v_exp_f32 v69, v69
    v_exp_f32 v70, v70
    v_exp_f32 v71, v71
    s_setprio 2
    s_waitcnt lgkmcnt(1)
    v_mfma_f32_32x32x16_bf16 v[40:55], v[136:139], v[156:159], 0
    v_exp_f32 v8, v8
    v_exp_f32 v9, v9
    v_exp_f32 v10, v10
    v_exp_f32 v11, v11
    v_smfmac_f32_32x32x32_bf16 v[120:135], v[148:151], v[64:71], v152
    s_mov_b64 exec, s[60:61]
    ds_read_b128 v[148:151], v155 offset:13440
    s_mov_b64 exec, -1
    v_exp_f32 v12, v12
    v_exp_f32 v13, v13
    v_exp_f32 v14, v14
    v_exp_f32 v15, v15
    v_mfma_f32_32x32x16_bf16 v[56:71], v[136:139], v[160:163], 0
    ds_read_b128 v[136:139], v153 offset:20480
    v_exp_f32 v16, v16
    v_exp_f32 v17, v17
    v_exp_f32 v18, v18
    v_exp_f32 v19, v19
    s_waitcnt lgkmcnt(2)
    v_smfmac_f32_32x32x32_bf16 v[104:119], v[144:147], v[8:15], v152
    s_mov_b32 m0, s90
    s_add_u32 s90, s90, 8192
    buffer_load_dwordx4 v1, s[44:47], s91 offen sc1 lds
    s_add_u32 s91, s91, 8192
    v_exp_f32 v20, v20
    v_exp_f32 v21, v21
    v_exp_f32 v22, v22
    v_exp_f32 v23, v23
    v_mfma_f32_32x32x4bf16_1k v[40:71], v[140:141], v[164:165], v[40:71] cbsz:1 abid:1
    ds_read_b64 v[140:141], v154 offset:22528
    v_exp_f32 v24, v24
    v_exp_f32 v25, v25
    v_exp_f32 v26, v26
    v_exp_f32 v27, v27
    s_mov_b32 m0, s90
    s_add_u32 s90, s90, 8192
    buffer_load_dwordx4 v1, s[44:47], s91 offen sc1 lds
    s_add_u32 s91, s91, 8192
    v_exp_f32 v28, v28
    v_exp_f32 v29, v29
    v_exp_f32 v30, v30
    v_exp_f32 v31, v31
    s_waitcnt lgkmcnt(2)
    v_smfmac_f32_32x32x32_bf16 v[104:119], v[148:151], v[16:23], v152
    v_exp_f32 v32, v32
    v_exp_f32 v33, v33
    v_exp_f32 v34, v34
    v_exp_f32 v35, v35
    v_smfmac_f32_32x32x32_bf16 v[120:135], v[144:147], v[24:31], v152
    s_mov_b64 exec, s[60:61]
    ds_read_b128 v[144:147], v155 offset:14080
    s_mov_b64 exec, -1
    s_mov_b32 m0, s90
    s_add_u32 s90, s90, 8192
    buffer_load_dwordx4 v1, s[44:47], s91 offen sc1 lds
    s_add_u32 s91, s91, 8192
    v_exp_f32 v36, v36
    v_exp_f32 v37, v37
    v_exp_f32 v38, v38
    v_exp_f32 v39, v39
    s_waitcnt lgkmcnt(1)
    v_mfma_f32_32x32x16_bf16 v[8:23], v[136:139], v[156:159], 0
    v_exp_f32 v40, v40
    v_exp_f32 v41, v41
    v_exp_f32 v42, v42
    v_exp_f32 v43, v43
    v_smfmac_f32_32x32x32_bf16 v[120:135], v[148:151], v[32:39], v152
    s_mov_b64 exec, s[60:61]
    ds_read_b128 v[148:151], v155 offset:14720
    s_mov_b64 exec, -1
    v_exp_f32 v44, v44
    v_exp_f32 v45, v45
    v_exp_f32 v46, v46
    v_exp_f32 v47, v47
    v_mfma_f32_32x32x16_bf16 v[24:39], v[136:139], v[160:163], 0
    ds_read_b128 v[136:139], v153 offset:21504
    v_exp_f32 v48, v48
    v_exp_f32 v49, v49
    v_exp_f32 v50, v50
    v_exp_f32 v51, v51
    s_waitcnt lgkmcnt(2)
    v_smfmac_f32_32x32x32_bf16 v[104:119], v[144:147], v[40:47], v152
    s_mov_b32 m0, s90
    s_add_u32 s90, s90, 8192
    buffer_load_dwordx4 v1, s[44:47], s91 offen sc1 lds
    s_add_u32 s91, s91, 8192
    v_exp_f32 v52, v52
    v_exp_f32 v53, v53
    v_exp_f32 v54, v54
    v_exp_f32 v55, v55
    v_mfma_f32_32x32x4bf16_1k v[8:39], v[140:141], v[164:165], v[8:39] cbsz:1 abid:0
    v_exp_f32 v56, v56
    v_exp_f32 v57, v57
    v_exp_f32 v58, v58
    v_exp_f32 v59, v59
    v_exp_f32 v60, v60
    v_exp_f32 v61, v61
    v_exp_f32 v62, v62
    v_exp_f32 v63, v63
    s_waitcnt lgkmcnt(1)
    v_smfmac_f32_32x32x32_bf16 v[104:119], v[148:151], v[48:55], v152
    v_exp_f32 v64, v64
    v_exp_f32 v65, v65
    v_exp_f32 v66, v66
    v_exp_f32 v67, v67
    v_smfmac_f32_32x32x32_bf16 v[120:135], v[144:147], v[56:63], v152
    s_mov_b64 exec, s[60:61]
    ds_read_b128 v[144:147], v155 offset:23040
    s_mov_b64 exec, -1
    v_exp_f32 v68, v68
    v_exp_f32 v69, v69
    v_exp_f32 v70, v70
    v_exp_f32 v71, v71
    s_setprio 1
    s_waitcnt lgkmcnt(1)
    v_mfma_f32_32x32x16_bf16 v[40:55], v[136:139], v[156:159], 0
    v_exp_f32 v8, v8
    v_exp_f32 v9, v9
    v_exp_f32 v10, v10
    v_exp_f32 v11, v11
    v_smfmac_f32_32x32x32_bf16 v[120:135], v[148:151], v[64:71], v152
    s_mov_b64 exec, s[60:61]
    ds_read_b128 v[148:151], v155 offset:23680
    s_mov_b64 exec, -1
    v_exp_f32 v12, v12
    v_exp_f32 v13, v13
    v_exp_f32 v14, v14
    v_exp_f32 v15, v15
    v_mfma_f32_32x32x16_bf16 v[56:71], v[136:139], v[160:163], 0
    ds_read_b128 v[136:139], v153 offset:30720
    v_exp_f32 v16, v16
    v_exp_f32 v17, v17
    v_exp_f32 v18, v18
    v_exp_f32 v19, v19
    s_waitcnt lgkmcnt(2)
    v_smfmac_f32_32x32x32_bf16 v[104:119], v[144:147], v[8:15], v152
    v_exp_f32 v20, v20
    v_exp_f32 v21, v21
    v_exp_f32 v22, v22
    v_exp_f32 v23, v23
    v_mfma_f32_32x32x4bf16_1k v[40:71], v[140:141], v[164:165], v[40:71] cbsz:1 abid:1
    ds_read_b64 v[140:141], v154 offset:32768
    v_exp_f32 v24, v24
    v_exp_f32 v25, v25
    v_exp_f32 v26, v26
    v_exp_f32 v27, v27
    v_exp_f32 v28, v28
    v_exp_f32 v29, v29
    v_exp_f32 v30, v30
    v_exp_f32 v31, v31
    s_waitcnt lgkmcnt(2)
    v_smfmac_f32_32x32x32_bf16 v[104:119], v[148:151], v[16:23], v152
    v_exp_f32 v32, v32
    v_exp_f32 v33, v33
    v_exp_f32 v34, v34
    v_exp_f32 v35, v35
    v_smfmac_f32_32x32x32_bf16 v[120:135], v[144:147], v[24:31], v152
    s_mov_b64 exec, s[60:61]
    ds_read_b128 v[144:147], v155 offset:24320
    s_mov_b64 exec, -1
    v_exp_f32 v36, v36
    v_exp_f32 v37, v37
    v_exp_f32 v38, v38
    v_exp_f32 v39, v39
    s_waitcnt lgkmcnt(1)
    v_mfma_f32_32x32x16_bf16 v[8:23], v[136:139], v[156:159], 0
    v_exp_f32 v40, v40
    v_exp_f32 v41, v41
    v_exp_f32 v42, v42
    v_exp_f32 v43, v43
    v_smfmac_f32_32x32x32_bf16 v[120:135], v[148:151], v[32:39], v152
    s_mov_b64 exec, s[60:61]
    ds_read_b128 v[148:151], v155 offset:24960
    s_mov_b64 exec, -1
    v_exp_f32 v44, v44
    v_exp_f32 v45, v45
    v_exp_f32 v46, v46
    v_exp_f32 v47, v47
    v_mfma_f32_32x32x16_bf16 v[24:39], v[136:139], v[160:163], 0
    ds_read_b128 v[136:139], v153 offset:31744
    v_exp_f32 v48, v48
    v_exp_f32 v49, v49
    v_exp_f32 v50, v50
    v_exp_f32 v51, v51
    s_waitcnt lgkmcnt(2)
    v_smfmac_f32_32x32x32_bf16 v[104:119], v[144:147], v[40:47], v152
    v_exp_f32 v52, v52
    v_exp_f32 v53, v53
    v_exp_f32 v54, v54
    v_exp_f32 v55, v55
    v_mfma_f32_32x32x4bf16_1k v[8:39], v[140:141], v[164:165], v[8:39] cbsz:1 abid:0
    v_exp_f32 v56, v56
    v_exp_f32 v57, v57
    v_exp_f32 v58, v58
    v_exp_f32 v59, v59
    v_exp_f32 v60, v60
    v_exp_f32 v61, v61
    v_exp_f32 v62, v62
    v_exp_f32 v63, v63
    s_waitcnt lgkmcnt(1)
    v_smfmac_f32_32x32x32_bf16 v[104:119], v[148:151], v[48:55], v152
    v_exp_f32 v64, v64
    v_exp_f32 v65, v65
    v_exp_f32 v66, v66
    v_exp_f32 v67, v67
    v_smfmac_f32_32x32x32_bf16 v[120:135], v[144:147], v[56:63], v152
    s_mov_b64 exec, s[60:61]
    ds_read_b128 v[144:147], v155 offset:33280
    s_mov_b64 exec, -1
    v_exp_f32 v68, v68
    v_exp_f32 v69, v69
    v_exp_f32 v70, v70
    v_exp_f32 v71, v71
    s_waitcnt vmcnt(0)
    s_barrier
    s_setprio 0
    s_waitcnt lgkmcnt(1)
    v_mfma_f32_32x32x16_bf16 v[40:55], v[136:139], v[156:159], 0
    v_exp_f32 v8, v8
    v_exp_f32 v9, v9
    v_exp_f32 v10, v10
    v_exp_f32 v11, v11
    v_smfmac_f32_32x32x32_bf16 v[120:135], v[148:151], v[64:71], v152
    s_mov_b64 exec, s[60:61]
    ds_read_b128 v[148:151], v155 offset:33920
    s_mov_b64 exec, -1
    v_exp_f32 v12, v12
    v_exp_f32 v13, v13
    v_exp_f32 v14, v14
    v_exp_f32 v15, v15
    v_mfma_f32_32x32x16_bf16 v[56:71], v[136:139], v[160:163], 0
    ds_read_b128 v[136:139], v153 offset:40960
    v_exp_f32 v16, v16
    v_exp_f32 v17, v17
    v_exp_f32 v18, v18
    v_exp_f32 v19, v19
    s_waitcnt lgkmcnt(2)
    v_smfmac_f32_32x32x32_bf16 v[104:119], v[144:147], v[8:15], v152
    v_exp_f32 v20, v20
    v_exp_f32 v21, v21
    v_exp_f32 v22, v22
    v_exp_f32 v23, v23
    v_mfma_f32_32x32x4bf16_1k v[40:71], v[140:141], v[164:165], v[40:71] cbsz:1 abid:1
    ds_read_b64 v[140:141], v154 offset:43008
    v_exp_f32 v24, v24
    v_exp_f32 v25, v25
    v_exp_f32 v26, v26
    v_exp_f32 v27, v27
    v_exp_f32 v28, v28
    v_exp_f32 v29, v29
    v_exp_f32 v30, v30
    v_exp_f32 v31, v31
    s_waitcnt lgkmcnt(2)
    v_smfmac_f32_32x32x32_bf16 v[104:119], v[148:151], v[16:23], v152
    v_exp_f32 v32, v32
    v_exp_f32 v33, v33
    v_exp_f32 v34, v34
    v_exp_f32 v35, v35
    v_smfmac_f32_32x32x32_bf16 v[120:135], v[144:147], v[24:31], v152
    s_mov_b64 exec, s[60:61]
    ds_read_b128 v[144:147], v155 offset:34560
    s_mov_b64 exec, -1
    v_exp_f32 v36, v36
    v_exp_f32 v37, v37
    v_exp_f32 v38, v38
    v_exp_f32 v39, v39
    s_waitcnt lgkmcnt(1)
    v_mfma_f32_32x32x16_bf16 v[8:23], v[136:139], v[156:159], 0
    v_exp_f32 v40, v40
    v_exp_f32 v41, v41
    v_exp_f32 v42, v42
    v_exp_f32 v43, v43
    v_smfmac_f32_32x32x32_bf16 v[120:135], v[148:151], v[32:39], v152
    s_mov_b64 exec, s[60:61]
    ds_read_b128 v[148:151], v155 offset:35200
    s_mov_b64 exec, -1
    v_exp_f32 v44, v44
    v_exp_f32 v45, v45
    v_exp_f32 v46, v46
    v_exp_f32 v47, v47
    v_mfma_f32_32x32x16_bf16 v[24:39], v[136:139], v[160:163], 0
    ds_read_b128 v[136:139], v153 offset:41984
    v_exp_f32 v48, v48
    v_exp_f32 v49, v49
    v_exp_f32 v50, v50
    v_exp_f32 v51, v51
    s_waitcnt lgkmcnt(2)
    v_smfmac_f32_32x32x32_bf16 v[104:119], v[144:147], v[40:47], v152
    v_exp_f32 v52, v52
    v_exp_f32 v53, v53
    v_exp_f32 v54, v54
    v_exp_f32 v55, v55
    v_mfma_f32_32x32x4bf16_1k v[8:39], v[140:141], v[164:165], v[8:39] cbsz:1 abid:0
    v_exp_f32 v56, v56
    v_exp_f32 v57, v57
    v_exp_f32 v58, v58
    v_exp_f32 v59, v59
    v_exp_f32 v60, v60
    v_exp_f32 v61, v61
    v_exp_f32 v62, v62
    v_exp_f32 v63, v63
    s_waitcnt lgkmcnt(1)
    v_smfmac_f32_32x32x32_bf16 v[104:119], v[148:151], v[48:55], v152
    v_exp_f32 v64, v64
    v_exp_f32 v65, v65
    v_exp_f32 v66, v66
    v_exp_f32 v67, v67
    v_smfmac_f32_32x32x32_bf16 v[120:135], v[144:147], v[56:63], v152
    s_mov_b64 exec, s[60:61]
    ds_read_b128 v[144:147], v155 offset:43520
    s_mov_b64 exec, -1
    v_exp_f32 v68, v68
    v_exp_f32 v69, v69
    v_exp_f32 v70, v70
    v_exp_f32 v71, v71
    v_add_u32 v153, 40960, v153
    v_add_u32 v154, 40960, v154
    v_add_u32 v155, 40960, v155
    s_setprio 3
    s_waitcnt lgkmcnt(1)
    v_mfma_f32_32x32x16_bf16 v[40:55], v[136:139], v[156:159], 0
    v_exp_f32 v8, v8
    v_exp_f32 v9, v9
    v_exp_f32 v10, v10
    v_exp_f32 v11, v11
    v_smfmac_f32_32x32x32_bf16 v[120:135], v[148:151], v[64:71], v152
    s_mov_b64 exec, s[60:61]
    ds_read_b128 v[148:151], v155 offset:3200
    s_mov_b64 exec, -1
    v_exp_f32 v12, v12
    v_exp_f32 v13, v13
    v_exp_f32 v14, v14
    v_exp_f32 v15, v15
    v_mfma_f32_32x32x16_bf16 v[56:71], v[136:139], v[160:163], 0
    ds_read_b128 v[136:139], v153 offset:10240
    v_exp_f32 v16, v16
    v_exp_f32 v17, v17
    v_exp_f32 v18, v18
    v_exp_f32 v19, v19
    s_waitcnt lgkmcnt(2)
    v_smfmac_f32_32x32x32_bf16 v[104:119], v[144:147], v[8:15], v152
    v_exp_f32 v20, v20
    v_exp_f32 v21, v21
    v_exp_f32 v22, v22
    v_exp_f32 v23, v23
    v_mfma_f32_32x32x4bf16_1k v[40:71], v[140:141], v[164:165], v[40:71] cbsz:1 abid:1
    ds_read_b64 v[140:141], v154 offset:12288
    v_exp_f32 v24, v24
    v_exp_f32 v25, v25
    v_exp_f32 v26, v26
    v_exp_f32 v27, v27
    v_exp_f32 v28, v28
    v_exp_f32 v29, v29
    v_exp_f32 v30, v30
    v_exp_f32 v31, v31
    s_waitcnt lgkmcnt(2)
    v_smfmac_f32_32x32x32_bf16 v[104:119], v[148:151], v[16:23], v152
    v_exp_f32 v32, v32
    v_exp_f32 v33, v33
    v_exp_f32 v34, v34
    v_exp_f32 v35, v35
    v_smfmac_f32_32x32x32_bf16 v[120:135], v[144:147], v[24:31], v152
    s_mov_b64 exec, s[60:61]
    ds_read_b128 v[144:147], v155 offset:3840
    s_mov_b64 exec, -1
    v_exp_f32 v36, v36
    v_exp_f32 v37, v37
    v_exp_f32 v38, v38
    v_exp_f32 v39, v39
    s_waitcnt lgkmcnt(1)
    v_mfma_f32_32x32x16_bf16 v[8:23], v[136:139], v[156:159], 0
    v_exp_f32 v40, v40
    v_exp_f32 v41, v41
    v_exp_f32 v42, v42
    v_exp_f32 v43, v43
    v_smfmac_f32_32x32x32_bf16 v[120:135], v[148:151], v[32:39], v152
    s_mov_b64 exec, s[60:61]
    ds_read_b128 v[148:151], v155 offset:4480
    s_mov_b64 exec, -1
    v_exp_f32 v44, v44
    v_exp_f32 v45, v45
    v_exp_f32 v46, v46
    v_exp_f32 v47, v47
    v_mfma_f32_32x32x16_bf16 v[24:39], v[136:139], v[160:163], 0
    ds_read_b128 v[136:139], v153 offset:11264
    v_exp_f32 v48, v48
    v_exp_f32 v49, v49
    v_exp_f32 v50, v50
    v_exp_f32 v51, v51
    s_waitcnt lgkmcnt(2)
    v_smfmac_f32_32x32x32_bf16 v[104:119], v[144:147], v[40:47], v152
    v_exp_f32 v52, v52
    v_exp_f32 v53, v53
    v_exp_f32 v54, v54
    v_exp_f32 v55, v55
    v_mfma_f32_32x32x4bf16_1k v[8:39], v[140:141], v[164:165], v[8:39] cbsz:1 abid:0
    v_exp_f32 v56, v56
    v_exp_f32 v57, v57
    v_exp_f32 v58, v58
    v_exp_f32 v59, v59
    v_exp_f32 v60, v60
    v_exp_f32 v61, v61
    v_exp_f32 v62, v62
    v_exp_f32 v63, v63
    s_waitcnt lgkmcnt(1)
    v_smfmac_f32_32x32x32_bf16 v[104:119], v[148:151], v[48:55], v152
    v_exp_f32 v64, v64
    v_exp_f32 v65, v65
    v_exp_f32 v66, v66
    v_exp_f32 v67, v67
    v_smfmac_f32_32x32x32_bf16 v[120:135], v[144:147], v[56:63], v152
    s_mov_b64 exec, s[60:61]
    ds_read_b128 v[144:147], v155 offset:12800
    s_mov_b64 exec, -1
    v_exp_f32 v68, v68
    v_exp_f32 v69, v69
    v_exp_f32 v70, v70
    v_exp_f32 v71, v71
    s_setprio 2
    s_waitcnt lgkmcnt(1)
    v_mfma_f32_32x32x16_bf16 v[40:55], v[136:139], v[156:159], 0
    v_exp_f32 v8, v8
    v_exp_f32 v9, v9
    v_exp_f32 v10, v10
    v_exp_f32 v11, v11
    v_smfmac_f32_32x32x32_bf16 v[120:135], v[148:151], v[64:71], v152
    s_mov_b64 exec, s[60:61]
    ds_read_b128 v[148:151], v155 offset:13440
    s_mov_b64 exec, -1
    v_exp_f32 v12, v12
    v_exp_f32 v13, v13
    v_exp_f32 v14, v14
    v_exp_f32 v15, v15
    v_mfma_f32_32x32x16_bf16 v[56:71], v[136:139], v[160:163], 0
    ds_read_b128 v[136:139], v153 offset:20480
    v_exp_f32 v16, v16
    v_exp_f32 v17, v17
    v_exp_f32 v18, v18
    v_exp_f32 v19, v19
    s_waitcnt lgkmcnt(2)
    v_smfmac_f32_32x32x32_bf16 v[104:119], v[144:147], v[8:15], v152
    v_exp_f32 v20, v20
    v_exp_f32 v21, v21
    v_exp_f32 v22, v22
    v_exp_f32 v23, v23
    v_mfma_f32_32x32x4bf16_1k v[40:71], v[140:141], v[164:165], v[40:71] cbsz:1 abid:1
    ds_read_b64 v[140:141], v154 offset:22528
    v_exp_f32 v24, v24
    v_exp_f32 v25, v25
    v_exp_f32 v26, v26
    v_exp_f32 v27, v27
    v_exp_f32 v28, v28
    v_exp_f32 v29, v29
    v_exp_f32 v30, v30
    v_exp_f32 v31, v31
    s_waitcnt lgkmcnt(2)
    v_smfmac_f32_32x32x32_bf16 v[104:119], v[148:151], v[16:23], v152
    v_exp_f32 v32, v32
    v_exp_f32 v33, v33
    v_exp_f32 v34, v34
    v_exp_f32 v35, v35
    v_smfmac_f32_32x32x32_bf16 v[120:135], v[144:147], v[24:31], v152
    s_mov_b64 exec, s[60:61]
    ds_read_b128 v[144:147], v155 offset:14080
    s_mov_b64 exec, -1
    v_exp_f32 v36, v36
    v_exp_f32 v37, v37
    v_exp_f32 v38, v38
    v_exp_f32 v39, v39
    s_waitcnt lgkmcnt(1)
    v_mfma_f32_32x32x16_bf16 v[8:23], v[136:139], v[156:159], 0
    v_exp_f32 v40, v40
    v_exp_f32 v41, v41
    v_exp_f32 v42, v42
    v_exp_f32 v43, v43
    v_smfmac_f32_32x32x32_bf16 v[120:135], v[148:151], v[32:39], v152
    s_mov_b64 exec, s[60:61]
    ds_read_b128 v[148:151], v155 offset:14720
    s_mov_b64 exec, -1
    v_exp_f32 v44, v44
    v_exp_f32 v45, v45
    v_exp_f32 v46, v46
    v_exp_f32 v47, v47
    v_mfma_f32_32x32x16_bf16 v[24:39], v[136:139], v[160:163], 0
    ds_read_b128 v[136:139], v153 offset:21504
    v_exp_f32 v48, v48
    v_exp_f32 v49, v49
    v_exp_f32 v50, v50
    v_exp_f32 v51, v51
    s_waitcnt lgkmcnt(2)
    v_smfmac_f32_32x32x32_bf16 v[104:119], v[144:147], v[40:47], v152
    v_exp_f32 v52, v52
    v_exp_f32 v53, v53
    v_exp_f32 v54, v54
    v_exp_f32 v55, v55
    v_mfma_f32_32x32x4bf16_1k v[8:39], v[140:141], v[164:165], v[8:39] cbsz:1 abid:0
    v_exp_f32 v56, v56
    v_exp_f32 v57, v57
    v_exp_f32 v58, v58
    v_exp_f32 v59, v59
    v_exp_f32 v60, v60
    v_exp_f32 v61, v61
    v_exp_f32 v62, v62
    v_exp_f32 v63, v63
    s_waitcnt lgkmcnt(1)
    v_smfmac_f32_32x32x32_bf16 v[104:119], v[148:151], v[48:55], v152
    v_exp_f32 v64, v64
    v_exp_f32 v65, v65
    v_exp_f32 v66, v66
    v_exp_f32 v67, v67
    v_smfmac_f32_32x32x32_bf16 v[120:135], v[144:147], v[56:63], v152
    s_mov_b64 exec, s[60:61]
    ds_read_b128 v[144:147], v155 offset:23040
    s_mov_b64 exec, -1
    v_exp_f32 v68, v68
    v_exp_f32 v69, v69
    v_exp_f32 v70, v70
    v_exp_f32 v71, v71
    s_setprio 1
    s_waitcnt lgkmcnt(1)
    v_mfma_f32_32x32x16_bf16 v[40:55], v[136:139], v[156:159], 0
    v_exp_f32 v8, v8
    v_exp_f32 v9, v9
    v_exp_f32 v10, v10
    v_exp_f32 v11, v11
    v_smfmac_f32_32x32x32_bf16 v[120:135], v[148:151], v[64:71], v152
    s_mov_b64 exec, s[60:61]
    ds_read_b128 v[148:151], v155 offset:23680
    s_mov_b64 exec, -1
    v_exp_f32 v12, v12
    v_exp_f32 v13, v13
    v_exp_f32 v14, v14
    v_exp_f32 v15, v15
    v_mfma_f32_32x32x16_bf16 v[56:71], v[136:139], v[160:163], 0
    ds_read_b128 v[136:139], v153 offset:30720
    v_exp_f32 v16, v16
    v_exp_f32 v17, v17
    v_exp_f32 v18, v18
    v_exp_f32 v19, v19
    s_waitcnt lgkmcnt(2)
    v_smfmac_f32_32x32x32_bf16 v[104:119], v[144:147], v[8:15], v152
    v_exp_f32 v20, v20
    v_exp_f32 v21, v21
    v_exp_f32 v22, v22
    v_exp_f32 v23, v23
    v_mfma_f32_32x32x4bf16_1k v[40:71], v[140:141], v[164:165], v[40:71] cbsz:1 abid:1
    ds_read_b64 v[140:141], v154 offset:32768
    v_exp_f32 v24, v24
    v_exp_f32 v25, v25
    v_exp_f32 v26, v26
    v_exp_f32 v27, v27
    v_exp_f32 v28, v28
    v_exp_f32 v29, v29
    v_exp_f32 v30, v30
    v_exp_f32 v31, v31
    s_waitcnt lgkmcnt(2)
    v_smfmac_f32_32x32x32_bf16 v[104:119], v[148:151], v[16:23], v152
    v_exp_f32 v32, v32
    v_exp_f32 v33, v33
    v_exp_f32 v34, v34
    v_exp_f32 v35, v35
    v_smfmac_f32_32x32x32_bf16 v[120:135], v[144:147], v[24:31], v152
    s_mov_b64 exec, s[60:61]
    ds_read_b128 v[144:147], v155 offset:24320
    s_mov_b64 exec, -1
    v_exp_f32 v36, v36
    v_exp_f32 v37, v37
    v_exp_f32 v38, v38
    v_exp_f32 v39, v39
    s_waitcnt lgkmcnt(1)
    v_mfma_f32_32x32x16_bf16 v[8:23], v[136:139], v[156:159], 0
    v_exp_f32 v40, v40
    v_exp_f32 v41, v41
    v_exp_f32 v42, v42
    v_exp_f32 v43, v43
    v_smfmac_f32_32x32x32_bf16 v[120:135], v[148:151], v[32:39], v152
    s_mov_b64 exec, s[60:61]
    ds_read_b128 v[148:151], v155 offset:24960
    s_mov_b64 exec, -1
    v_exp_f32 v44, v44
    v_exp_f32 v45, v45
    v_exp_f32 v46, v46
    v_exp_f32 v47, v47
    v_mfma_f32_32x32x16_bf16 v[24:39], v[136:139], v[160:163], 0
    ds_read_b128 v[136:139], v153 offset:31744
    v_exp_f32 v48, v48
    v_exp_f32 v49, v49
    v_exp_f32 v50, v50
    v_exp_f32 v51, v51
    s_waitcnt lgkmcnt(2)
    v_smfmac_f32_32x32x32_bf16 v[104:119], v[144:147], v[40:47], v152
    v_exp_f32 v52, v52
    v_exp_f32 v53, v53
    v_exp_f32 v54, v54
    v_exp_f32 v55, v55
    v_mfma_f32_32x32x4bf16_1k v[8:39], v[140:141], v[164:165], v[8:39] cbsz:1 abid:0
    v_exp_f32 v56, v56
    v_exp_f32 v57, v57
    v_exp_f32 v58, v58
    v_exp_f32 v59, v59
    v_exp_f32 v60, v60
    v_exp_f32 v61, v61
    v_exp_f32 v62, v62
    v_exp_f32 v63, v63
    s_waitcnt lgkmcnt(1)
    v_smfmac_f32_32x32x32_bf16 v[104:119], v[148:151], v[48:55], v152
    v_exp_f32 v64, v64
    v_exp_f32 v65, v65
    v_exp_f32 v66, v66
    v_exp_f32 v67, v67
    v_smfmac_f32_32x32x32_bf16 v[120:135], v[144:147], v[56:63], v152
    s_mov_b64 exec, s[60:61]
    ds_read_b128 v[144:147], v155 offset:33280
    s_mov_b64 exec, -1
    v_exp_f32 v68, v68
    v_exp_f32 v69, v69
    v_exp_f32 v70, v70
    v_exp_f32 v71, v71
    s_cmp_lg_u32 s52, 7
    s_cbranch_scc1 L_attn_nosample
    s_lshl_b32 s62, s53, 10
    s_add_u32 s62, s62, 16384
    v_add_u32 v2, s62, v1
    buffer_load_dwordx4 v[4:7], v2, s[44:47], 0 offen sc1
L_attn_nosample:
    s_setprio 0
    s_waitcnt lgkmcnt(1)
    v_mfma_f32_32x32x16_bf16 v[40:55], v[136:139], v[156:159], 0
    v_exp_f32 v8, v8
    v_exp_f32 v9, v9
    v_exp_f32 v10, v10
    v_exp_f32 v11, v11
    v_smfmac_f32_32x32x32_bf16 v[120:135], v[148:151], v[64:71], v152
    s_mov_b64 exec, s[60:61]
    ds_read_b128 v[148:151], v155 offset:33920
    s_mov_b64 exec, -1
    v_exp_f32 v12, v12
    v_exp_f32 v13, v13
    v_exp_f32 v14, v14
    v_exp_f32 v15, v15
    v_mfma_f32_32x32x16_bf16 v[56:71], v[136:139], v[160:163], 0
    ds_read_b128 v[136:139], v153 offset:40960
    v_exp_f32 v16, v16
    v_exp_f32 v17, v17
    v_exp_f32 v18, v18
    v_exp_f32 v19, v19
    s_waitcnt lgkmcnt(2)
    v_smfmac_f32_32x32x32_bf16 v[104:119], v[144:147], v[8:15], v152
    v_exp_f32 v20, v20
    v_exp_f32 v21, v21
    v_exp_f32 v22, v22
    v_exp_f32 v23, v23
    v_mfma_f32_32x32x4bf16_1k v[40:71], v[140:141], v[164:165], v[40:71] cbsz:1 abid:1
    ds_read_b64 v[140:141], v154 offset:43008
    v_exp_f32 v24, v24
    v_exp_f32 v25, v25
    v_exp_f32 v26, v26
    v_exp_f32 v27, v27
    v_exp_f32 v28, v28
    v_exp_f32 v29, v29
    v_exp_f32 v30, v30
    v_exp_f32 v31, v31
    s_waitcnt lgkmcnt(2)
    v_smfmac_f32_32x32x32_bf16 v[104:119], v[148:151], v[16:23], v152
    v_exp_f32 v32, v32
    v_exp_f32 v33, v33
    v_exp_f32 v34, v34
    v_exp_f32 v35, v35
    v_smfmac_f32_32x32x32_bf16 v[120:135], v[144:147], v[24:31], v152
    s_mov_b64 exec, s[60:61]
    ds_read_b128 v[144:147], v155 offset:34560
    s_mov_b64 exec, -1
    v_exp_f32 v36, v36
    v_exp_f32 v37, v37
    v_exp_f32 v38, v38
    v_exp_f32 v39, v39
    s_waitcnt lgkmcnt(1)
    v_mfma_f32_32x32x16_bf16 v[8:23], v[136:139], v[156:159], 0
    v_exp_f32 v40, v40
    v_exp_f32 v41, v41
    v_exp_f32 v42, v42
    v_exp_f32 v43, v43
    v_smfmac_f32_32x32x32_bf16 v[120:135], v[148:151], v[32:39], v152
    s_mov_b64 exec, s[60:61]
    ds_read_b128 v[148:151], v155 offset:35200
    s_mov_b64 exec, -1
    v_exp_f32 v44, v44
    v_exp_f32 v45, v45
    v_exp_f32 v46, v46
    v_exp_f32 v47, v47
    v_mfma_f32_32x32x16_bf16 v[24:39], v[136:139], v[160:163], 0
    ds_read_b128 v[136:139], v153 offset:41984
    v_exp_f32 v48, v48
    v_exp_f32 v49, v49
    v_exp_f32 v50, v50
    v_exp_f32 v51, v51
    s_waitcnt lgkmcnt(2)
    v_smfmac_f32_32x32x32_bf16 v[104:119], v[144:147], v[40:47], v152
    v_exp_f32 v52, v52
    v_exp_f32 v53, v53
    v_exp_f32 v54, v54
    v_exp_f32 v55, v55
    v_mfma_f32_32x32x4bf16_1k v[8:39], v[140:141], v[164:165], v[8:39] cbsz:1 abid:0
    v_exp_f32 v56, v56
    v_exp_f32 v57, v57
    v_exp_f32 v58, v58
    v_exp_f32 v59, v59
    v_exp_f32 v60, v60
    v_exp_f32 v61, v61
    v_exp_f32 v62, v62
    v_exp_f32 v63, v63
    s_waitcnt lgkmcnt(1)
    v_smfmac_f32_32x32x32_bf16 v[104:119], v[148:151], v[48:55], v152
    v_exp_f32 v64, v64
    v_exp_f32 v65, v65
    v_exp_f32 v66, v66
    v_exp_f32 v67, v67
    v_smfmac_f32_32x32x32_bf16 v[120:135], v[144:147], v[56:63], v152
    s_mov_b64 exec, s[60:61]
    ds_read_b128 v[144:147], v155 offset:43520
    s_mov_b64 exec, -1
    v_exp_f32 v68, v68
    v_exp_f32 v69, v69
    v_exp_f32 v70, v70
    v_exp_f32 v71, v71
    v_add_u32 v153, 40960, v153
    v_add_u32 v154, 40960, v154
    v_add_u32 v155, 40960, v155
    s_cmp_lg_u32 s52, 7
    s_cbranch_scc1 L_attn_nopoll
    s_waitcnt vmcnt(0)
    s_mov_b32 s69, 0
    s_branch L_pollc_y
L_poll_y:
    buffer_load_dwordx4 v[4:7], v2, s[44:47], 0 offen sc1
    s_waitcnt vmcnt(0)
L_pollc_y:
    v_xor_b32 v4, s57, v4
    v_xor_b32 v5, s57, v5
    v_xor_b32 v6, s57, v6
    v_xor_b32 v7, s57, v7
    v_or_b32 v4, v4, v5
    v_or3_b32 v4, v4, v6, v7
    v_cmp_ne_u32 vcc, 0, v4
    s_add_u32 s69, s69, 1
    s_nop 2
    s_cmp_eq_u64 vcc, 0
    s_cbranch_scc1 L_polld_y
    s_cmp_lt_u32 s69, 1000000
    s_cbranch_scc1 L_poll_y
L_polld_y:
L_attn_nopoll:
    s_barrier
L_tail_dma:
    s_cmp_lt_u32 s52, 5
    s_cbranch_scc1 L_yd_done
    s_sub_u32 s64, s52, 5
    s_mul_i32 s65, s53, 327680
    s_lshl_b32 s66, s54, 7
    s_add_u32 s65, s65, s66
    s_lshl_b32 s66, s64, 15
    s_add_u32 s65, s65, s66
    s_lshl_b32 s66, s64, 10
    s_add_u32 m0, s66, 102400
    s_add_u32 s65, s65, 2883584
    buffer_load_dwordx4 v240, s[44:47], s65 offen sc1 lds
    s_add_u32 m0, m0, 3072
    s_add_u32 s65, s65, 98304
    buffer_load_dwordx4 v240, s[44:47], s65 offen sc1 lds
    s_add_u32 m0, m0, 3072
    s_add_u32 s65, s65, 98304
    buffer_load_dwordx4 v240, s[44:47], s65 offen sc1 lds
    s_add_u32 m0, m0, 3072
    s_add_u32 s65, s65, 98304
    s_cmp_lg_u32 s52, 5
    s_cbranch_scc1 L_yd_done
    buffer_load_dwordx4 v240, s[44:47], s65 offen sc1 lds
L_yd_done:
    s_mov_b32 s36, s12
    s_mov_b32 s37, s13
    s_mov_b32 s38, 819200
    s_mov_b32 s39, 0x00020000
    s_mul_i32 s91, s56, 160
    s_lshl_b32 s90, s52, 10
    s_setprio 3
    s_waitcnt lgkmcnt(1)
    v_mfma_f32_32x32x16_bf16 v[40:55], v[136:139], v[156:159], 0
    v_exp_f32 v8, v8
    v_exp_f32 v9, v9
    v_exp_f32 v10, v10
    v_exp_f32 v11, v11
    v_smfmac_f32_32x32x32_bf16 v[120:135], v[148:151], v[64:71], v152
    s_mov_b64 exec, s[60:61]
    ds_read_b128 v[148:151], v155 offset:3200
    s_mov_b64 exec, -1
    v_exp_f32 v12, v12
    v_exp_f32 v13, v13
    v_exp_f32 v14, v14
    v_exp_f32 v15, v15
    v_mfma_f32_32x32x16_bf16 v[56:71], v[136:139], v[160:163], 0
    ds_read_b128 v[136:139], v153 offset:10240
    v_exp_f32 v16, v16
    v_exp_f32 v17, v17
    v_exp_f32 v18, v18
    v_exp_f32 v19, v19
    s_waitcnt lgkmcnt(2)
    v_smfmac_f32_32x32x32_bf16 v[104:119], v[144:147], v[8:15], v152
    s_cmp_ge_u32 s52, 5
    s_cbranch_scc1 L_tdsm_1
    s_mov_b32 m0, s90
    s_add_u32 s90, s90, 5120
    buffer_load_dwordx4 v245, s[36:39], s91 offen  lds
    s_add_u32 s91, s91, 40960
L_tdsm_1:
    v_exp_f32 v20, v20
    v_exp_f32 v21, v21
    v_exp_f32 v22, v22
    v_exp_f32 v23, v23
    v_mfma_f32_32x32x4bf16_1k v[40:71], v[140:141], v[164:165], v[40:71] cbsz:1 abid:1
    ds_read_b64 v[140:141], v154 offset:12288
    v_exp_f32 v24, v24
    v_exp_f32 v25, v25
    v_exp_f32 v26, v26
    v_exp_f32 v27, v27
    s_cmp_ge_u32 s52, 5
    s_cbranch_scc1 L_tdsm_2
    s_mov_b32 m0, s90
    s_add_u32 s90, s90, 5120
    buffer_load_dwordx4 v245, s[36:39], s91 offen  lds
    s_add_u32 s91, s91, 40960
L_tdsm_2:
    v_exp_f32 v28, v28
    v_exp_f32 v29, v29
    v_exp_f32 v30, v30
    v_exp_f32 v31, v31
    s_waitcnt lgkmcnt(2)
    v_smfmac_f32_32x32x32_bf16 v[104:119], v[148:151], v[16:23], v152
    v_exp_f32 v32, v32
    v_exp_f32 v33, v33
    v_exp_f32 v34, v34
    v_exp_f32 v35, v35
    v_smfmac_f32_32x32x32_bf16 v[120:135], v[144:147], v[24:31], v152
    s_mov_b64 exec, s[60:61]
    ds_read_b128 v[144:147], v155 offset:3840
    s_mov_b64 exec, -1
    s_cmp_ge_u32 s52, 5
    s_cbranch_scc1 L_tdsm_3
    s_mov_b32 m0, s90
    s_add_u32 s90, s90, 5120
    buffer_load_dwordx4 v245, s[36:39], s91 offen  lds
    s_add_u32 s91, s91, 40960
L_tdsm_3:
    v_exp_f32 v36, v36
    v_exp_f32 v37, v37
    v_exp_f32 v38, v38
    v_exp_f32 v39, v39
    s_waitcnt lgkmcnt(1)
    v_mfma_f32_32x32x16_bf16 v[8:23], v[136:139], v[156:159], 0
    v_exp_f32 v40, v40
    v_exp_f32 v41, v41
    v_exp_f32 v42, v42
    v_exp_f32 v43, v43
    v_smfmac_f32_32x32x32_bf16 v[120:135], v[148:151], v[32:39], v152
    s_mov_b64 exec, s[60:61]
    ds_read_b128 v[148:151], v155 offset:4480
    s_mov_b64 exec, -1
    v_exp_f32 v44, v44
    v_exp_f32 v45, v45
    v_exp_f32 v46, v46
    v_exp_f32 v47, v47
    v_mfma_f32_32x32x16_bf16 v[24:39], v[136:139], v[160:163], 0
    ds_read_b128 v[136:139], v153 offset:11264
    v_exp_f32 v48, v48
    v_exp_f32 v49, v49
    v_exp_f32 v50, v50
    v_exp_f32 v51, v51
    s_waitcnt lgkmcnt(2)
    v_smfmac_f32_32x32x32_bf16 v[104:119], v[144:147], v[40:47], v152
    s_cmp_ge_u32 s52, 5
    s_cbranch_scc1 L_tdsm_4
    s_mov_b32 m0, s90
    s_add_u32 s90, s90, 5120
    buffer_load_dwordx4 v245, s[36:39], s91 offen  lds
    s_add_u32 s91, s91, 40960
L_tdsm_4:
    v_exp_f32 v52, v52
    v_exp_f32 v53, v53
    v_exp_f32 v54, v54
    v_exp_f32 v55, v55
    v_mfma_f32_32x32x4bf16_1k v[8:39], v[140:141], v[164:165], v[8:39] cbsz:1 abid:0
    v_exp_f32 v56, v56
    v_exp_f32 v57, v57
    v_exp_f32 v58, v58
    v_exp_f32 v59, v59
    s_cmp_ge_u32 s52, 5
    s_cbranch_scc1 L_tdsm_5
    s_mov_b32 m0, s90
    s_add_u32 s90, s90, 5120
    buffer_load_dwordx4 v245, s[36:39], s91 offen  lds
    s_add_u32 s91, s91, 40960
L_tdsm_5:
    v_exp_f32 v60, v60
    v_exp_f32 v61, v61
    v_exp_f32 v62, v62
    v_exp_f32 v63, v63
    s_waitcnt lgkmcnt(1)
    v_smfmac_f32_32x32x32_bf16 v[104:119], v[148:151], v[48:55], v152
    v_exp_f32 v64, v64
    v_exp_f32 v65, v65
    v_exp_f32 v66, v66
    v_exp_f32 v67, v67
    v_smfmac_f32_32x32x32_bf16 v[120:135], v[144:147], v[56:63], v152
    s_mov_b64 exec, s[60:61]
    ds_read_b128 v[144:147], v155 offset:12800
    s_mov_b64 exec, -1
    s_cmp_ge_u32 s52, 5
    s_cbranch_scc1 L_tdsm_6
    s_mov_b32 m0, s90
    s_add_u32 s90, s90, 5120
    buffer_load_dwordx4 v245, s[36:39], s91 offen  lds
    s_add_u32 s91, s91, 40960
L_tdsm_6:
    v_exp_f32 v68, v68
    v_exp_f32 v69, v69
    v_exp_f32 v70, v70
    v_exp_f32 v71, v71
    s_setprio 2
    s_waitcnt lgkmcnt(1)
    v_mfma_f32_32x32x16_bf16 v[40:55], v[136:139], v[156:159], 0
    v_exp_f32 v8, v8
    v_exp_f32 v9, v9
    v_exp_f32 v10, v10
    v_exp_f32 v11, v11
    v_smfmac_f32_32x32x32_bf16 v[120:135], v[148:151], v[64:71], v152
    s_mov_b64 exec, s[60:61]
    ds_read_b128 v[148:151], v155 offset:13440
    s_mov_b64 exec, -1
    v_exp_f32 v12, v12
    v_exp_f32 v13, v13
    v_exp_f32 v14, v14
    v_exp_f32 v15, v15
    v_mfma_f32_32x32x16_bf16 v[56:71], v[136:139], v[160:163], 0
    ds_read_b128 v[136:139], v153 offset:20480
    v_exp_f32 v16, v16
    v_exp_f32 v17, v17
    v_exp_f32 v18, v18
    v_exp_f32 v19, v19
    s_waitcnt lgkmcnt(2)
    v_smfmac_f32_32x32x32_bf16 v[104:119], v[144:147], v[8:15], v152
    s_cmp_ge_u32 s52, 5
    s_cbranch_scc1 L_tdsm_7
    s_mov_b32 m0, s90
    s_add_u32 s90, s90, 5120
    buffer_load_dwordx4 v245, s[36:39], s91 offen  lds
    s_add_u32 s91, s91, 40960
L_tdsm_7:
    v_exp_f32 v20, v20
    v_exp_f32 v21, v21
    v_exp_f32 v22, v22
    v_exp_f32 v23, v23
    v_mfma_f32_32x32x4bf16_1k v[40:71], v[140:141], v[164:165], v[40:71] cbsz:1 abid:1
    ds_read_b64 v[140:141], v154 offset:22528
    v_exp_f32 v24, v24
    v_exp_f32 v25, v25
    v_exp_f32 v26, v26
    v_exp_f32 v27, v27
    s_cmp_ge_u32 s52, 5
    s_cbranch_scc1 L_tdsm_8
    s_mov_b32 m0, s90
    s_add_u32 s90, s90, 5120
    buffer_load_dwordx4 v245, s[36:39], s91 offen  lds
    s_add_u32 s91, s91, 40960
L_tdsm_8:
    v_exp_f32 v28, v28
    v_exp_f32 v29, v29
    v_exp_f32 v30, v30
    v_exp_f32 v31, v31
    s_waitcnt lgkmcnt(2)
    v_smfmac_f32_32x32x32_bf16 v[104:119], v[148:151], v[16:23], v152
    v_exp_f32 v32, v32
    v_exp_f32 v33, v33
    v_exp_f32 v34, v34
    v_exp_f32 v35, v35
    v_smfmac_f32_32x32x32_bf16 v[120:135], v[144:147], v[24:31], v152
    s_mov_b64 exec, s[60:61]
    ds_read_b128 v[144:147], v155 offset:14080
    s_mov_b64 exec, -1
    s_cmp_ge_u32 s52, 5
    s_cbranch_scc1 L_tdsm_9
    s_mov_b32 m0, s90
    s_add_u32 s90, s90, 5120
    buffer_load_dwordx4 v245, s[36:39], s91 offen  lds
    s_add_u32 s91, s91, 40960
L_tdsm_9:
    v_exp_f32 v36, v36
    v_exp_f32 v37, v37
    v_exp_f32 v38, v38
    v_exp_f32 v39, v39
    s_waitcnt lgkmcnt(1)
    v_mfma_f32_32x32x16_bf16 v[8:23], v[136:139], v[156:159], 0
    v_exp_f32 v40, v40
    v_exp_f32 v41, v41
    v_exp_f32 v42, v42
    v_exp_f32 v43, v43
    v_smfmac_f32_32x32x32_bf16 v[120:135], v[148:151], v[32:39], v152
    s_mov_b64 exec, s[60:61]
    ds_read_b128 v[148:151], v155 offset:14720
    s_mov_b64 exec, -1
    v_exp_f32 v44, v44
    v_exp_f32 v45, v45
    v_exp_f32 v46, v46
    v_exp_f32 v47, v47
    v_mfma_f32_32x32x16_bf16 v[24:39], v[136:139], v[160:163], 0
    ds_read_b128 v[136:139], v153 offset:21504
    v_exp_f32 v48, v48
    v_exp_f32 v49, v49
    v_exp_f32 v50, v50
    v_exp_f32 v51, v51
    s_waitcnt lgkmcnt(2)
    v_smfmac_f32_32x32x32_bf16 v[104:119], v[144:147], v[40:47], v152
    s_cmp_ge_u32 s52, 5
    s_cbranch_scc1 L_tdsm_10
    s_mov_b32 m0, s90
    s_add_u32 s90, s90, 5120
    buffer_load_dwordx4 v245, s[36:39], s91 offen  lds
    s_add_u32 s91, s91, 40960
L_tdsm_10:
    v_exp_f32 v52, v52
    v_exp_f32 v53, v53
    v_exp_f32 v54, v54
    v_exp_f32 v55, v55
    v_mfma_f32_32x32x4bf16_1k v[8:39], v[140:141], v[164:165], v[8:39] cbsz:1 abid:0
    v_exp_f32 v56, v56
    v_exp_f32 v57, v57
    v_exp_f32 v58, v58
    v_exp_f32 v59, v59
    s_cmp_ge_u32 s52, 5
    s_cbranch_scc1 L_tdsm_11
    s_mov_b32 m0, s90
    s_add_u32 s90, s90, 5120
    buffer_load_dwordx4 v245, s[36:39], s91 offen  lds
    s_add_u32 s91, s91, 40960
L_tdsm_11:
    v_exp_f32 v60, v60
    v_exp_f32 v61, v61
    v_exp_f32 v62, v62
    v_exp_f32 v63, v63
    s_waitcnt lgkmcnt(1)
    v_smfmac_f32_32x32x32_bf16 v[104:119], v[148:151], v[48:55], v152
    v_exp_f32 v64, v64
    v_exp_f32 v65, v65
    v_exp_f32 v66, v66
    v_exp_f32 v67, v67
    v_smfmac_f32_32x32x32_bf16 v[120:135], v[144:147], v[56:63], v152
    s_mov_b64 exec, s[60:61]
    ds_read_b128 v[144:147], v155 offset:23040
    s_mov_b64 exec, -1
    s_cmp_ge_u32 s52, 5
    s_cbranch_scc1 L_tdsm_12
    s_mov_b32 m0, s90
    s_add_u32 s90, s90, 5120
    buffer_load_dwordx4 v245, s[36:39], s91 offen  lds
    s_add_u32 s91, s91, 40960
L_tdsm_12:
    v_exp_f32 v68, v68
    v_exp_f32 v69, v69
    v_exp_f32 v70, v70
    v_exp_f32 v71, v71
    s_setprio 1
    s_waitcnt lgkmcnt(1)
    v_mfma_f32_32x32x16_bf16 v[40:55], v[136:139], v[156:159], 0
    v_exp_f32 v8, v8
    v_exp_f32 v9, v9
    v_exp_f32 v10, v10
    v_exp_f32 v11, v11
    v_smfmac_f32_32x32x32_bf16 v[120:135], v[148:151], v[64:71], v152
    s_mov_b64 exec, s[60:61]
    ds_read_b128 v[148:151], v155 offset:23680
    s_mov_b64 exec, -1
    v_exp_f32 v12, v12
    v_exp_f32 v13, v13
    v_exp_f32 v14, v14
    v_exp_f32 v15, v15
    v_mfma_f32_32x32x16_bf16 v[56:71], v[136:139], v[160:163], 0
    ds_read_b128 v[136:139], v153 offset:30720
    v_exp_f32 v16, v16
    v_exp_f32 v17, v17
    v_exp_f32 v18, v18
    v_exp_f32 v19, v19
    s_waitcnt lgkmcnt(2)
    v_smfmac_f32_32x32x32_bf16 v[104:119], v[144:147], v[8:15], v152
    s_cmp_ge_u32 s52, 5
    s_cbranch_scc1 L_tdsm_13
    s_mov_b32 m0, s90
    s_add_u32 s90, s90, 5120
    buffer_load_dwordx4 v245, s[36:39], s91 offen  lds
    s_add_u32 s91, s91, 40960
L_tdsm_13:
    v_exp_f32 v20, v20
    v_exp_f32 v21, v21
    v_exp_f32 v22, v22
    v_exp_f32 v23, v23
    v_mfma_f32_32x32x4bf16_1k v[40:71], v[140:141], v[164:165], v[40:71] cbsz:1 abid:1
    ds_read_b64 v[140:141], v154 offset:32768
    v_exp_f32 v24, v24
    v_exp_f32 v25, v25
    v_exp_f32 v26, v26
    v_exp_f32 v27, v27
    s_cmp_ge_u32 s52, 5
    s_cbranch_scc1 L_tdsm_14
    s_mov_b32 m0, s90
    s_add_u32 s90, s90, 5120
    buffer_load_dwordx4 v245, s[36:39], s91 offen  lds
    s_add_u32 s91, s91, 40960
L_tdsm_14:
    v_exp_f32 v28, v28
    v_exp_f32 v29, v29
    v_exp_f32 v30, v30
    v_exp_f32 v31, v31
    s_waitcnt lgkmcnt(2)
    v_smfmac_f32_32x32x32_bf16 v[104:119], v[148:151], v[16:23], v152
    v_exp_f32 v32, v32
    v_exp_f32 v33, v33
    v_exp_f32 v34, v34
    v_exp_f32 v35, v35
    v_smfmac_f32_32x32x32_bf16 v[120:135], v[144:147], v[24:31], v152
    s_mov_b64 exec, s[60:61]
    ds_read_b128 v[144:147], v155 offset:24320
    s_mov_b64 exec, -1
    s_cmp_ge_u32 s52, 5
    s_cbranch_scc1 L_tdsm_15
    s_mov_b32 m0, s90
    s_add_u32 s90, s90, 5120
    buffer_load_dwordx4 v245, s[36:39], s91 offen  lds
    s_add_u32 s91, s91, 40960
L_tdsm_15:
    v_exp_f32 v36, v36
    v_exp_f32 v37, v37
    v_exp_f32 v38, v38
    v_exp_f32 v39, v39
    s_waitcnt lgkmcnt(1)
    v_mfma_f32_32x32x16_bf16 v[8:23], v[136:139], v[156:159], 0
    v_exp_f32 v40, v40
    v_exp_f32 v41, v41
    v_exp_f32 v42, v42
    v_exp_f32 v43, v43
    v_smfmac_f32_32x32x32_bf16 v[120:135], v[148:151], v[32:39], v152
    s_mov_b64 exec, s[60:61]
    ds_read_b128 v[148:151], v155 offset:24960
    s_mov_b64 exec, -1
    v_exp_f32 v44, v44
    v_exp_f32 v45, v45
    v_exp_f32 v46, v46
    v_exp_f32 v47, v47
    v_mfma_f32_32x32x16_bf16 v[24:39], v[136:139], v[160:163], 0
    ds_read_b128 v[136:139], v153 offset:31744
    v_exp_f32 v48, v48
    v_exp_f32 v49, v49
    v_exp_f32 v50, v50
    v_exp_f32 v51, v51
    s_waitcnt lgkmcnt(2)
    v_smfmac_f32_32x32x32_bf16 v[104:119], v[144:147], v[40:47], v152
    s_cmp_ge_u32 s52, 5
    s_cbranch_scc1 L_tdsm_16
    s_mov_b32 m0, s90
    s_add_u32 s90, s90, 5120
    buffer_load_dwordx4 v245, s[36:39], s91 offen  lds
    s_add_u32 s91, s91, 40960
L_tdsm_16:
    v_exp_f32 v52, v52
    v_exp_f32 v53, v53
    v_exp_f32 v54, v54
    v_exp_f32 v55, v55
    v_mfma_f32_32x32x4bf16_1k v[8:39], v[140:141], v[164:165], v[8:39] cbsz:1 abid:0
    v_exp_f32 v56, v56
    v_exp_f32 v57, v57
    v_exp_f32 v58, v58
    v_exp_f32 v59, v59
    s_cmp_ge_u32 s52, 5
    s_cbranch_scc1 L_tdsm_17
    s_mov_b32 m0, s90
    s_add_u32 s90, s90, 5120
    buffer_load_dwordx4 v245, s[36:39], s91 offen  lds
    s_add_u32 s91, s91, 40960
L_tdsm_17:
    v_exp_f32 v60, v60
    v_exp_f32 v61, v61
    v_exp_f32 v62, v62
    v_exp_f32 v63, v63
    s_waitcnt lgkmcnt(1)
    v_smfmac_f32_32x32x32_bf16 v[104:119], v[148:151], v[48:55], v152
    v_exp_f32 v64, v64
    v_exp_f32 v65, v65
    v_exp_f32 v66, v66
    v_exp_f32 v67, v67
    v_smfmac_f32_32x32x32_bf16 v[120:135], v[144:147], v[56:63], v152
    s_mov_b64 exec, s[60:61]
    ds_read_b128 v[144:147], v155 offset:33280
    s_mov_b64 exec, -1
    s_cmp_ge_u32 s52, 5
    s_cbranch_scc1 L_tdsm_18
    s_mov_b32 m0, s90
    s_add_u32 s90, s90, 5120
    buffer_load_dwordx4 v245, s[36:39], s91 offen  lds
    s_add_u32 s91, s91, 40960
L_tdsm_18:
    v_exp_f32 v68, v68
    v_exp_f32 v69, v69
    v_exp_f32 v70, v70
    v_exp_f32 v71, v71
    s_setprio 0
    s_waitcnt lgkmcnt(1)
    v_mfma_f32_32x32x16_bf16 v[40:55], v[136:139], v[156:159], 0
    v_exp_f32 v8, v8
    v_exp_f32 v9, v9
    v_exp_f32 v10, v10
    v_exp_f32 v11, v11
    v_smfmac_f32_32x32x32_bf16 v[120:135], v[148:151], v[64:71], v152
    s_mov_b64 exec, s[60:61]
    ds_read_b128 v[148:151], v155 offset:33920
    s_mov_b64 exec, -1
    v_exp_f32 v12, v12
    v_exp_f32 v13, v13
    v_exp_f32 v14, v14
    v_exp_f32 v15, v15
    v_mfma_f32_32x32x16_bf16 v[56:71], v[136:139], v[160:163], 0
    ds_read_b128 v[136:139], v153 offset:40960
    v_exp_f32 v16, v16
    v_exp_f32 v17, v17
    v_exp_f32 v18, v18
    v_exp_f32 v19, v19
    s_waitcnt lgkmcnt(2)
    v_smfmac_f32_32x32x32_bf16 v[104:119], v[144:147], v[8:15], v152
    s_cmp_ge_u32 s52, 5
    s_cbranch_scc1 L_tdsm_19
    s_mov_b32 m0, s90
    s_add_u32 s90, s90, 5120
    buffer_load_dwordx4 v245, s[36:39], s91 offen  lds
    s_add_u32 s91, s91, 40960
L_tdsm_19:
    v_exp_f32 v20, v20
    v_exp_f32 v21, v21
    v_exp_f32 v22, v22
    v_exp_f32 v23, v23
    v_mfma_f32_32x32x4bf16_1k v[40:71], v[140:141], v[164:165], v[40:71] cbsz:1 abid:1
    ds_read_b64 v[140:141], v154 offset:43008
    v_exp_f32 v24, v24
    v_exp_f32 v25, v25
    v_exp_f32 v26, v26
    v_exp_f32 v27, v27
    s_cmp_ge_u32 s52, 5
    s_cbranch_scc1 L_tdsm_20
    s_mov_b32 m0, s90
    s_add_u32 s90, s90, 5120
    buffer_load_dwordx4 v245, s[36:39], s91 offen  lds
    s_add_u32 s91, s91, 40960
L_tdsm_20:
    v_exp_f32 v28, v28
    v_exp_f32 v29, v29
    v_exp_f32 v30, v30
    v_exp_f32 v31, v31
    s_waitcnt lgkmcnt(2)
    v_smfmac_f32_32x32x32_bf16 v[104:119], v[148:151], v[16:23], v152
    v_exp_f32 v32, v32
    v_exp_f32 v33, v33
    v_exp_f32 v34, v34
    v_exp_f32 v35, v35
    v_smfmac_f32_32x32x32_bf16 v[120:135], v[144:147], v[24:31], v152
    s_mov_b64 exec, s[60:61]
    ds_read_b128 v[144:147], v155 offset:34560
    s_mov_b64 exec, -1
    v_exp_f32 v36, v36
    v_exp_f32 v37, v37
    v_exp_f32 v38, v38
    v_exp_f32 v39, v39
    s_waitcnt lgkmcnt(1)
    v_mfma_f32_32x32x16_bf16 v[8:23], v[136:139], v[156:159], 0
    v_exp_f32 v40, v40
    v_exp_f32 v41, v41
    v_exp_f32 v42, v42
    v_exp_f32 v43, v43
    v_smfmac_f32_32x32x32_bf16 v[120:135], v[148:151], v[32:39], v152
    s_mov_b64 exec, s[60:61]
    ds_read_b128 v[148:151], v155 offset:35200
    s_mov_b64 exec, -1
    v_exp_f32 v44, v44
    v_exp_f32 v45, v45
    v_exp_f32 v46, v46
    v_exp_f32 v47, v47
    v_mfma_f32_32x32x16_bf16 v[24:39], v[136:139], v[160:163], 0
    ds_read_b128 v[136:139], v153 offset:41984
    v_exp_f32 v48, v48
    v_exp_f32 v49, v49
    v_exp_f32 v50, v50
    v_exp_f32 v51, v51
    s_waitcnt lgkmcnt(2)
    v_smfmac_f32_32x32x32_bf16 v[104:119], v[144:147], v[40:47], v152
    v_exp_f32 v52, v52
    v_exp_f32 v53, v53
    v_exp_f32 v54, v54
    v_exp_f32 v55, v55
    v_mfma_f32_32x32x4bf16_1k v[8:39], v[140:141], v[164:165], v[8:39] cbsz:1 abid:0
    v_exp_f32 v56, v56
    v_exp_f32 v57, v57
    v_exp_f32 v58, v58
    v_exp_f32 v59, v59
    v_exp_f32 v60, v60
    v_exp_f32 v61, v61
    v_exp_f32 v62, v62
    v_exp_f32 v63, v63
    s_waitcnt lgkmcnt(1)
    v_smfmac_f32_32x32x32_bf16 v[104:119], v[148:151], v[48:55], v152
    v_exp_f32 v64, v64
    v_exp_f32 v65, v65
    v_exp_f32 v66, v66
    v_exp_f32 v67, v67
    v_smfmac_f32_32x32x32_bf16 v[120:135], v[144:147], v[56:63], v152
    s_mov_b64 exec, s[60:61]
    ds_read_b128 v[144:147], v155 offset:43520
    s_mov_b64 exec, -1
    v_exp_f32 v68, v68
    v_exp_f32 v69, v69
    v_exp_f32 v70, v70
    v_exp_f32 v71, v71
    v_add_u32 v153, 40960, v153
    v_add_u32 v154, 40960, v154
    v_add_u32 v155, 40960, v155
    v_smfmac_f32_32x32x32_bf16 v[120:135], v[148:151], v[64:71], v152
    s_setprio 0
L_ofin:
    v_mov_b32 v4, 159744
    v_mov_b32 v5, 0
    s_mov_b32 s62, 0x2b800000
    s_mov_b32 s63, 0x53800000
    s_waitcnt vmcnt(0) lgkmcnt(0)
    s_nop 4
    s_barrier
    ds_write_b32 v4, v5
    s_cmp_eq_u32 s71, 0
    s_cbranch_scc0 L_ox_hi
    ds_write_b128 v235, v[120:123] offset:0
    ds_write_b128 v235, v[124:127] offset:1024
    ds_write_b128 v235, v[128:131] offset:2048
    s_waitcnt lgkmcnt(0)
    s_barrier
    ds_read_b128 v[16:19], v236 offset:2048
    ds_read_b128 v[8:11], v236 offset:0
    ds_read_b128 v[12:15], v236 offset:1024
    s_waitcnt lgkmcnt(2)
    v_add_f32 v24, v16, v112
    v_add_f32 v25, v16, v112
    v_add_f32 v16, v16, v112
    v_add_f32 v17, v17, v113
    v_add_f32 v18, v18, v114
    v_add_f32 v19, v19, v115
    v_permlane32_swap_b32 v24, v25
    s_waitcnt lgkmcnt(0)
    v_add_f32 v8, v8, v104
    v_add_f32 v9, v9, v105
    v_add_f32 v10, v10, v106
    v_add_f32 v11, v11, v107
    v_add_f32 v12, v12, v108
    v_add_f32 v13, v13, v109
    v_add_f32 v14, v14, v110
    v_add_f32 v15, v15, v111
    s_branch L_ox_done
L_ox_hi:
    ds_write_b128 v235, v[104:107] offset:0
    ds_write_b128 v235, v[108:111] offset:1024
    ds_write_b128 v235, v[112:115] offset:2048
    s_waitcnt lgkmcnt(0)
    s_barrier
    ds_read_b128 v[16:19], v236 offset:2048
    ds_read_b128 v[8:11], v236 offset:0
    ds_read_b128 v[12:15], v236 offset:1024
    s_waitcnt lgkmcnt(2)
    v_add_f32 v24, v16, v128
    v_add_f32 v25, v16, v128
    v_add_f32 v16, v16, v128
    v_add_f32 v17, v17, v129
    v_add_f32 v18, v18, v130
    v_add_f32 v19, v19, v131
    v_permlane32_swap_b32 v24, v25
    s_waitcnt lgkmcnt(0)
    v_add_f32 v8, v8, v120
    v_add_f32 v9, v9, v121
    v_add_f32 v10, v10, v122
    v_add_f32 v11, v11, v123
    v_add_f32 v12, v12, v124
    v_add_f32 v13, v13, v125
    v_add_f32 v14, v14, v126
    v_add_f32 v15, v15, v127
L_ox_done:
    v_rcp_f32 v24, v25
    s_nop 0
    v_mul_f32 v8, v8, v24
    v_mul_f32 v9, v9, v24
    v_mul_f32 v10, v10, v24
    v_mul_f32 v11, v11, v24
    v_mul_f32 v12, v12, v24
    v_mul_f32 v13, v13, v24
    v_mul_f32 v14, v14, v24
    v_mul_f32 v15, v15, v24
    v_mul_f32 v16, v16, v24
    v_mul_f32 v17, v17, v24
    v_mul_f32 v18, v18, v24
    v_mul_f32 v19, v19, v24
    v_cvt_pk_bf16_f32 v26, v8, v9
    v_cvt_pk_bf16_f32 v27, v10, v11
    v_cvt_pk_bf16_f32 v28, v12, v13
    v_cvt_pk_bf16_f32 v29, v14, v15
    v_cvt_pk_bf16_f32 v30, v16, v17
    v_cvt_pk_bf16_f32 v31, v18, v19
    ds_write_b64 v232, v[26:27]
    ds_write_b64 v232, v[28:29] offset:16
    s_mov_b32 exec_hi, 0
    ds_write_b64 v232, v[30:31] offset:32
    s_mov_b32 exec_hi, -1
    ds_read_b128 v[32:35], v233
    ds_read_b128 v[36:39], v233 offset:64
    v_mov_b32 v24, 0
    s_waitcnt lgkmcnt(1)
    buffer_store_dwordx4 v[32:35], v234, s[44:47], 0 offen sc1
    s_mov_b64 exec, 0xffff
    s_waitcnt lgkmcnt(0)
    buffer_store_dwordx4 v[36:39], v234, s[44:47], 0 offen offset:1024 sc1
    s_mov_b64 exec, -1
    v_fma_f32 v24, v8, 0, v24
    v_fma_f32 v25, v9, 0, v25
    v_fma_f32 v24, v10, 0, v24
    v_fma_f32 v25, v11, 0, v25
    v_fma_f32 v24, v12, 0, v24
    v_fma_f32 v25, v13, 0, v25
    v_fma_f32 v24, v14, 0, v24
    v_fma_f32 v25, v15, 0, v25
    v_fma_f32 v24, v16, 0, v24
    v_fma_f32 v25, v17, 0, v25
    v_fma_f32 v24, v18, 0, v24
    v_fma_f32 v25, v19, 0, v25
    v_add_f32 v24, v24, v25
    v_cmp_le_f32 vcc, s62, v24
    v_cmp_ge_f32 s[64:65], s63, v24
    s_nop 3
    s_and_b64 vcc, vcc, s[64:65]
    s_cmp_eq_u64 vcc, -1
    s_cbranch_scc1 L_ox_ok
    s_cmp_lg_u32 s72, 0
    s_cbranch_scc1 L_ox_ok
    v_mov_b32 v5, 1
    ds_write_b32 v4, v5
    s_waitcnt lgkmcnt(0)
L_ox_ok:
    s_barrier
    ds_read_b32 v5, v4
    s_lshl_b32 s62, s56, 2
    s_lshl_b32 s63, s55, 8
    s_add_u32 s62, s62, s63
    s_add_u32 s62, s62, 24576
    ds_read_b64_tr_b16 v[8:9], v226
    ds_read_b64_tr_b16 v[10:11], v226 offset:512
    ds_read_b64_tr_b16 v[12:13], v226 offset:8192
    ds_read_b64_tr_b16 v[14:15], v226 offset:8704
    v_mov_b32 v2, s57
    v_mov_b32 v3, 0
    s_waitcnt lgkmcnt(4)
    v_readfirstlane_b32 s64, v5
    s_waitcnt lgkmcnt(2)
    ds_write_b128 v227, v[8:11]
    s_mov_b64 exec, 0xffff
    s_waitcnt lgkmcnt(1)
    ds_write_b128 v227, v[12:15] offset:128
    s_mov_b64 exec, -1
    s_cmp_lg_u32 s64, 0
    s_cbranch_scc1 L_fallback
    ds_read_b128 v[16:19], v228
    ds_read_b128 v[20:23], v228 offset:1024
    ds_read_b64_tr_b16 v[40:41], v231 offset:0
    ds_read_b64_tr_b16 v[42:43], v231 offset:1280
    ds_read_b64_tr_b16 v[44:45], v231 offset:32
    ds_read_b64_tr_b16 v[46:47], v231 offset:1312
    ds_read_b64_tr_b16 v[48:49], v231 offset:64
    ds_read_b64_tr_b16 v[50:51], v231 offset:1344
    ds_read_b64_tr_b16 v[52:53], v231 offset:96
    ds_read_b64_tr_b16 v[54:55], v231 offset:1376
    ds_read_b64_tr_b16 v[56:57], v231 offset:128
    ds_read_b64_tr_b16 v[58:59], v231 offset:1408
    s_waitcnt vmcnt(0)
    s_barrier
    s_cmp_lg_u32 s52, 0
    s_cbranch_scc1 L_op_noflag
    s_mov_b64 exec, 1
    buffer_store_dword v2, v3, s[44:47], s62 offen sc1
    s_mov_b64 exec, -1
L_op_noflag:
    s_lshl_b32 s62, s54, 6
    s_lshl_b32 s63, s52, 3
    s_add_u32 s62, s62, s63
    s_mul_i32 s62, s62, 2560
    s_mul_i32 s63, s53, 160
    s_add_u32 s62, s62, s63
    s_add_u32 s62, s62, 1280
    s_waitcnt lgkmcnt(10)
    buffer_store_dwordx4 v[16:19], v229, s[48:51], s62 offen nt
    s_mov_b64 exec, 0xffff
    buffer_store_dwordx4 v[20:23], v230, s[48:51], s62 offen nt
    s_mov_b64 exec, -1
    ds_read_b64_tr_b16 v[60:61], v231 offset:5120
    ds_read_b64_tr_b16 v[62:63], v231 offset:6400
    ds_read_b64_tr_b16 v[64:65], v231 offset:5152
    ds_read_b64_tr_b16 v[66:67], v231 offset:6432
    ds_read_b64_tr_b16 v[68:69], v231 offset:5184
    ds_read_b64_tr_b16 v[70:71], v231 offset:6464
    ds_read_b64_tr_b16 v[72:73], v231 offset:5216
    ds_read_b64_tr_b16 v[74:75], v231 offset:6496
    ds_read_b64_tr_b16 v[76:77], v231 offset:5248
    ds_read_b64_tr_b16 v[78:79], v231 offset:6528
    ds_read_b64_tr_b16 v[80:81], v231 offset:10240
    ds_read_b64_tr_b16 v[82:83], v231 offset:11520
    ds_read_b64_tr_b16 v[84:85], v231 offset:10272
    ds_read_b64_tr_b16 v[86:87], v231 offset:11552
    ds_read_b64_tr_b16 v[88:89], v231 offset:10304
    ds_read_b64_tr_b16 v[90:91], v231 offset:11584
    ds_read_b64_tr_b16 v[92:93], v231 offset:10336
    ds_read_b64_tr_b16 v[94:95], v231 offset:11616
    ds_read_b64_tr_b16 v[96:97], v231 offset:10368
    ds_read_b64_tr_b16 v[98:99], v231 offset:11648
    ds_read_b64_tr_b16 v[100:101], v231 offset:15360
    ds_read_b64_tr_b16 v[102:103], v231 offset:16640
    ds_read_b64_tr_b16 v[104:105], v231 offset:15392
    ds_read_b64_tr_b16 v[106:107], v231 offset:16672
    ds_read_b64_tr_b16 v[108:109], v231 offset:15424
    ds_read_b64_tr_b16 v[110:111], v231 offset:16704
    ds_read_b64_tr_b16 v[112:113], v231 offset:15456
    ds_read_b64_tr_b16 v[114:115], v231 offset:16736
    ds_read_b64_tr_b16 v[116:117], v231 offset:15488
    ds_read_b64_tr_b16 v[118:119], v231 offset:16768
    ds_read_b64_tr_b16 v[120:121], v231 offset:20480
    ds_read_b64_tr_b16 v[122:123], v231 offset:21760
    ds_read_b64_tr_b16 v[124:125], v231 offset:20512
    ds_read_b64_tr_b16 v[126:127], v231 offset:21792
    ds_read_b64_tr_b16 v[128:129], v231 offset:20544
    ds_read_b64_tr_b16 v[130:131], v231 offset:21824
    ds_read_b64_tr_b16 v[132:133], v231 offset:20576
    ds_read_b64_tr_b16 v[134:135], v231 offset:21856
    ds_read_b64_tr_b16 v[136:137], v231 offset:20608
    ds_read_b64_tr_b16 v[138:139], v231 offset:21888
    ds_read_b64_tr_b16 v[140:141], v231 offset:25600
    ds_read_b64_tr_b16 v[142:143], v231 offset:26880
    ds_read_b64_tr_b16 v[144:145], v231 offset:25632
    ds_read_b64_tr_b16 v[146:147], v231 offset:26912
    ds_read_b64_tr_b16 v[148:149], v231 offset:25664
    ds_read_b64_tr_b16 v[150:151], v231 offset:26944
    ds_read_b64_tr_b16 v[152:153], v231 offset:25696
    ds_read_b64_tr_b16 v[154:155], v231 offset:26976
    ds_read_b64_tr_b16 v[156:157], v231 offset:25728
    ds_read_b64_tr_b16 v[158:159], v231 offset:27008
    ds_read_b64_tr_b16 v[160:161], v231 offset:30720
    ds_read_b64_tr_b16 v[162:163], v231 offset:32000
    ds_read_b64_tr_b16 v[164:165], v231 offset:30752
    ds_read_b64_tr_b16 v[166:167], v231 offset:32032
    ds_read_b64_tr_b16 v[168:169], v231 offset:30784
    ds_read_b64_tr_b16 v[170:171], v231 offset:32064
    ds_read_b64_tr_b16 v[172:173], v231 offset:30816
    ds_read_b64_tr_b16 v[174:175], v231 offset:32096
    ds_read_b64_tr_b16 v[176:177], v231 offset:30848
    ds_read_b64_tr_b16 v[178:179], v231 offset:32128
    s_and_b32 s64, s52, 3
    s_lshl_b32 s62, s55, 2
    s_add_u32 s62, s62, s64
    s_mul_i32 s65, s62, 40960
    s_mul_i32 s62, s62, 20480
    s_mul_i32 s63, s71, 10240
    s_add_u32 s62, s62, s63
    s_add_u32 s62, s62, 5505024
    s_add_u32 s63, s62, 4096
    s_add_u32 s64, s62, 8192
    s_mul_i32 s66, s56, 160
    s_add_u32 s65, s65, s66
    s_mul_i32 s66, s52, 1536
    s_add_u32 s66, s66, 147456
    v_add_u32 v7, s66, v1
    s_cmp_lg_u32 s52, 0
    s_cbranch_scc1 L_op_nopoll
    s_mov_b32 exec_lo, 0x000000ff
    s_mov_b32 exec_hi, 0
    s_mov_b32 s69, 0
L_poll_o:
    buffer_load_dword v4, v241, s[44:47], 0 offen sc1
    s_waitcnt vmcnt(0)
L_pollc_o:
    v_xor_b32 v4, s57, v4
    v_cmp_ne_u32 vcc, 0, v4
    s_add_u32 s69, s69, 1
    s_nop 2
    s_cmp_eq_u64 vcc, 0
    s_cbranch_scc1 L_polld_o
    s_cmp_lt_u32 s69, 1000000
    s_cbranch_scc1 L_poll_o
L_polld_o:
    s_mov_b64 exec, -1
L_op_nopoll:
    s_barrier
    s_cmp_eq_u32 s71, 0
    s_cbranch_scc1 L_op_p0
    s_setprio 2
    s_branch L_op_p1
L_op_p0:
    s_setprio 3
L_op_p1:
    buffer_load_dwordx4 v[186:189], v1, s[44:47], s62 offen offset:0 sc1
    buffer_load_dwordx4 v[190:193], v1, s[44:47], s62 offen offset:1024 sc1
    buffer_load_dwordx4 v[194:197], v1, s[44:47], s62 offen offset:2048 sc1
    buffer_load_dwordx4 v[198:201], v1, s[44:47], s62 offen offset:3072 sc1
    buffer_load_dwordx4 v[202:205], v1, s[44:47], s63 offen offset:0 sc1
    s_cmp_eq_u32 s71, 0
    s_cbranch_scc1 L_op_p2
    s_setprio 0
    s_branch L_op_p3
L_op_p2:
    s_setprio 1
L_op_p3:
    buffer_load_dwordx4 v[206:209], v1, s[44:47], s63 offen offset:1024 sc1
    buffer_load_dwordx4 v[210:213], v1, s[44:47], s63 offen offset:2048 sc1
    buffer_load_dwordx4 v[214:217], v1, s[44:47], s63 offen offset:3072 sc1
    buffer_load_dwordx4 v[218:221], v1, s[44:47], s64 offen offset:0 sc1
    buffer_load_dwordx4 v[222:225], v1, s[44:47], s64 offen offset:1024 sc1
    s_setprio 0
    s_waitcnt lgkmcnt(0)
    s_waitcnt vmcnt(9)
    v_mfma_f32_16x16x32_bf16 v[8:11], v[40:43], v[186:189], 0
    v_mfma_f32_16x16x32_bf16 v[12:15], v[44:47], v[186:189], 0
    v_mfma_f32_16x16x32_bf16 v[16:19], v[48:51], v[186:189], 0
    v_mfma_f32_16x16x32_bf16 v[20:23], v[52:55], v[186:189], 0
    v_mfma_f32_16x16x32_bf16 v[24:27], v[56:59], v[186:189], 0
    ds_read_b64_tr_b16 v[40:41], v231 offset:35840
    ds_read_b64_tr_b16 v[42:43], v231 offset:37120
    ds_read_b64_tr_b16 v[44:45], v231 offset:35872
    ds_read_b64_tr_b16 v[46:47], v231 offset:37152
    ds_read_b64_tr_b16 v[48:49], v231 offset:35904
    ds_read_b64_tr_b16 v[50:51], v231 offset:37184
    ds_read_b64_tr_b16 v[52:53], v231 offset:35936
    ds_read_b64_tr_b16 v[54:55], v231 offset:37216
    ds_read_b64_tr_b16 v[56:57], v231 offset:35968
    ds_read_b64_tr_b16 v[58:59], v231 offset:37248
    s_waitcnt vmcnt(8)
    v_mfma_f32_16x16x32_bf16 v[8:11], v[60:63], v[190:193], v[8:11]
    v_mfma_f32_16x16x32_bf16 v[12:15], v[64:67], v[190:193], v[12:15]
    v_mfma_f32_16x16x32_bf16 v[16:19], v[68:71], v[190:193], v[16:19]
    v_mfma_f32_16x16x32_bf16 v[20:23], v[72:75], v[190:193], v[20:23]
    v_mfma_f32_16x16x32_bf16 v[24:27], v[76:79], v[190:193], v[24:27]
    ds_read_b64_tr_b16 v[60:61], v231 offset:40960
    ds_read_b64_tr_b16 v[62:63], v231 offset:42240
    ds_read_b64_tr_b16 v[64:65], v231 offset:40992
    ds_read_b64_tr_b16 v[66:67], v231 offset:42272
    ds_read_b64_tr_b16 v[68:69], v231 offset:41024
    ds_read_b64_tr_b16 v[70:71], v231 offset:42304
    ds_read_b64_tr_b16 v[72:73], v231 offset:41056
    ds_read_b64_tr_b16 v[74:75], v231 offset:42336
    ds_read_b64_tr_b16 v[76:77], v231 offset:41088
    ds_read_b64_tr_b16 v[78:79], v231 offset:42368
    s_waitcnt vmcnt(7)
    v_mfma_f32_16x16x32_bf16 v[8:11], v[80:83], v[194:197], v[8:11]
    v_mfma_f32_16x16x32_bf16 v[12:15], v[84:87], v[194:197], v[12:15]
    v_mfma_f32_16x16x32_bf16 v[16:19], v[88:91], v[194:197], v[16:19]
    v_mfma_f32_16x16x32_bf16 v[20:23], v[92:95], v[194:197], v[20:23]
    v_mfma_f32_16x16x32_bf16 v[24:27], v[96:99], v[194:197], v[24:27]
    ds_read_b64_tr_b16 v[80:81], v231 offset:46080
    ds_read_b64_tr_b16 v[82:83], v231 offset:47360
    ds_read_b64_tr_b16 v[84:85], v231 offset:46112
    ds_read_b64_tr_b16 v[86:87], v231 offset:47392
    ds_read_b64_tr_b16 v[88:89], v231 offset:46144
    ds_read_b64_tr_b16 v[90:91], v231 offset:47424
    ds_read_b64_tr_b16 v[92:93], v231 offset:46176
    ds_read_b64_tr_b16 v[94:95], v231 offset:47456
    ds_read_b64_tr_b16 v[96:97], v231 offset:46208
    ds_read_b64_tr_b16 v[98:99], v231 offset:47488
    s_waitcnt vmcnt(6)
    v_mfma_f32_16x16x32_bf16 v[8:11], v[100:103], v[198:201], v[8:11]
    v_mfma_f32_16x16x32_bf16 v[12:15], v[104:107], v[198:201], v[12:15]
    v_mfma_f32_16x16x32_bf16 v[16:19], v[108:111], v[198:201], v[16:19]
    v_mfma_f32_16x16x32_bf16 v[20:23], v[112:115], v[198:201], v[20:23]
    v_mfma_f32_16x16x32_bf16 v[24:27], v[116:119], v[198:201], v[24:27]
    s_waitcnt vmcnt(5)
    v_mfma_f32_16x16x32_bf16 v[8:11], v[120:123], v[202:205], v[8:11]
    v_mfma_f32_16x16x32_bf16 v[12:15], v[124:127], v[202:205], v[12:15]
    v_mfma_f32_16x16x32_bf16 v[16:19], v[128:131], v[202:205], v[16:19]
    v_mfma_f32_16x16x32_bf16 v[20:23], v[132:135], v[202:205], v[20:23]
    v_mfma_f32_16x16x32_bf16 v[24:27], v[136:139], v[202:205], v[24:27]
    s_waitcnt vmcnt(4)
    v_mfma_f32_16x16x32_bf16 v[8:11], v[140:143], v[206:209], v[8:11]
    v_mfma_f32_16x16x32_bf16 v[12:15], v[144:147], v[206:209], v[12:15]
    v_mfma_f32_16x16x32_bf16 v[16:19], v[148:151], v[206:209], v[16:19]
    v_mfma_f32_16x16x32_bf16 v[20:23], v[152:155], v[206:209], v[20:23]
    v_mfma_f32_16x16x32_bf16 v[24:27], v[156:159], v[206:209], v[24:27]
    s_waitcnt vmcnt(3)
    v_mfma_f32_16x16x32_bf16 v[8:11], v[160:163], v[210:213], v[8:11]
    v_mfma_f32_16x16x32_bf16 v[12:15], v[164:167], v[210:213], v[12:15]
    v_mfma_f32_16x16x32_bf16 v[16:19], v[168:171], v[210:213], v[16:19]
    v_mfma_f32_16x16x32_bf16 v[20:23], v[172:175], v[210:213], v[20:23]
    v_mfma_f32_16x16x32_bf16 v[24:27], v[176:179], v[210:213], v[24:27]
    s_waitcnt vmcnt(2) lgkmcnt(15)
    v_mfma_f32_16x16x32_bf16 v[8:11], v[40:43], v[214:217], v[8:11]
    v_mfma_f32_16x16x32_bf16 v[12:15], v[44:47], v[214:217], v[12:15]
    v_mfma_f32_16x16x32_bf16 v[16:19], v[48:51], v[214:217], v[16:19]
    v_mfma_f32_16x16x32_bf16 v[20:23], v[52:55], v[214:217], v[20:23]
    v_mfma_f32_16x16x32_bf16 v[24:27], v[56:59], v[214:217], v[24:27]
    s_waitcnt vmcnt(1) lgkmcnt(10)
    v_mfma_f32_16x16x32_bf16 v[8:11], v[60:63], v[218:221], v[8:11]
    v_mfma_f32_16x16x32_bf16 v[12:15], v[64:67], v[218:221], v[12:15]
    v_mfma_f32_16x16x32_bf16 v[16:19], v[68:71], v[218:221], v[16:19]
    v_mfma_f32_16x16x32_bf16 v[20:23], v[72:75], v[218:221], v[20:23]
    v_mfma_f32_16x16x32_bf16 v[24:27], v[76:79], v[218:221], v[24:27]
    s_waitcnt vmcnt(0) lgkmcnt(0)
    v_mfma_f32_16x16x32_bf16 v[8:11], v[80:83], v[222:225], v[8:11]
    v_mfma_f32_16x16x32_bf16 v[12:15], v[84:87], v[222:225], v[12:15]
    v_mfma_f32_16x16x32_bf16 v[16:19], v[88:91], v[222:225], v[16:19]
    v_mfma_f32_16x16x32_bf16 v[20:23], v[92:95], v[222:225], v[20:23]
    v_mfma_f32_16x16x32_bf16 v[24:27], v[96:99], v[222:225], v[24:27]
    s_cmp_eq_u32 s71, 0
    s_cbranch_scc0 L_px_hi
    s_nop 5
    ds_write_b128 v235, v[20:23] offset:0
    ds_write_b128 v235, v[24:27] offset:1024
    s_waitcnt lgkmcnt(0)
    s_barrier
    ds_read_b128 v[40:43], v236 offset:0
    ds_read_b128 v[44:47], v236 offset:1024
    ds_read_b128 v[48:51], v236 offset:2048
    s_waitcnt lgkmcnt(2)
    v_add_f32 v40, v40, v8
    v_add_f32 v41, v41, v9
    v_add_f32 v42, v42, v10
    v_add_f32 v43, v43, v11
    v_cvt_pk_bf16_f32 v56, v40, v41
    v_cvt_pk_bf16_f32 v57, v42, v43
    ds_write_b64 v237, v[56:57] offset:0
    s_waitcnt lgkmcnt(2)
    v_add_f32 v44, v44, v12
    v_add_f32 v45, v45, v13
    v_add_f32 v46, v46, v14
    v_add_f32 v47, v47, v15
    v_cvt_pk_bf16_f32 v58, v44, v45
    v_cvt_pk_bf16_f32 v59, v46, v47
    ds_write_b64 v237, v[58:59] offset:32
    s_waitcnt lgkmcnt(2)
    v_add_f32 v48, v48, v16
    v_add_f32 v49, v49, v17
    v_add_f32 v50, v50, v18
    v_add_f32 v51, v51, v19
    v_cvt_pk_bf16_f32 v60, v48, v49
    v_cvt_pk_bf16_f32 v61, v50, v51
    ds_write_b64 v237, v[60:61] offset:64
    ds_read_b128 v[64:67], v7
    ds_read_b128 v[68:71], v7 offset:1024
    s_waitcnt lgkmcnt(1)
    buffer_store_dwordx4 v[64:67], v238, s[48:51], s65 offen nt
    s_mov_b32 exec_hi, 0
    s_waitcnt lgkmcnt(0)
    buffer_store_dwordx4 v[68:71], v239, s[48:51], s65 offen nt
    s_mov_b32 exec_hi, -1
    s_branch L_px_done
L_px_hi:
    s_nop 5
    ds_write_b128 v235, v[8:11] offset:0
    ds_write_b128 v235, v[12:15] offset:1024
    ds_write_b128 v235, v[16:19] offset:2048
    s_waitcnt lgkmcnt(0)
    s_barrier
    ds_read_b128 v[40:43], v236 offset:0
    ds_read_b128 v[44:47], v236 offset:1024
    s_waitcnt lgkmcnt(1)
    v_add_f32 v40, v40, v20
    v_add_f32 v41, v41, v21
    v_add_f32 v42, v42, v22
    v_add_f32 v43, v43, v23
    v_cvt_pk_bf16_f32 v56, v40, v41
    v_cvt_pk_bf16_f32 v57, v42, v43
    ds_write_b64 v237, v[56:57] offset:0
    s_waitcnt lgkmcnt(1)
    v_add_f32 v44, v44, v24
    v_add_f32 v45, v45, v25
    v_add_f32 v46, v46, v26
    v_add_f32 v47, v47, v27
    v_cvt_pk_bf16_f32 v58, v44, v45
    v_cvt_pk_bf16_f32 v59, v46, v47
    ds_write_b64 v237, v[58:59] offset:32
    ds_read_b128 v[64:67], v7
    s_waitcnt lgkmcnt(0)
    buffer_store_dwordx4 v[64:67], v238, s[48:51], s65 offen nt
L_px_done:
L_end:
    s_endpgm
L_code_end:
L_fallback:
    s_mov_b32 s72, 1
    s_waitcnt vmcnt(0) lgkmcnt(0)
    s_barrier
    s_lshl_b32 s90, s52, 10
    s_add_u32 s90, s90, 0
    s_add_u32 s91, s90, 65536
    s_mov_b32 m0, s90
    s_add_u32 s90, s90, 8192
    buffer_load_dwordx4 v1, s[44:47], s91 offen sc1 lds
    s_add_u32 s91, s91, 8192
    s_mov_b32 m0, s90
    s_add_u32 s90, s90, 8192
    buffer_load_dwordx4 v1, s[44:47], s91 offen sc1 lds
    s_add_u32 s91, s91, 8192
    s_mov_b32 m0, s90
    s_add_u32 s90, s90, 8192
    buffer_load_dwordx4 v1, s[44:47], s91 offen sc1 lds
    s_add_u32 s91, s91, 8192
    s_mov_b32 m0, s90
    s_add_u32 s90, s90, 8192
    buffer_load_dwordx4 v1, s[44:47], s91 offen sc1 lds
    s_add_u32 s91, s91, 8192
    s_mov_b32 m0, s90
    s_add_u32 s90, s90, 8192
    buffer_load_dwordx4 v1, s[44:47], s91 offen sc1 lds
    s_add_u32 s91, s91, 8192
    s_mov_b32 m0, s90
    s_add_u32 s90, s90, 8192
    buffer_load_dwordx4 v1, s[44:47], s91 offen sc1 lds
    s_add_u32 s91, s91, 8192
    s_mov_b32 m0, s90
    s_add_u32 s90, s90, 8192
    buffer_load_dwordx4 v1, s[44:47], s91 offen sc1 lds
    s_add_u32 s91, s91, 8192
    s_mov_b32 m0, s90
    s_add_u32 s90, s90, 8192
    buffer_load_dwordx4 v1, s[44:47], s91 offen sc1 lds
    s_add_u32 s91, s91, 8192
    s_mov_b32 m0, s90
    s_add_u32 s90, s90, 8192
    buffer_load_dwordx4 v1, s[44:47], s91 offen sc1 lds
    s_add_u32 s91, s91, 8192
    s_mov_b32 m0, s90
    s_add_u32 s90, s90, 8192
    buffer_load_dwordx4 v1, s[44:47], s91 offen sc1 lds
    s_add_u32 s91, s91, 8192
    s_mov_b32 m0, s90
    s_add_u32 s90, s90, 8192
    buffer_load_dwordx4 v1, s[44:47], s91 offen sc1 lds
    s_add_u32 s91, s91, 8192
    s_mov_b32 m0, s90
    s_add_u32 s90, s90, 8192
    buffer_load_dwordx4 v1, s[44:47], s91 offen sc1 lds
    s_add_u32 s91, s91, 8192
    s_mov_b32 m0, s90
    s_add_u32 s90, s90, 8192
    buffer_load_dwordx4 v1, s[44:47], s91 offen sc1 lds
    s_add_u32 s91, s91, 8192
    s_mov_b32 m0, s90
    s_add_u32 s90, s90, 8192
    buffer_load_dwordx4 v1, s[44:47], s91 offen sc1 lds
    s_add_u32 s91, s91, 8192
    s_mov_b32 m0, s90
    s_add_u32 s90, s90, 8192
    buffer_load_dwordx4 v1, s[44:47], s91 offen sc1 lds
    s_add_u32 s91, s91, 8192
    s_mov_b32 m0, s90
    s_add_u32 s90, s90, 8192
    buffer_load_dwordx4 v1, s[44:47], s91 offen sc1 lds
    s_add_u32 s91, s91, 8192
    s_mov_b32 m0, s90
    s_add_u32 s90, s90, 8192
    buffer_load_dwordx4 v1, s[44:47], s91 offen sc1 lds
    s_add_u32 s91, s91, 8192
    s_mov_b32 m0, s90
    s_add_u32 s90, s90, 8192
    buffer_load_dwordx4 v1, s[44:47], s91 offen sc1 lds
    s_add_u32 s91, s91, 8192
    s_mov_b32 m0, s90
    s_add_u32 s90, s90, 8192
    buffer_load_dwordx4 v1, s[44:47], s91 offen sc1 lds
    s_add_u32 s91, s91, 8192
    s_mov_b32 m0, s90
    s_add_u32 s90, s90, 8192
    buffer_load_dwordx4 v1, s[44:47], s91 offen sc1 lds
    s_add_u32 s91, s91, 8192
    v_mov_b32 v153, v1
    v_lshlrev_b32 v154, 3, v0
    v_mov_b32 v2, 0xff7fffff
    v_mov_b32 v3, 0xff7fffff
    s_mov_b32 s73, 0
    s_waitcnt vmcnt(0)
    s_barrier
L_fb_loop:
    ds_read_b128 v[136:139], v153 offset:0
    ds_read_b64 v[140:141], v154 offset:2048
    s_waitcnt lgkmcnt(0)
    v_mfma_f32_32x32x16_bf16 v[8:23], v[136:139], v[156:159], 0
    v_mfma_f32_32x32x16_bf16 v[24:39], v[136:139], v[160:163], 0
    s_nop 9
    v_mfma_f32_32x32x4bf16_1k v[8:39], v[140:141], v[164:165], v[8:39] cbsz:1 abid:0
    s_nop 15
    s_nop 3
    v_max3_f32 v2, v2, v8, v9
    v_max3_f32 v3, v3, v24, v25
    v_max3_f32 v2, v2, v10, v11
    v_max3_f32 v3, v3, v26, v27
    v_max3_f32 v2, v2, v12, v13
    v_max3_f32 v3, v3, v28, v29
    v_max3_f32 v2, v2, v14, v15
    v_max3_f32 v3, v3, v30, v31
    v_max3_f32 v2, v2, v16, v17
    v_max3_f32 v3, v3, v32, v33
    v_max3_f32 v2, v2, v18, v19
    v_max3_f32 v3, v3, v34, v35
    v_max3_f32 v2, v2, v20, v21
    v_max3_f32 v3, v3, v36, v37
    v_max3_f32 v2, v2, v22, v23
    v_max3_f32 v3, v3, v38, v39
    ds_read_b128 v[136:139], v153 offset:1024
    ds_read_b64 v[140:141], v154 offset:2048
    s_waitcnt lgkmcnt(0)
    v_mfma_f32_32x32x16_bf16 v[8:23], v[136:139], v[156:159], 0
    v_mfma_f32_32x32x16_bf16 v[24:39], v[136:139], v[160:163], 0
    s_nop 9
    v_mfma_f32_32x32x4bf16_1k v[8:39], v[140:141], v[164:165], v[8:39] cbsz:1 abid:1
    s_nop 15
    s_nop 3
    v_max3_f32 v2, v2, v8, v9
    v_max3_f32 v3, v3, v24, v25
    v_max3_f32 v2, v2, v10, v11
    v_max3_f32 v3, v3, v26, v27
    v_max3_f32 v2, v2, v12, v13
    v_max3_f32 v3, v3, v28, v29
    v_max3_f32 v2, v2, v14, v15
    v_max3_f32 v3, v3, v30, v31
    v_max3_f32 v2, v2, v16, v17
    v_max3_f32 v3, v3, v32, v33
    v_max3_f32 v2, v2, v18, v19
    v_max3_f32 v3, v3, v34, v35
    v_max3_f32 v2, v2, v20, v21
    v_max3_f32 v3, v3, v36, v37
    v_max3_f32 v2, v2, v22, v23
    v_max3_f32 v3, v3, v38, v39
    v_add_u32 v153, 5120, v153
    v_add_u32 v154, 5120, v154
    s_add_u32 s73, s73, 1
    s_cmp_lt_u32 s73, 32
    s_cbranch_scc1 L_fb_loop
    v_mov_b32 v4, v2
    v_mov_b32 v5, v3
    s_nop 1
    v_permlane32_swap_b32 v2, v4
    v_permlane32_swap_b32 v3, v5
    v_max_f32 v2, v2, v4
    v_max_f32 v3, v3, v5
    v_sub_f32 v72, 0, v2
    v_sub_f32 v88, 0, v3
    v_sub_f32 v73, 0, v2
    v_sub_f32 v89, 0, v3
    v_sub_f32 v74, 0, v2
    v_sub_f32 v90, 0, v3
    v_sub_f32 v75, 0, v2
    v_sub_f32 v91, 0, v3
    v_sub_f32 v76, 0, v2
    v_sub_f32 v92, 0, v3
    v_sub_f32 v77, 0, v2
    v_sub_f32 v93, 0, v3
    v_sub_f32 v78, 0, v2
    v_sub_f32 v94, 0, v3
    v_sub_f32 v79, 0, v2
    v_sub_f32 v95, 0, v3
    v_sub_f32 v80, 0, v2
    v_sub_f32 v96, 0, v3
    v_sub_f32 v81, 0, v2
    v_sub_f32 v97, 0, v3
    v_sub_f32 v82, 0, v2
    v_sub_f32 v98, 0, v3
    v_sub_f32 v83, 0, v2
    v_sub_f32 v99, 0, v3
    v_sub_f32 v84, 0, v2
    v_sub_f32 v100, 0, v3
    v_sub_f32 v85, 0, v2
    v_sub_f32 v101, 0, v3
    v_sub_f32 v86, 0, v2
    v_sub_f32 v102, 0, v3
    v_sub_f32 v87, 0, v2
    v_sub_f32 v103, 0, v3
    s_mul_i32 s62, s71, 5120
    v_add_u32 v153, s62, v1
    v_lshl_add_u32 v154, v0, 3, s62
    v_and_b32 v2, 31, v0
    v_lshrrev_b32 v3, 5, v0
    v_mul_u32_u24 v3, 320, v3
    v_lshl_add_u32 v2, v2, 4, v3
    v_add_u32 v155, s62, v2
    v_mov_b32 v152, 0xdddd
    v_mov_b32 v144, 0
    v_mov_b32 v145, 0
    v_mov_b32 v146, 0
    v_mov_b32 v147, 0
    v_mov_b32 v148, 0
    v_mov_b32 v149, 0
    v_mov_b32 v150, 0
    v_mov_b32 v151, 0
    s_mov_b32 exec_lo, 0x00100000
    s_mov_b32 exec_hi, 0x00100000
    v_mov_b32 v144, 0x3f803f80
    v_mov_b32 v145, 0x3f803f80
    v_mov_b32 v146, 0x3f803f80
    v_mov_b32 v147, 0x3f803f80
    v_mov_b32 v148, 0x3f803f80
    v_mov_b32 v149, 0x3f803f80
    v_mov_b32 v150, 0x3f803f80
    v_mov_b32 v151, 0x3f803f80
    s_mov_b64 exec, -1
    v_mov_b32 v64, 0
    v_mov_b32 v65, 0
    v_mov_b32 v66, 0
    v_mov_b32 v67, 0
    v_mov_b32 v68, 0
    v_mov_b32 v69, 0
    v_mov_b32 v70, 0
    v_mov_b32 v71, 0
    s_nop 0
    v_mfma_f32_32x32x16_bf16 v[104:119], v[64:67], v[64:67], 0
    v_mfma_f32_32x32x16_bf16 v[120:135], v[64:67], v[64:67], 0
    ds_read_b128 v[136:139], v153
    ds_read_b64 v[140:141], v154 offset:2048
    s_waitcnt lgkmcnt(0)
    v_mfma_f32_32x32x16_bf16 v[8:23], v[136:139], v[156:159], v[72:87]
    v_mfma_f32_32x32x16_bf16 v[24:39], v[136:139], v[160:163], v[88:103]
    ds_read_b128 v[136:139], v153 offset:1024
    s_mov_b64 exec, s[60:61]
    ds_read_b128 v[144:147], v155 offset:2560
    s_mov_b64 exec, -1
    s_nop 7
    v_mfma_f32_32x32x4bf16_1k v[8:39], v[140:141], v[164:165], v[8:39] cbsz:1 abid:0
    s_nop 15
    s_nop 2
    s_mov_b32 s73, 0
L_fb_attn:
    s_waitcnt lgkmcnt(1)
    v_mfma_f32_32x32x16_bf16 v[40:55], v[136:139], v[156:159], v[72:87]
    v_exp_f32 v8, v8
    v_exp_f32 v9, v9
    v_exp_f32 v10, v10
    v_exp_f32 v11, v11
    v_smfmac_f32_32x32x32_bf16 v[120:135], v[148:151], v[64:71], v152
    s_mov_b64 exec, s[60:61]
    ds_read_b128 v[148:151], v155 offset:3200
    s_mov_b64 exec, -1
    v_exp_f32 v12, v12
    v_exp_f32 v13, v13
    v_exp_f32 v14, v14
    v_exp_f32 v15, v15
    v_mfma_f32_32x32x16_bf16 v[56:71], v[136:139], v[160:163], v[88:103]
    ds_read_b128 v[136:139], v153 offset:10240
    v_exp_f32 v16, v16
    v_exp_f32 v17, v17
    v_exp_f32 v18, v18
    v_exp_f32 v19, v19
    s_waitcnt lgkmcnt(2)
    v_smfmac_f32_32x32x32_bf16 v[104:119], v[144:147], v[8:15], v152
    v_exp_f32 v20, v20
    v_exp_f32 v21, v21
    v_exp_f32 v22, v22
    v_exp_f32 v23, v23
    v_mfma_f32_32x32x4bf16_1k v[40:71], v[140:141], v[164:165], v[40:71] cbsz:1 abid:1
    ds_read_b64 v[140:141], v154 offset:12288
    v_exp_f32 v24, v24
    v_exp_f32 v25, v25
    v_exp_f32 v26, v26
    v_exp_f32 v27, v27
    v_exp_f32 v28, v28
    v_exp_f32 v29, v29
    v_exp_f32 v30, v30
    v_exp_f32 v31, v31
    s_waitcnt lgkmcnt(2)
    v_smfmac_f32_32x32x32_bf16 v[104:119], v[148:151], v[16:23], v152
    v_exp_f32 v32, v32
    v_exp_f32 v33, v33
    v_exp_f32 v34, v34
    v_exp_f32 v35, v35
    v_smfmac_f32_32x32x32_bf16 v[120:135], v[144:147], v[24:31], v152
    s_mov_b64 exec, s[60:61]
    ds_read_b128 v[144:147], v155 offset:3840
    s_mov_b64 exec, -1
    v_exp_f32 v36, v36
    v_exp_f32 v37, v37
    v_exp_f32 v38, v38
    v_exp_f32 v39, v39
    s_waitcnt lgkmcnt(1)
    v_mfma_f32_32x32x16_bf16 v[8:23], v[136:139], v[156:159], v[72:87]
    v_exp_f32 v40, v40
    v_exp_f32 v41, v41
    v_exp_f32 v42, v42
    v_exp_f32 v43, v43
    v_smfmac_f32_32x32x32_bf16 v[120:135], v[148:151], v[32:39], v152
    s_mov_b64 exec, s[60:61]
    ds_read_b128 v[148:151], v155 offset:4480
    s_mov_b64 exec, -1
    v_exp_f32 v44, v44
    v_exp_f32 v45, v45
    v_exp_f32 v46, v46
    v_exp_f32 v47, v47
    v_mfma_f32_32x32x16_bf16 v[24:39], v[136:139], v[160:163], v[88:103]
    ds_read_b128 v[136:139], v153 offset:11264
    v_exp_f32 v48, v48
    v_exp_f32 v49, v49
    v_exp_f32 v50, v50
    v_exp_f32 v51, v51
    s_waitcnt lgkmcnt(2)
    v_smfmac_f32_32x32x32_bf16 v[104:119], v[144:147], v[40:47], v152
    v_exp_f32 v52, v52
    v_exp_f32 v53, v53
    v_exp_f32 v54, v54
    v_exp_f32 v55, v55
    v_mfma_f32_32x32x4bf16_1k v[8:39], v[140:141], v[164:165], v[8:39] cbsz:1 abid:0
    v_exp_f32 v56, v56
    v_exp_f32 v57, v57
    v_exp_f32 v58, v58
    v_exp_f32 v59, v59
    v_exp_f32 v60, v60
    v_exp_f32 v61, v61
    v_exp_f32 v62, v62
    v_exp_f32 v63, v63
    s_waitcnt lgkmcnt(1)
    v_smfmac_f32_32x32x32_bf16 v[104:119], v[148:151], v[48:55], v152
    v_exp_f32 v64, v64
    v_exp_f32 v65, v65
    v_exp_f32 v66, v66
    v_exp_f32 v67, v67
    v_smfmac_f32_32x32x32_bf16 v[120:135], v[144:147], v[56:63], v152
    s_mov_b64 exec, s[60:61]
    ds_read_b128 v[144:147], v155 offset:12800
    s_mov_b64 exec, -1
    v_exp_f32 v68, v68
    v_exp_f32 v69, v69
    v_exp_f32 v70, v70
    v_exp_f32 v71, v71
    s_waitcnt lgkmcnt(1)
    v_mfma_f32_32x32x16_bf16 v[40:55], v[136:139], v[156:159], v[72:87]
    v_exp_f32 v8, v8
    v_exp_f32 v9, v9
    v_exp_f32 v10, v10
    v_exp_f32 v11, v11
    v_smfmac_f32_32x32x32_bf16 v[120:135], v[148:151], v[64:71], v152
    s_mov_b64 exec, s[60:61]
    ds_read_b128 v[148:151], v155 offset:13440
    s_mov_b64 exec, -1
    v_exp_f32 v12, v12
    v_exp_f32 v13, v13
    v_exp_f32 v14, v14
    v_exp_f32 v15, v15
    v_mfma_f32_32x32x16_bf16 v[56:71], v[136:139], v[160:163], v[88:103]
    ds_read_b128 v[136:139], v153 offset:20480
    v_exp_f32 v16, v16
    v_exp_f32 v17, v17
    v_exp_f32 v18, v18
    v_exp_f32 v19, v19
    s_waitcnt lgkmcnt(2)
    v_smfmac_f32_32x32x32_bf16 v[104:119], v[144:147], v[8:15], v152
    v_exp_f32 v20, v20
    v_exp_f32 v21, v21
    v_exp_f32 v22, v22
    v_exp_f32 v23, v23
    v_mfma_f32_32x32x4bf16_1k v[40:71], v[140:141], v[164:165], v[40:71] cbsz:1 abid:1
    ds_read_b64 v[140:141], v154 offset:22528
    v_exp_f32 v24, v24
    v_exp_f32 v25, v25
    v_exp_f32 v26, v26
    v_exp_f32 v27, v27
    v_exp_f32 v28, v28
    v_exp_f32 v29, v29
    v_exp_f32 v30, v30
    v_exp_f32 v31, v31
    s_waitcnt lgkmcnt(2)
    v_smfmac_f32_32x32x32_bf16 v[104:119], v[148:151], v[16:23], v152
    v_exp_f32 v32, v32
    v_exp_f32 v33, v33
    v_exp_f32 v34, v34
    v_exp_f32 v35, v35
    v_smfmac_f32_32x32x32_bf16 v[120:135], v[144:147], v[24:31], v152
    s_mov_b64 exec, s[60:61]
    ds_read_b128 v[144:147], v155 offset:14080
    s_mov_b64 exec, -1
    v_exp_f32 v36, v36
    v_exp_f32 v37, v37
    v_exp_f32 v38, v38
    v_exp_f32 v39, v39
    s_waitcnt lgkmcnt(1)
    v_mfma_f32_32x32x16_bf16 v[8:23], v[136:139], v[156:159], v[72:87]
    v_exp_f32 v40, v40
    v_exp_f32 v41, v41
    v_exp_f32 v42, v42
    v_exp_f32 v43, v43
    v_smfmac_f32_32x32x32_bf16 v[120:135], v[148:151], v[32:39], v152
    s_mov_b64 exec, s[60:61]
    ds_read_b128 v[148:151], v155 offset:14720
    s_mov_b64 exec, -1
    v_exp_f32 v44, v44
    v_exp_f32 v45, v45
    v_exp_f32 v46, v46
    v_exp_f32 v47, v47
    v_mfma_f32_32x32x16_bf16 v[24:39], v[136:139], v[160:163], v[88:103]
    ds_read_b128 v[136:139], v153 offset:21504
    v_exp_f32 v48, v48
    v_exp_f32 v49, v49
    v_exp_f32 v50, v50
    v_exp_f32 v51, v51
    s_waitcnt lgkmcnt(2)
    v_smfmac_f32_32x32x32_bf16 v[104:119], v[144:147], v[40:47], v152
    v_exp_f32 v52, v52
    v_exp_f32 v53, v53
    v_exp_f32 v54, v54
    v_exp_f32 v55, v55
    v_mfma_f32_32x32x4bf16_1k v[8:39], v[140:141], v[164:165], v[8:39] cbsz:1 abid:0
    v_exp_f32 v56, v56
    v_exp_f32 v57, v57
    v_exp_f32 v58, v58
    v_exp_f32 v59, v59
    v_exp_f32 v60, v60
    v_exp_f32 v61, v61
    v_exp_f32 v62, v62
    v_exp_f32 v63, v63
    s_waitcnt lgkmcnt(1)
    v_smfmac_f32_32x32x32_bf16 v[104:119], v[148:151], v[48:55], v152
    v_exp_f32 v64, v64
    v_exp_f32 v65, v65
    v_exp_f32 v66, v66
    v_exp_f32 v67, v67
    v_smfmac_f32_32x32x32_bf16 v[120:135], v[144:147], v[56:63], v152
    s_mov_b64 exec, s[60:61]
    ds_read_b128 v[144:147], v155 offset:23040
    s_mov_b64 exec, -1
    v_exp_f32 v68, v68
    v_exp_f32 v69, v69
    v_exp_f32 v70, v70
    v_exp_f32 v71, v71
    s_waitcnt lgkmcnt(1)
    v_mfma_f32_32x32x16_bf16 v[40:55], v[136:139], v[156:159], v[72:87]
    v_exp_f32 v8, v8
    v_exp_f32 v9, v9
    v_exp_f32 v10, v10
    v_exp_f32 v11, v11
    v_smfmac_f32_32x32x32_bf16 v[120:135], v[148:151], v[64:71], v152
    s_mov_b64 exec, s[60:61]
    ds_read_b128 v[148:151], v155 offset:23680
    s_mov_b64 exec, -1
    v_exp_f32 v12, v12
    v_exp_f32 v13, v13
    v_exp_f32 v14, v14
    v_exp_f32 v15, v15
    v_mfma_f32_32x32x16_bf16 v[56:71], v[136:139], v[160:163], v[88:103]
    ds_read_b128 v[136:139], v153 offset:30720
    v_exp_f32 v16, v16
    v_exp_f32 v17, v17
    v_exp_f32 v18, v18
    v_exp_f32 v19, v19
    s_waitcnt lgkmcnt(2)
    v_smfmac_f32_32x32x32_bf16 v[104:119], v[144:147], v[8:15], v152
    v_exp_f32 v20, v20
    v_exp_f32 v21, v21
    v_exp_f32 v22, v22
    v_exp_f32 v23, v23
    v_mfma_f32_32x32x4bf16_1k v[40:71], v[140:141], v[164:165], v[40:71] cbsz:1 abid:1
    ds_read_b64 v[140:141], v154 offset:32768
    v_exp_f32 v24, v24
    v_exp_f32 v25, v25
    v_exp_f32 v26, v26
    v_exp_f32 v27, v27
    v_exp_f32 v28, v28
    v_exp_f32 v29, v29
    v_exp_f32 v30, v30
    v_exp_f32 v31, v31
    s_waitcnt lgkmcnt(2)
    v_smfmac_f32_32x32x32_bf16 v[104:119], v[148:151], v[16:23], v152
    v_exp_f32 v32, v32
    v_exp_f32 v33, v33
    v_exp_f32 v34, v34
    v_exp_f32 v35, v35
    v_smfmac_f32_32x32x32_bf16 v[120:135], v[144:147], v[24:31], v152
    s_mov_b64 exec, s[60:61]
    ds_read_b128 v[144:147], v155 offset:24320
    s_mov_b64 exec, -1
    v_exp_f32 v36, v36
    v_exp_f32 v37, v37
    v_exp_f32 v38, v38
    v_exp_f32 v39, v39
    s_waitcnt lgkmcnt(1)
    v_mfma_f32_32x32x16_bf16 v[8:23], v[136:139], v[156:159], v[72:87]
    v_exp_f32 v40, v40
    v_exp_f32 v41, v41
    v_exp_f32 v42, v42
    v_exp_f32 v43, v43
    v_smfmac_f32_32x32x32_bf16 v[120:135], v[148:151], v[32:39], v152
    s_mov_b64 exec, s[60:61]
    ds_read_b128 v[148:151], v155 offset:24960
    s_mov_b64 exec, -1
    v_exp_f32 v44, v44
    v_exp_f32 v45, v45
    v_exp_f32 v46, v46
    v_exp_f32 v47, v47
    v_mfma_f32_32x32x16_bf16 v[24:39], v[136:139], v[160:163], v[88:103]
    ds_read_b128 v[136:139], v153 offset:31744
    v_exp_f32 v48, v48
    v_exp_f32 v49, v49
    v_exp_f32 v50, v50
    v_exp_f32 v51, v51
    s_waitcnt lgkmcnt(2)
    v_smfmac_f32_32x32x32_bf16 v[104:119], v[144:147], v[40:47], v152
    v_exp_f32 v52, v52
    v_exp_f32 v53, v53
    v_exp_f32 v54, v54
    v_exp_f32 v55, v55
    v_mfma_f32_32x32x4bf16_1k v[8:39], v[140:141], v[164:165], v[8:39] cbsz:1 abid:0
    v_exp_f32 v56, v56
    v_exp_f32 v57, v57
    v_exp_f32 v58, v58
    v_exp_f32 v59, v59
    v_exp_f32 v60, v60
    v_exp_f32 v61, v61
    v_exp_f32 v62, v62
    v_exp_f32 v63, v63
    s_waitcnt lgkmcnt(1)
    v_smfmac_f32_32x32x32_bf16 v[104:119], v[148:151], v[48:55], v152
    v_exp_f32 v64, v64
    v_exp_f32 v65, v65
    v_exp_f32 v66, v66
    v_exp_f32 v67, v67
    v_smfmac_f32_32x32x32_bf16 v[120:135], v[144:147], v[56:63], v152
    s_mov_b64 exec, s[60:61]
    ds_read_b128 v[144:147], v155 offset:33280
    s_mov_b64 exec, -1
    v_exp_f32 v68, v68
    v_exp_f32 v69, v69
    v_exp_f32 v70, v70
    v_exp_f32 v71, v71
    s_waitcnt lgkmcnt(1)
    v_mfma_f32_32x32x16_bf16 v[40:55], v[136:139], v[156:159], v[72:87]
    v_exp_f32 v8, v8
    v_exp_f32 v9, v9
    v_exp_f32 v10, v10
    v_exp_f32 v11, v11
    v_smfmac_f32_32x32x32_bf16 v[120:135], v[148:151], v[64:71], v152
    s_mov_b64 exec, s[60:61]
    ds_read_b128 v[148:151], v155 offset:33920
    s_mov_b64 exec, -1
    v_exp_f32 v12, v12
    v_exp_f32 v13, v13
    v_exp_f32 v14, v14
    v_exp_f32 v15, v15
    v_mfma_f32_32x32x16_bf16 v[56:71], v[136:139], v[160:163], v[88:103]
    ds_read_b128 v[136:139], v153 offset:40960
    v_exp_f32 v16, v16
    v_exp_f32 v17, v17
    v_exp_f32 v18, v18
    v_exp_f32 v19, v19
    s_waitcnt lgkmcnt(2)
    v_smfmac_f32_32x32x32_bf16 v[104:119], v[144:147], v[8:15], v152
    v_exp_f32 v20, v20
    v_exp_f32 v21, v21
    v_exp_f32 v22, v22
    v_exp_f32 v23, v23
    v_mfma_f32_32x32x4bf16_1k v[40:71], v[140:141], v[164:165], v[40:71] cbsz:1 abid:1
    ds_read_b64 v[140:141], v154 offset:43008
    v_exp_f32 v24, v24
    v_exp_f32 v25, v25
    v_exp_f32 v26, v26
    v_exp_f32 v27, v27
    v_exp_f32 v28, v28
    v_exp_f32 v29, v29
    v_exp_f32 v30, v30
    v_exp_f32 v31, v31
    s_waitcnt lgkmcnt(2)
    v_smfmac_f32_32x32x32_bf16 v[104:119], v[148:151], v[16:23], v152
    v_exp_f32 v32, v32
    v_exp_f32 v33, v33
    v_exp_f32 v34, v34
    v_exp_f32 v35, v35
    v_smfmac_f32_32x32x32_bf16 v[120:135], v[144:147], v[24:31], v152
    s_mov_b64 exec, s[60:61]
    ds_read_b128 v[144:147], v155 offset:34560
    s_mov_b64 exec, -1
    v_exp_f32 v36, v36
    v_exp_f32 v37, v37
    v_exp_f32 v38, v38
    v_exp_f32 v39, v39
    s_waitcnt lgkmcnt(1)
    v_mfma_f32_32x32x16_bf16 v[8:23], v[136:139], v[156:159], v[72:87]
    v_exp_f32 v40, v40
    v_exp_f32 v41, v41
    v_exp_f32 v42, v42
    v_exp_f32 v43, v43
    v_smfmac_f32_32x32x32_bf16 v[120:135], v[148:151], v[32:39], v152
    s_mov_b64 exec, s[60:61]
    ds_read_b128 v[148:151], v155 offset:35200
    s_mov_b64 exec, -1
    v_exp_f32 v44, v44
    v_exp_f32 v45, v45
    v_exp_f32 v46, v46
    v_exp_f32 v47, v47
    v_mfma_f32_32x32x16_bf16 v[24:39], v[136:139], v[160:163], v[88:103]
    ds_read_b128 v[136:139], v153 offset:41984
    v_exp_f32 v48, v48
    v_exp_f32 v49, v49
    v_exp_f32 v50, v50
    v_exp_f32 v51, v51
    s_waitcnt lgkmcnt(2)
    v_smfmac_f32_32x32x32_bf16 v[104:119], v[144:147], v[40:47], v152
    v_exp_f32 v52, v52
    v_exp_f32 v53, v53
    v_exp_f32 v54, v54
    v_exp_f32 v55, v55
    v_mfma_f32_32x32x4bf16_1k v[8:39], v[140:141], v[164:165], v[8:39] cbsz:1 abid:0
    v_exp_f32 v56, v56
    v_exp_f32 v57, v57
    v_exp_f32 v58, v58
    v_exp_f32 v59, v59
    v_exp_f32 v60, v60
    v_exp_f32 v61, v61
    v_exp_f32 v62, v62
    v_exp_f32 v63, v63
    s_waitcnt lgkmcnt(1)
    v_smfmac_f32_32x32x32_bf16 v[104:119], v[148:151], v[48:55], v152
    v_exp_f32 v64, v64
    v_exp_f32 v65, v65
    v_exp_f32 v66, v66
    v_exp_f32 v67, v67
    v_smfmac_f32_32x32x32_bf16 v[120:135], v[144:147], v[56:63], v152
    s_mov_b64 exec, s[60:61]
    ds_read_b128 v[144:147], v155 offset:43520
    s_mov_b64 exec, -1
    v_exp_f32 v68, v68
    v_exp_f32 v69, v69
    v_exp_f32 v70, v70
    v_exp_f32 v71, v71
    v_add_u32 v153, 40960, v153
    v_add_u32 v154, 40960, v154
    v_add_u32 v155, 40960, v155
    s_add_u32 s73, s73, 1
    s_cmp_lt_u32 s73, 4
    s_cbranch_scc1 L_fb_attn
    v_smfmac_f32_32x32x32_bf16 v[120:135], v[148:151], v[64:71], v152
    s_waitcnt lgkmcnt(0)
    s_barrier
    s_cmp_lt_u32 s52, 5
    s_cbranch_scc1 L_yd_done_f
    s_sub_u32 s64, s52, 5
    s_mul_i32 s65, s53, 327680
    s_lshl_b32 s66, s54, 7
    s_add_u32 s65, s65, s66
    s_lshl_b32 s66, s64, 15
    s_add_u32 s65, s65, s66
    s_lshl_b32 s66, s64, 10
    s_add_u32 m0, s66, 102400
    s_add_u32 s65, s65, 2883584
    buffer_load_dwordx4 v240, s[44:47], s65 offen sc1 lds
    s_add_u32 m0, m0, 3072
    s_add_u32 s65, s65, 98304
    buffer_load_dwordx4 v240, s[44:47], s65 offen sc1 lds
    s_add_u32 m0, m0, 3072
    s_add_u32 s65, s65, 98304
    buffer_load_dwordx4 v240, s[44:47], s65 offen sc1 lds
    s_add_u32 m0, m0, 3072
    s_add_u32 s65, s65, 98304
    s_cmp_lg_u32 s52, 5
    s_cbranch_scc1 L_yd_done_f
    buffer_load_dwordx4 v240, s[44:47], s65 offen sc1 lds
L_yd_done_f:
    s_mov_b32 s36, s12
    s_mov_b32 s37, s13
    s_mov_b32 s38, 819200
    s_mov_b32 s39, 0x00020000
    s_mul_i32 s91, s56, 160
    s_lshl_b32 s90, s52, 10
    s_cmp_ge_u32 s52, 5
    s_cbranch_scc1 L_tdsf_1
    s_mov_b32 m0, s90
    s_add_u32 s90, s90, 5120
    buffer_load_dwordx4 v245, s[36:39], s91 offen  lds
    s_add_u32 s91, s91, 40960
L_tdsf_1:
    s_cmp_ge_u32 s52, 5
    s_cbranch_scc1 L_tdsf_2
    s_mov_b32 m0, s90
    s_add_u32 s90, s90, 5120
    buffer_load_dwordx4 v245, s[36:39], s91 offen  lds
    s_add_u32 s91, s91, 40960
L_tdsf_2:
    s_cmp_ge_u32 s52, 5
    s_cbranch_scc1 L_tdsf_3
    s_mov_b32 m0, s90
    s_add_u32 s90, s90, 5120
    buffer_load_dwordx4 v245, s[36:39], s91 offen  lds
    s_add_u32 s91, s91, 40960
L_tdsf_3:
    s_cmp_ge_u32 s52, 5
    s_cbranch_scc1 L_tdsf_4
    s_mov_b32 m0, s90
    s_add_u32 s90, s90, 5120
    buffer_load_dwordx4 v245, s[36:39], s91 offen  lds
    s_add_u32 s91, s91, 40960
L_tdsf_4:
    s_cmp_ge_u32 s52, 5
    s_cbranch_scc1 L_tdsf_5
    s_mov_b32 m0, s90
    s_add_u32 s90, s90, 5120
    buffer_load_dwordx4 v245, s[36:39], s91 offen  lds
    s_add_u32 s91, s91, 40960
L_tdsf_5:
    s_cmp_ge_u32 s52, 5
    s_cbranch_scc1 L_tdsf_6
    s_mov_b32 m0, s90
    s_add_u32 s90, s90, 5120
    buffer_load_dwordx4 v245, s[36:39], s91 offen  lds
    s_add_u32 s91, s91, 40960
L_tdsf_6:
    s_cmp_ge_u32 s52, 5
    s_cbranch_scc1 L_tdsf_7
    s_mov_b32 m0, s90
    s_add_u32 s90, s90, 5120
    buffer_load_dwordx4 v245, s[36:39], s91 offen  lds
    s_add_u32 s91, s91, 40960
L_tdsf_7:
    s_cmp_ge_u32 s52, 5
    s_cbranch_scc1 L_tdsf_8
    s_mov_b32 m0, s90
    s_add_u32 s90, s90, 5120
    buffer_load_dwordx4 v245, s[36:39], s91 offen  lds
    s_add_u32 s91, s91, 40960
L_tdsf_8:
    s_cmp_ge_u32 s52, 5
    s_cbranch_scc1 L_tdsf_9
    s_mov_b32 m0, s90
    s_add_u32 s90, s90, 5120
    buffer_load_dwordx4 v245, s[36:39], s91 offen  lds
    s_add_u32 s91, s91, 40960
L_tdsf_9:
    s_cmp_ge_u32 s52, 5
    s_cbranch_scc1 L_tdsf_10
    s_mov_b32 m0, s90
    s_add_u32 s90, s90, 5120
    buffer_load_dwordx4 v245, s[36:39], s91 offen  lds
    s_add_u32 s91, s91, 40960
L_tdsf_10:
    s_cmp_ge_u32 s52, 5
    s_cbranch_scc1 L_tdsf_11
    s_mov_b32 m0, s90
    s_add_u32 s90, s90, 5120
    buffer_load_dwordx4 v245, s[36:39], s91 offen  lds
    s_add_u32 s91, s91, 40960
L_tdsf_11:
    s_cmp_ge_u32 s52, 5
    s_cbranch_scc1 L_tdsf_12
    s_mov_b32 m0, s90
    s_add_u32 s90, s90, 5120
    buffer_load_dwordx4 v245, s[36:39], s91 offen  lds
    s_add_u32 s91, s91, 40960
L_tdsf_12:
    s_cmp_ge_u32 s52, 5
    s_cbranch_scc1 L_tdsf_13
    s_mov_b32 m0, s90
    s_add_u32 s90, s90, 5120
    buffer_load_dwordx4 v245, s[36:39], s91 offen  lds
    s_add_u32 s91, s91, 40960
L_tdsf_13:
    s_cmp_ge_u32 s52, 5
    s_cbranch_scc1 L_tdsf_14
    s_mov_b32 m0, s90
    s_add_u32 s90, s90, 5120
    buffer_load_dwordx4 v245, s[36:39], s91 offen  lds
    s_add_u32 s91, s91, 40960
L_tdsf_14:
    s_cmp_ge_u32 s52, 5
    s_cbranch_scc1 L_tdsf_15
    s_mov_b32 m0, s90
    s_add_u32 s90, s90, 5120
    buffer_load_dwordx4 v245, s[36:39], s91 offen  lds
    s_add_u32 s91, s91, 40960
L_tdsf_15:
    s_cmp_ge_u32 s52, 5
    s_cbranch_scc1 L_tdsf_16
    s_mov_b32 m0, s90
    s_add_u32 s90, s90, 5120
    buffer_load_dwordx4 v245, s[36:39], s91 offen  lds
    s_add_u32 s91, s91, 40960
L_tdsf_16:
    s_cmp_ge_u32 s52, 5
    s_cbranch_scc1 L_tdsf_17
    s_mov_b32 m0, s90
    s_add_u32 s90, s90, 5120
    buffer_load_dwordx4 v245, s[36:39], s91 offen  lds
    s_add_u32 s91, s91, 40960
L_tdsf_17:
    s_cmp_ge_u32 s52, 5
    s_cbranch_scc1 L_tdsf_18
    s_mov_b32 m0, s90
    s_add_u32 s90, s90, 5120
    buffer_load_dwordx4 v245, s[36:39], s91 offen  lds
    s_add_u32 s91, s91, 40960
L_tdsf_18:
    s_cmp_ge_u32 s52, 5
    s_cbranch_scc1 L_tdsf_19
    s_mov_b32 m0, s90
    s_add_u32 s90, s90, 5120
    buffer_load_dwordx4 v245, s[36:39], s91 offen  lds
    s_add_u32 s91, s91, 40960
L_tdsf_19:
    s_cmp_ge_u32 s52, 5
    s_cbranch_scc1 L_tdsf_20
    s_mov_b32 m0, s90
    s_add_u32 s90, s90, 5120
    buffer_load_dwordx4 v245, s[36:39], s91 offen  lds
    s_add_u32 s91, s91, 40960
L_tdsf_20:
    s_branch L_ofin
.section .rodata,"a"
.p2align 6
.amdhsa_kernel concat_heads__grouped_kv_mqa__ssm_conv_s4d__prompt_kernel
  .amdhsa_next_free_vgpr 256
  .amdhsa_next_free_sgpr 96
  .amdhsa_accum_offset 256
  .amdhsa_group_segment_fixed_size 0
  .amdhsa_kernarg_size 120
  .amdhsa_user_sgpr_count 2
  .amdhsa_user_sgpr_kernarg_segment_ptr 1
  .amdhsa_system_sgpr_workgroup_id_x 1
  .amdhsa_float_denorm_mode_32 3
.end_amdhsa_kernel
```
